```python
import torch

def _softmax(x, axis=-1):
    return torch.softmax(x, dim=axis)
def _gelu(x):
    return torch.nn.functional.gelu(x, approximate="tanh")
def _silu(x):
    return torch.nn.functional.silu(x)
def _sigmoid(x):
    return torch.sigmoid(x)
def _layernorm(x, axis=-1, eps=1e-5):
    m = x.mean(dim=axis, keepdim=True)
    v = x.var(dim=axis, keepdim=True, unbiased=False)
    return (x - m) / torch.sqrt(v + eps)
def _scatter_add(tgt, idx, src, axis=0):
    return tgt.clone().index_add_(axis, idx, src)
def _segment_sum(src, seg, n):
    out = torch.zeros((n,) + src.shape[1:], dtype=src.dtype)
    return out.index_add_(0, seg, src)
def _pad(x, pw):
    flat = tuple(v for pair in reversed(pw) for v in pair)
    return torch.nn.functional.pad(x, flat)

kernel_name = 'parallel_sum__ssm_conv_s4d__glu_gated_bilinear__prompt'

def setup_inputs():

    _w = (lambda a: (lambda t: t.to(torch.bfloat16) if t.is_floating_point() else t)(torch.as_tensor(a)))
    def _A_setup():
        Bsz, L, D, N = 1, 2048, 576, 128
        return {
            "u": _w((lambda *s: torch.randn(*s, dtype=torch.bfloat16) * 0.05)(Bsz, L, D)),
            "log_A_real": _w((lambda *s: torch.randn(*s, dtype=torch.bfloat16) * 3.2)(D, N) * 0.5),
            "A_imag": _w((lambda *s: torch.randn(*s, dtype=torch.bfloat16) * 0.05)(D, N) * 3.14),
            "C_real": _w((lambda *s: torch.randn(*s, dtype=torch.bfloat16) * 0.2)(D, N) / N ** 0.5),
            "C_imag": _w((lambda *s: torch.randn(*s, dtype=torch.bfloat16) * 0.2)(D, N) / N ** 0.5),
            "log_dt": _w((lambda *s: torch.randn(*s, dtype=torch.bfloat16) * 0.05)(D) * 0.5 - 4.0),
            "D_skip": _w((lambda *s: torch.randn(*s, dtype=torch.bfloat16) * 0.05)(D)),
        }
    _A_in = _A_setup()

    def _B_setup():
        B, S, D, F = 1, 2048, 576, 4608
        return {
            "x": _w((lambda *s: torch.randn(*s, dtype=torch.bfloat16) * 0.05)(B, S, D)),
            "w_gate": _w((lambda *s: torch.randn(*s, dtype=torch.bfloat16) * 0.4)(D, F) * (D ** -0.5)),
            "w_up": _w((lambda *s: torch.randn(*s, dtype=torch.bfloat16) * 0.4)(D, F) * (D ** -0.5)),
            "w_down": _w((lambda *s: torch.randn(*s, dtype=torch.bfloat16) * 0.4)(F, D) * (F ** -0.5)),
        }
    _B_in = _B_setup()

    return {
        "A_u": _A_in["u"],
        "A_log_A_real": _A_in["log_A_real"],
        "A_A_imag": _A_in["A_imag"],
        "A_C_real": _A_in["C_real"],
        "A_C_imag": _A_in["C_imag"],
        "A_log_dt": _A_in["log_dt"],
        "A_D_skip": _A_in["D_skip"],
        "B_x": _B_in["x"],
        "B_w_gate": _B_in["w_gate"],
        "B_w_up": _B_in["w_up"],
        "B_w_down": _B_in["w_down"],
    }

def reference(A_u, A_log_A_real, A_A_imag, A_C_real, A_C_imag, A_log_dt, A_D_skip, B_x, B_w_gate, B_w_up, B_w_down):
    def _A_ref(u, log_A_real, A_imag, C_real, C_imag, log_dt, D_skip):
        L = u.shape[1]
        dt = torch.exp(log_dt)
        A = -torch.exp(log_A_real) + 1j * A_imag
        C = (C_real + 1j * C_imag) * dt[:, None]
        pos = (lambda x, dt: x.to(dt))(torch.arange(L), log_dt.dtype)
        P = torch.exp((A * dt[:, None])[:, :, None] * pos[None, None, :])
        K = 2.0 * torch.einsum("dn,dnl->dl", C, P).real
        L2 = 2 * L
        u_t = (lambda x, *d: x.permute(*d))(u, 0, 2, 1)
        Kf = (lambda x, *a, **k: torch.fft.rfft(x.float(), *a, **k))(K, L2)
        Uf = (lambda x, *a, **k: torch.fft.rfft(x.float(), *a, **k))(u_t, L2)
        y = (lambda x, *a, **k: torch.fft.irfft(x, *a, **k).to(torch.bfloat16))(Uf * Kf[None, :, :], L2)[:, :, :L]
        y = (lambda x, *d: x.permute(*d))(y, 0, 2, 1)
        return y + u * D_skip[None, None, :]

    def _B_ref(x, w_gate, w_up, w_down):
        g = torch.einsum("bsd,df->bsf", x, w_gate)
        u = torch.einsum("bsd,df->bsf", x, w_up)
        h = g * u
        return torch.einsum("bsf,fd->bsd", h, w_down)

    x = A_u
    xn = _layernorm(x, axis=-1)
    return x + _A_ref(xn, A_log_A_real, A_A_imag, A_C_real, A_C_imag, A_log_dt, A_D_skip) + _B_ref(xn, B_w_gate, B_w_up, B_w_down)
```

```asm
; @launch grid=(256,1,1) block=(256,1,1) lds=163840
.amdgcn_target "amdgcn-amd-amdhsa--gfx950"
.text
.globl parallel_sum__ssm_conv_s4d__glu_gated_bilinear__prompt_kernel
.p2align 8
.type parallel_sum__ssm_conv_s4d__glu_gated_bilinear__prompt_kernel,@function
parallel_sum__ssm_conv_s4d__glu_gated_bilinear__prompt_kernel:
L_top:
    s_cmp_ge_u32 s2, 256
    s_cbranch_scc1 L_end
    s_load_dwordx16 s[84:99], s[0:1], 48
    s_load_dwordx16 s[36:51], s[0:1], 0
    s_getpc_b64 s[80:81]
L_pc_1:
    s_sub_u32 s80, s80, L_pc_1-L_top
    s_subb_u32 s81, s81, 0
    s_and_b32 s82, s2, 0xf8
    v_lshrrev_b32 v244, 4, v0
    v_lshl_add_u32 v244, s82, 1, v244
    v_lshlrev_b32 v244, 7, v244
    v_min_u32 v244, L_end2-L_top, v244
    v_mov_b32 v245, s81
    v_add_co_u32 v244, vcc, s80, v244
    s_nop 1
    v_addc_co_u32 v245, vcc, 0, v245, vcc
    global_load_dword v250, v[244:245], off
    v_lshrrev_b32 v246, 6, v0
    v_and_b32 v243, 63, v0
    s_mov_b32 s3, 0
    v_readfirstlane_b32 s32, v246
    s_mov_b32 s26, 2359296
    s_mov_b32 s27, 0x00020000
    s_cmp_lg_u32 s32, 0
    s_cbranch_scc1 L_kg
L_ln:
    s_waitcnt lgkmcnt(0)
    s_mov_b64 s[24:25], s[36:37]
    v_lshrrev_b32 v8, 3, v243
    v_and_b32 v9, 7, v243
    s_mul_i32 s80, s2, 9216
    v_mul_u32_u24 v10, 1152, v8
    v_lshl_add_u32 v10, v9, 4, v10
    buffer_load_dwordx4 v[16:19], v10, s[24:27], s80 offen offset:0
    buffer_load_dwordx4 v[20:23], v10, s[24:27], s80 offen offset:128
    buffer_load_dwordx4 v[24:27], v10, s[24:27], s80 offen offset:256
    buffer_load_dwordx4 v[28:31], v10, s[24:27], s80 offen offset:384
    buffer_load_dwordx4 v[32:35], v10, s[24:27], s80 offen offset:512
    buffer_load_dwordx4 v[36:39], v10, s[24:27], s80 offen offset:640
    buffer_load_dwordx4 v[40:43], v10, s[24:27], s80 offen offset:768
    buffer_load_dwordx4 v[44:47], v10, s[24:27], s80 offen offset:896
    buffer_load_dwordx4 v[48:51], v10, s[24:27], s80 offen offset:1024
    s_mov_b64 s[4:5], s[88:89]
    s_mov_b64 s[8:9], s[90:91]
    s_mov_b64 s[76:77], s[96:97]
    s_mov_b64 s[16:17], s[98:99]
    s_mov_b64 s[20:21], s[92:93]
    s_mov_b64 s[28:29], s[94:95]
    s_mov_b32 s18, 67108864
    s_mov_b32 s19, s27
    s_mov_b32 s6, 5308416
    s_mov_b32 s7, s27
    s_mov_b32 s10, 5309440
    s_mov_b32 s11, s27
    s_mov_b32 s22, 5308416
    s_mov_b32 s23, s27
    s_mov_b32 s30, 2359296
    s_mov_b32 s31, s27
    s_mov_b32 s78, 256
    s_mov_b32 s79, s27
    s_and_b32 s33, s2, 7
    s_bfe_u32 s34, s2, 0x30003
    s_lshr_b32 s35, s2, 6
    s_lshl_b32 s36, s34, 2
    s_add_u32 s36, s36, s32
    s_lshl_b32 s37, s32, 11
    s_lshl_b32 s38, s32, 10
    s_and_b32 s58, s32, 1
    s_sub_u32 s8, s8, 1024
    s_subb_u32 s9, s9, 0
    v_lshrrev_b32 v244, 3, v243
    v_and_b32 v245, 3, v244
    v_xor_b32 v245, s58, v245
    v_lshlrev_b32 v245, 1, v245
    v_and_b32 v246, 7, v243
    v_xor_b32 v245, v245, v246
    v_mul_u32_u24 v244, 9216, v244
    v_lshl_add_u32 v244, v245, 4, v244
    s_mul_i32 s59, s32, 73728
    s_mul_i32 s60, s33, 1152
    s_lshl_b32 s61, s35, 7
    s_add_u32 s59, s59, s60
    s_add_u32 s59, s59, s61
    v_add_u32 v237, s59, v244
    v_add_u32 v238, 640, v237
    v_lshrrev_b32 v244, 1, v243
    v_and_b32 v245, 19, v244
    v_bfe_u32 v246, v244, 2, 1
    v_lshl_add_u32 v245, v246, 3, v245
    v_bfe_u32 v246, v244, 3, 1
    v_lshl_add_u32 v245, v246, 2, v245
    v_mul_u32_u24 v245, 9216, v245
    v_and_b32 v246, 1, v243
    v_lshl_add_u32 v245, v246, 4, v245
    s_lshr_b32 s59, s32, 1
    s_mul_i32 s59, s59, 294912
    s_add_u32 s59, s59, s60
    s_lshl_b32 s61, s35, 5
    s_add_u32 s59, s59, s61
    s_add_u32 s59, s59, 512
    v_add_u32 v239, s59, v245
    s_mov_b32 s40, 0
    s_mov_b32 s41, 294912
    s_mov_b32 s42, 589824
    s_mov_b32 s43, 884736
    s_mov_b32 s44, 1179648
    s_mov_b32 s45, 1474560
    s_mov_b32 s46, 1769472
    s_mov_b32 s47, 2064384
    s_mov_b32 s48, 2359296
    s_mov_b32 s49, 2654208
    s_mov_b32 s50, 2949120
    s_mov_b32 s51, 3244032
    s_mov_b32 s52, 3538944
    s_mov_b32 s53, 3833856
    s_mov_b32 s54, 4128768
    s_mov_b32 s55, 4423680
    s_mov_b32 s56, 4718592
    s_mov_b32 s57, 5013504
    s_mul_i32 s39, s36, 73728
    v_lshlrev_b32 v240, 4, v243
    v_add_u32 v241, 4096, v240
    v_lshrrev_b32 v244, 4, v243
    v_bfe_u32 v245, v243, 2, 2
    v_and_b32 v246, 3, v243
    v_lshlrev_b32 v246, 3, v246
    v_lshl_add_u32 v247, v245, 7, v246
    v_lshl_add_u32 v247, v244, 11, v247
    v_lshl_add_u32 v236, v245, 5, v246
    v_and_b32 v246, 1, v244
    v_lshl_add_u32 v236, v246, 7, v236
    v_xor_b32 v245, v245, v246
    v_lshrrev_b32 v244, 1, v244
    v_lshl_add_u32 v236, v244, 9, v236
    v_add_u32 v236, 57344, v236
    v_xor_b32 v244, 0, v245
    v_lshl_add_u32 v232, v244, 5, v247
    v_xor_b32 v244, 1, v245
    v_lshl_add_u32 v233, v244, 5, v247
    v_xor_b32 v244, 2, v245
    v_lshl_add_u32 v234, v244, 5, v247
    v_xor_b32 v244, 3, v245
    v_lshl_add_u32 v235, v244, 5, v247
    s_mul_i32 s100, s33, 2359296
    s_add_u32 s100, s100, s39
    s_add_u32 s100, s100, 16777216
    s_mul_i32 s101, s33, 663552
    s_xor_b32 s67, s35, 0
    s_lshl_b32 s58, s67, 13
    s_add_u32 s58, s58, s100
    s_mul_i32 s67, s67, 73728
    s_add_u32 s67, s67, s101
    s_xor_b32 s68, s35, 1
    s_lshl_b32 s59, s68, 13
    s_add_u32 s59, s59, s100
    s_mul_i32 s68, s68, 73728
    s_add_u32 s68, s68, s101
    s_xor_b32 s69, s35, 2
    s_lshl_b32 s60, s69, 13
    s_add_u32 s60, s60, s100
    s_mul_i32 s69, s69, 73728
    s_add_u32 s69, s69, s101
    s_xor_b32 s70, s35, 3
    s_lshl_b32 s61, s70, 13
    s_add_u32 s61, s61, s100
    s_mul_i32 s70, s70, 73728
    s_add_u32 s70, s70, s101
    s_mov_b32 s71, 4
    s_lshl_b32 s62, s71, 13
    s_add_u32 s62, s62, s100
    s_mul_i32 s71, s71, 73728
    s_add_u32 s71, s71, s101
    s_xor_b32 s72, s35, 3
    s_add_u32 s72, s72, 5
    s_lshl_b32 s63, s72, 13
    s_add_u32 s63, s63, s100
    s_mul_i32 s72, s72, 73728
    s_add_u32 s72, s72, s101
    s_xor_b32 s73, s35, 2
    s_add_u32 s73, s73, 5
    s_lshl_b32 s64, s73, 13
    s_add_u32 s64, s64, s100
    s_mul_i32 s73, s73, 73728
    s_add_u32 s73, s73, s101
    s_xor_b32 s74, s35, 1
    s_add_u32 s74, s74, 5
    s_lshl_b32 s65, s74, 13
    s_add_u32 s65, s65, s100
    s_mul_i32 s74, s74, 73728
    s_add_u32 s74, s74, s101
    s_xor_b32 s75, s35, 0
    s_add_u32 s75, s75, 5
    s_lshl_b32 s66, s75, 13
    s_add_u32 s66, s66, s100
    s_mul_i32 s75, s75, 73728
    s_add_u32 s75, s75, s101
    s_lshr_b32 s100, s35, 1
    s_lshl_b32 s100, s100, 12
    s_and_b32 s101, s35, 1
    s_lshl_b32 s101, s101, 9
    s_add_u32 s100, s100, s101
    v_lshrrev_b32 v244, 5, v243
    v_lshlrev_b32 v244, 9, v244
    v_add3_u32 v242, v240, v244, s100
    s_lshl_b32 s101, s34, 2
    s_add_u32 s101, s101, s35
    s_lshl_b32 s101, s101, 19
    s_add_u32 s101, s101, 35651584
    s_lshl_b32 s100, s33, 16
    s_add_u32 s100, s100, s37
    s_add_u32 s100, s100, s101
    s_lshl_b32 m0, s32, 17
    s_add_u32 s101, s101, m0
    s_lshl_b32 m0, s33, 10
    s_add_u32 s101, s101, m0
    s_and_b32 m0, s100, 65536
    s_add_u32 s101, s101, m0
    s_lshr_b32 m0, m0, 5
    s_add_u32 s39, s39, m0
    v_lshrrev_b32 v252, 3, v243
    v_min_u32 v252, 1, v252
    v_lshl_add_u32 v252, v252, 30, v240
    v_and_b32 v253, 7, v243
    v_lshlrev_b32 v253, 7, v253
    v_lshrrev_b32 v244, 4, v243
    v_lshlrev_b32 v244, 1, v244
    v_and_b32 v245, 7, v243
    v_xor_b32 v244, v244, v245
    s_lshr_b32 m0, s33, 2
    s_lshl1_add_u32 m0, s35, m0
    s_lshl_b32 m0, m0, 7
    v_lshl_add_u32 v244, v244, 4, m0
    v_lshrrev_b32 v245, 3, v243
    s_lshl_b32 m0, s32, 3
    v_add_u32 v246, m0, v245
    v_mul_u32_u24 v254, 1152, v246
    v_add_u32 v254, v254, v244
    v_add_u32 v255, 36864, v254
    s_mov_b32 s83, 1024
    s_lshr_b32 s82, s2, 3
    s_mul_i32 s82, s82, 110592
    s_mul_i32 s81, s33, 1152
    s_add_u32 s82, s82, s81
    s_add_u32 s82, s82, 1769472
    v_min_u32 v5, 47, v243
    v_lshrrev_b32 v5, 2, v5
    v_mul_u32_u24 v5, 9216, v5
    v_and_b32 v6, 3, v243
    v_lshlrev_b32 v6, 7, v6
    v_add3_u32 v5, v5, v6, s82
    v_mul_u32_u24 v10, 1344, v8
    v_lshl_add_u32 v10, v9, 4, v10
    v_mul_u32_u24 v11, 1344, v9
    v_lshl_add_u32 v11, v8, 4, v11
    v_add_u32 v10, 94208, v10
    v_add_u32 v11, 94208, v11
    v_lshrrev_b32 v12, 2, v8
    v_lshlrev_b32 v12, 12, v12
    v_and_b32 v13, 3, v8
    v_lshl_add_u32 v12, v13, 8, v12
    v_lshl_add_u32 v12, v9, 4, v12
    s_lshr_b32 s80, s2, 3
    s_mul_i32 s80, s80, 73728
    s_bfe_u32 s81, s2, 0x20001
    s_lshl_b32 s81, s81, 10
    s_add_u32 s80, s80, s81
    s_and_b32 s81, s2, 1
    s_lshl_b32 s81, s81, 7
    s_add_u32 s80, s80, s81
    s_mov_b32 s82, 0xffff0000
    s_waitcnt vmcnt(8)
    v_lshlrev_b32 v56, 16, v16
    v_and_b32 v57, s82, v16
    v_lshlrev_b32 v58, 16, v17
    v_and_b32 v59, s82, v17
    v_lshlrev_b32 v60, 16, v18
    v_and_b32 v61, s82, v18
    v_lshlrev_b32 v62, 16, v19
    v_and_b32 v63, s82, v19
    v_pk_add_f32 v[52:53], v[56:57], v[60:61]
    v_pk_add_f32 v[54:55], v[58:59], v[62:63]
    s_waitcnt vmcnt(7)
    v_lshlrev_b32 v64, 16, v20
    v_and_b32 v65, s82, v20
    v_lshlrev_b32 v66, 16, v21
    v_and_b32 v67, s82, v21
    v_lshlrev_b32 v68, 16, v22
    v_and_b32 v69, s82, v22
    v_lshlrev_b32 v70, 16, v23
    v_and_b32 v71, s82, v23
    v_pk_add_f32 v[52:53], v[52:53], v[64:65]
    v_pk_add_f32 v[54:55], v[54:55], v[66:67]
    v_pk_add_f32 v[52:53], v[52:53], v[68:69]
    v_pk_add_f32 v[54:55], v[54:55], v[70:71]
    s_waitcnt vmcnt(6)
    v_lshlrev_b32 v72, 16, v24
    v_and_b32 v73, s82, v24
    v_lshlrev_b32 v74, 16, v25
    v_and_b32 v75, s82, v25
    v_lshlrev_b32 v76, 16, v26
    v_and_b32 v77, s82, v26
    v_lshlrev_b32 v78, 16, v27
    v_and_b32 v79, s82, v27
    v_pk_add_f32 v[52:53], v[52:53], v[72:73]
    v_pk_add_f32 v[54:55], v[54:55], v[74:75]
    v_pk_add_f32 v[52:53], v[52:53], v[76:77]
    v_pk_add_f32 v[54:55], v[54:55], v[78:79]
    s_waitcnt vmcnt(5)
    v_lshlrev_b32 v80, 16, v28
    v_and_b32 v81, s82, v28
    v_lshlrev_b32 v82, 16, v29
    v_and_b32 v83, s82, v29
    v_lshlrev_b32 v84, 16, v30
    v_and_b32 v85, s82, v30
    v_lshlrev_b32 v86, 16, v31
    v_and_b32 v87, s82, v31
    v_pk_add_f32 v[52:53], v[52:53], v[80:81]
    v_pk_add_f32 v[54:55], v[54:55], v[82:83]
    v_pk_add_f32 v[52:53], v[52:53], v[84:85]
    v_pk_add_f32 v[54:55], v[54:55], v[86:87]
    s_waitcnt vmcnt(4)
    v_lshlrev_b32 v88, 16, v32
    v_and_b32 v89, s82, v32
    v_lshlrev_b32 v90, 16, v33
    v_and_b32 v91, s82, v33
    v_lshlrev_b32 v92, 16, v34
    v_and_b32 v93, s82, v34
    v_lshlrev_b32 v94, 16, v35
    v_and_b32 v95, s82, v35
    v_pk_add_f32 v[52:53], v[52:53], v[88:89]
    v_pk_add_f32 v[54:55], v[54:55], v[90:91]
    v_pk_add_f32 v[52:53], v[52:53], v[92:93]
    v_pk_add_f32 v[54:55], v[54:55], v[94:95]
    s_waitcnt vmcnt(3)
    v_lshlrev_b32 v96, 16, v36
    v_and_b32 v97, s82, v36
    v_lshlrev_b32 v98, 16, v37
    v_and_b32 v99, s82, v37
    v_lshlrev_b32 v100, 16, v38
    v_and_b32 v101, s82, v38
    v_lshlrev_b32 v102, 16, v39
    v_and_b32 v103, s82, v39
    v_pk_add_f32 v[52:53], v[52:53], v[96:97]
    v_pk_add_f32 v[54:55], v[54:55], v[98:99]
    v_pk_add_f32 v[52:53], v[52:53], v[100:101]
    v_pk_add_f32 v[54:55], v[54:55], v[102:103]
    s_waitcnt vmcnt(2)
    v_lshlrev_b32 v104, 16, v40
    v_and_b32 v105, s82, v40
    v_lshlrev_b32 v106, 16, v41
    v_and_b32 v107, s82, v41
    v_lshlrev_b32 v108, 16, v42
    v_and_b32 v109, s82, v42
    v_lshlrev_b32 v110, 16, v43
    v_and_b32 v111, s82, v43
    v_pk_add_f32 v[52:53], v[52:53], v[104:105]
    v_pk_add_f32 v[54:55], v[54:55], v[106:107]
    v_pk_add_f32 v[52:53], v[52:53], v[108:109]
    v_pk_add_f32 v[54:55], v[54:55], v[110:111]
    s_waitcnt vmcnt(1)
    v_lshlrev_b32 v112, 16, v44
    v_and_b32 v113, s82, v44
    v_lshlrev_b32 v114, 16, v45
    v_and_b32 v115, s82, v45
    v_lshlrev_b32 v116, 16, v46
    v_and_b32 v117, s82, v46
    v_lshlrev_b32 v118, 16, v47
    v_and_b32 v119, s82, v47
    v_pk_add_f32 v[52:53], v[52:53], v[112:113]
    v_pk_add_f32 v[54:55], v[54:55], v[114:115]
    v_pk_add_f32 v[52:53], v[52:53], v[116:117]
    v_pk_add_f32 v[54:55], v[54:55], v[118:119]
    s_waitcnt vmcnt(0)
    v_lshlrev_b32 v120, 16, v48
    v_and_b32 v121, s82, v48
    v_lshlrev_b32 v122, 16, v49
    v_and_b32 v123, s82, v49
    v_lshlrev_b32 v124, 16, v50
    v_and_b32 v125, s82, v50
    v_lshlrev_b32 v126, 16, v51
    v_and_b32 v127, s82, v51
    v_pk_add_f32 v[52:53], v[52:53], v[120:121]
    v_pk_add_f32 v[54:55], v[54:55], v[122:123]
    v_pk_add_f32 v[52:53], v[52:53], v[124:125]
    v_pk_add_f32 v[54:55], v[54:55], v[126:127]
    v_pk_add_f32 v[52:53], v[52:53], v[54:55]
    s_nop 0
    v_add_f32 v52, v52, v53
    s_nop 1
    v_add_f32_dpp v52, v52, v52 quad_perm:[1,0,3,2] row_mask:0xf bank_mask:0xf
    s_nop 1
    v_add_f32_dpp v52, v52, v52 quad_perm:[2,3,0,1] row_mask:0xf bank_mask:0xf
    s_nop 1
    v_add_f32_dpp v52, v52, v52 row_half_mirror row_mask:0xf bank_mask:0xf
    v_mul_f32 v52, 0x3ae38e39, v52
    v_mov_b32 v16, v52
    v_cvt_pk_bf16_f32 v17, v52, v52
    v_pk_add_f32 v[56:57], v[56:57], v[16:17] op_sel_hi:[1,0] neg_lo:[0,1] neg_hi:[0,1]
    v_pk_add_f32 v[58:59], v[58:59], v[16:17] op_sel_hi:[1,0] neg_lo:[0,1] neg_hi:[0,1]
    v_pk_add_f32 v[60:61], v[60:61], v[16:17] op_sel_hi:[1,0] neg_lo:[0,1] neg_hi:[0,1]
    v_pk_add_f32 v[62:63], v[62:63], v[16:17] op_sel_hi:[1,0] neg_lo:[0,1] neg_hi:[0,1]
    v_pk_add_f32 v[64:65], v[64:65], v[16:17] op_sel_hi:[1,0] neg_lo:[0,1] neg_hi:[0,1]
    v_pk_add_f32 v[66:67], v[66:67], v[16:17] op_sel_hi:[1,0] neg_lo:[0,1] neg_hi:[0,1]
    v_pk_add_f32 v[68:69], v[68:69], v[16:17] op_sel_hi:[1,0] neg_lo:[0,1] neg_hi:[0,1]
    v_pk_add_f32 v[70:71], v[70:71], v[16:17] op_sel_hi:[1,0] neg_lo:[0,1] neg_hi:[0,1]
    v_pk_add_f32 v[72:73], v[72:73], v[16:17] op_sel_hi:[1,0] neg_lo:[0,1] neg_hi:[0,1]
    v_pk_add_f32 v[74:75], v[74:75], v[16:17] op_sel_hi:[1,0] neg_lo:[0,1] neg_hi:[0,1]
    v_pk_add_f32 v[76:77], v[76:77], v[16:17] op_sel_hi:[1,0] neg_lo:[0,1] neg_hi:[0,1]
    v_pk_add_f32 v[78:79], v[78:79], v[16:17] op_sel_hi:[1,0] neg_lo:[0,1] neg_hi:[0,1]
    v_pk_add_f32 v[80:81], v[80:81], v[16:17] op_sel_hi:[1,0] neg_lo:[0,1] neg_hi:[0,1]
    v_pk_add_f32 v[82:83], v[82:83], v[16:17] op_sel_hi:[1,0] neg_lo:[0,1] neg_hi:[0,1]
    v_pk_add_f32 v[84:85], v[84:85], v[16:17] op_sel_hi:[1,0] neg_lo:[0,1] neg_hi:[0,1]
    v_pk_add_f32 v[86:87], v[86:87], v[16:17] op_sel_hi:[1,0] neg_lo:[0,1] neg_hi:[0,1]
    v_pk_add_f32 v[88:89], v[88:89], v[16:17] op_sel_hi:[1,0] neg_lo:[0,1] neg_hi:[0,1]
    v_pk_add_f32 v[90:91], v[90:91], v[16:17] op_sel_hi:[1,0] neg_lo:[0,1] neg_hi:[0,1]
    v_pk_add_f32 v[92:93], v[92:93], v[16:17] op_sel_hi:[1,0] neg_lo:[0,1] neg_hi:[0,1]
    v_pk_add_f32 v[94:95], v[94:95], v[16:17] op_sel_hi:[1,0] neg_lo:[0,1] neg_hi:[0,1]
    v_pk_add_f32 v[96:97], v[96:97], v[16:17] op_sel_hi:[1,0] neg_lo:[0,1] neg_hi:[0,1]
    v_pk_add_f32 v[98:99], v[98:99], v[16:17] op_sel_hi:[1,0] neg_lo:[0,1] neg_hi:[0,1]
    v_pk_add_f32 v[100:101], v[100:101], v[16:17] op_sel_hi:[1,0] neg_lo:[0,1] neg_hi:[0,1]
    v_pk_add_f32 v[102:103], v[102:103], v[16:17] op_sel_hi:[1,0] neg_lo:[0,1] neg_hi:[0,1]
    v_pk_add_f32 v[104:105], v[104:105], v[16:17] op_sel_hi:[1,0] neg_lo:[0,1] neg_hi:[0,1]
    v_pk_add_f32 v[106:107], v[106:107], v[16:17] op_sel_hi:[1,0] neg_lo:[0,1] neg_hi:[0,1]
    v_pk_add_f32 v[108:109], v[108:109], v[16:17] op_sel_hi:[1,0] neg_lo:[0,1] neg_hi:[0,1]
    v_pk_add_f32 v[110:111], v[110:111], v[16:17] op_sel_hi:[1,0] neg_lo:[0,1] neg_hi:[0,1]
    v_pk_add_f32 v[112:113], v[112:113], v[16:17] op_sel_hi:[1,0] neg_lo:[0,1] neg_hi:[0,1]
    v_pk_add_f32 v[114:115], v[114:115], v[16:17] op_sel_hi:[1,0] neg_lo:[0,1] neg_hi:[0,1]
    v_pk_add_f32 v[116:117], v[116:117], v[16:17] op_sel_hi:[1,0] neg_lo:[0,1] neg_hi:[0,1]
    v_pk_add_f32 v[118:119], v[118:119], v[16:17] op_sel_hi:[1,0] neg_lo:[0,1] neg_hi:[0,1]
    v_pk_add_f32 v[120:121], v[120:121], v[16:17] op_sel_hi:[1,0] neg_lo:[0,1] neg_hi:[0,1]
    v_pk_add_f32 v[122:123], v[122:123], v[16:17] op_sel_hi:[1,0] neg_lo:[0,1] neg_hi:[0,1]
    v_pk_add_f32 v[124:125], v[124:125], v[16:17] op_sel_hi:[1,0] neg_lo:[0,1] neg_hi:[0,1]
    v_pk_add_f32 v[126:127], v[126:127], v[16:17] op_sel_hi:[1,0] neg_lo:[0,1] neg_hi:[0,1]
    v_pk_mul_f32 v[52:53], v[56:57], v[56:57]
    v_pk_mul_f32 v[54:55], v[58:59], v[58:59]
    v_pk_fma_f32 v[52:53], v[60:61], v[60:61], v[52:53]
    v_pk_fma_f32 v[54:55], v[62:63], v[62:63], v[54:55]
    v_pk_fma_f32 v[52:53], v[64:65], v[64:65], v[52:53]
    v_pk_fma_f32 v[54:55], v[66:67], v[66:67], v[54:55]
    v_pk_fma_f32 v[52:53], v[68:69], v[68:69], v[52:53]
    v_pk_fma_f32 v[54:55], v[70:71], v[70:71], v[54:55]
    v_pk_fma_f32 v[52:53], v[72:73], v[72:73], v[52:53]
    v_pk_fma_f32 v[54:55], v[74:75], v[74:75], v[54:55]
    v_pk_fma_f32 v[52:53], v[76:77], v[76:77], v[52:53]
    v_pk_fma_f32 v[54:55], v[78:79], v[78:79], v[54:55]
    v_pk_fma_f32 v[52:53], v[80:81], v[80:81], v[52:53]
    v_pk_fma_f32 v[54:55], v[82:83], v[82:83], v[54:55]
    v_pk_fma_f32 v[52:53], v[84:85], v[84:85], v[52:53]
    v_pk_fma_f32 v[54:55], v[86:87], v[86:87], v[54:55]
    v_pk_fma_f32 v[52:53], v[88:89], v[88:89], v[52:53]
    v_pk_fma_f32 v[54:55], v[90:91], v[90:91], v[54:55]
    v_pk_fma_f32 v[52:53], v[92:93], v[92:93], v[52:53]
    v_pk_fma_f32 v[54:55], v[94:95], v[94:95], v[54:55]
    v_pk_fma_f32 v[52:53], v[96:97], v[96:97], v[52:53]
    v_pk_fma_f32 v[54:55], v[98:99], v[98:99], v[54:55]
    v_pk_fma_f32 v[52:53], v[100:101], v[100:101], v[52:53]
    v_pk_fma_f32 v[54:55], v[102:103], v[102:103], v[54:55]
    v_pk_fma_f32 v[52:53], v[104:105], v[104:105], v[52:53]
    v_pk_fma_f32 v[54:55], v[106:107], v[106:107], v[54:55]
    v_pk_fma_f32 v[52:53], v[108:109], v[108:109], v[52:53]
    v_pk_fma_f32 v[54:55], v[110:111], v[110:111], v[54:55]
    v_pk_fma_f32 v[52:53], v[112:113], v[112:113], v[52:53]
    v_pk_fma_f32 v[54:55], v[114:115], v[114:115], v[54:55]
    v_pk_fma_f32 v[52:53], v[116:117], v[116:117], v[52:53]
    v_pk_fma_f32 v[54:55], v[118:119], v[118:119], v[54:55]
    v_pk_fma_f32 v[52:53], v[120:121], v[120:121], v[52:53]
    v_pk_fma_f32 v[54:55], v[122:123], v[122:123], v[54:55]
    v_pk_fma_f32 v[52:53], v[124:125], v[124:125], v[52:53]
    v_pk_fma_f32 v[54:55], v[126:127], v[126:127], v[54:55]
    v_pk_add_f32 v[52:53], v[52:53], v[54:55]
    s_nop 0
    v_add_f32 v52, v52, v53
    s_nop 1
    v_add_f32_dpp v52, v52, v52 quad_perm:[1,0,3,2] row_mask:0xf bank_mask:0xf
    s_nop 1
    v_add_f32_dpp v52, v52, v52 quad_perm:[2,3,0,1] row_mask:0xf bank_mask:0xf
    s_nop 1
    v_add_f32_dpp v52, v52, v52 row_half_mirror row_mask:0xf bank_mask:0xf
    v_mul_f32 v52, 0x3ae38e39, v52
    v_cvt_pk_bf16_f32 v52, v52, v52
    v_lshlrev_b32 v17, 16, v17
    v_lshlrev_b32 v52, 16, v52
    v_add_f32 v52, 0x3727c5ac, v52
    v_cvt_pk_bf16_f32 v52, v52, v52
    v_sub_f32 v17, v16, v17
    v_lshlrev_b32 v52, 16, v52
    v_sqrt_f32 v52, v52
    s_nop 0
    v_cvt_pk_bf16_f32 v52, v52, v52
    v_lshlrev_b32 v52, 16, v52
    v_rcp_f32 v18, v52
    s_nop 0
    v_mul_f32 v19, v17, v18
    v_pk_fma_f32 v[56:57], v[56:57], v[18:19], v[18:19] op_sel:[0,0,1] op_sel_hi:[1,0,1]
    v_pk_fma_f32 v[58:59], v[58:59], v[18:19], v[18:19] op_sel:[0,0,1] op_sel_hi:[1,0,1]
    v_pk_fma_f32 v[60:61], v[60:61], v[18:19], v[18:19] op_sel:[0,0,1] op_sel_hi:[1,0,1]
    v_pk_fma_f32 v[62:63], v[62:63], v[18:19], v[18:19] op_sel:[0,0,1] op_sel_hi:[1,0,1]
    v_cvt_pk_bf16_f32 v20, v56, v57
    v_cvt_pk_bf16_f32 v21, v58, v59
    v_cvt_pk_bf16_f32 v22, v60, v61
    v_cvt_pk_bf16_f32 v23, v62, v63
    ds_write_b128 v10, v[20:23] offset:0
    v_pk_fma_f32 v[64:65], v[64:65], v[18:19], v[18:19] op_sel:[0,0,1] op_sel_hi:[1,0,1]
    v_pk_fma_f32 v[66:67], v[66:67], v[18:19], v[18:19] op_sel:[0,0,1] op_sel_hi:[1,0,1]
    v_pk_fma_f32 v[68:69], v[68:69], v[18:19], v[18:19] op_sel:[0,0,1] op_sel_hi:[1,0,1]
    v_pk_fma_f32 v[70:71], v[70:71], v[18:19], v[18:19] op_sel:[0,0,1] op_sel_hi:[1,0,1]
    v_cvt_pk_bf16_f32 v24, v64, v65
    v_cvt_pk_bf16_f32 v25, v66, v67
    v_cvt_pk_bf16_f32 v26, v68, v69
    v_cvt_pk_bf16_f32 v27, v70, v71
    ds_write_b128 v10, v[24:27] offset:128
    v_pk_fma_f32 v[72:73], v[72:73], v[18:19], v[18:19] op_sel:[0,0,1] op_sel_hi:[1,0,1]
    v_pk_fma_f32 v[74:75], v[74:75], v[18:19], v[18:19] op_sel:[0,0,1] op_sel_hi:[1,0,1]
    v_pk_fma_f32 v[76:77], v[76:77], v[18:19], v[18:19] op_sel:[0,0,1] op_sel_hi:[1,0,1]
    v_pk_fma_f32 v[78:79], v[78:79], v[18:19], v[18:19] op_sel:[0,0,1] op_sel_hi:[1,0,1]
    v_cvt_pk_bf16_f32 v28, v72, v73
    v_cvt_pk_bf16_f32 v29, v74, v75
    v_cvt_pk_bf16_f32 v30, v76, v77
    v_cvt_pk_bf16_f32 v31, v78, v79
    ds_write_b128 v10, v[28:31] offset:256
    v_pk_fma_f32 v[80:81], v[80:81], v[18:19], v[18:19] op_sel:[0,0,1] op_sel_hi:[1,0,1]
    v_pk_fma_f32 v[82:83], v[82:83], v[18:19], v[18:19] op_sel:[0,0,1] op_sel_hi:[1,0,1]
    v_pk_fma_f32 v[84:85], v[84:85], v[18:19], v[18:19] op_sel:[0,0,1] op_sel_hi:[1,0,1]
    v_pk_fma_f32 v[86:87], v[86:87], v[18:19], v[18:19] op_sel:[0,0,1] op_sel_hi:[1,0,1]
    v_cvt_pk_bf16_f32 v32, v80, v81
    v_cvt_pk_bf16_f32 v33, v82, v83
    v_cvt_pk_bf16_f32 v34, v84, v85
    v_cvt_pk_bf16_f32 v35, v86, v87
    ds_write_b128 v10, v[32:35] offset:384
    v_pk_fma_f32 v[88:89], v[88:89], v[18:19], v[18:19] op_sel:[0,0,1] op_sel_hi:[1,0,1]
    v_pk_fma_f32 v[90:91], v[90:91], v[18:19], v[18:19] op_sel:[0,0,1] op_sel_hi:[1,0,1]
    v_pk_fma_f32 v[92:93], v[92:93], v[18:19], v[18:19] op_sel:[0,0,1] op_sel_hi:[1,0,1]
    v_pk_fma_f32 v[94:95], v[94:95], v[18:19], v[18:19] op_sel:[0,0,1] op_sel_hi:[1,0,1]
    v_cvt_pk_bf16_f32 v20, v88, v89
    v_cvt_pk_bf16_f32 v21, v90, v91
    v_cvt_pk_bf16_f32 v22, v92, v93
    v_cvt_pk_bf16_f32 v23, v94, v95
    ds_write_b128 v10, v[20:23] offset:512
    v_pk_fma_f32 v[96:97], v[96:97], v[18:19], v[18:19] op_sel:[0,0,1] op_sel_hi:[1,0,1]
    v_pk_fma_f32 v[98:99], v[98:99], v[18:19], v[18:19] op_sel:[0,0,1] op_sel_hi:[1,0,1]
    v_pk_fma_f32 v[100:101], v[100:101], v[18:19], v[18:19] op_sel:[0,0,1] op_sel_hi:[1,0,1]
    v_pk_fma_f32 v[102:103], v[102:103], v[18:19], v[18:19] op_sel:[0,0,1] op_sel_hi:[1,0,1]
    v_cvt_pk_bf16_f32 v24, v96, v97
    v_cvt_pk_bf16_f32 v25, v98, v99
    v_cvt_pk_bf16_f32 v26, v100, v101
    v_cvt_pk_bf16_f32 v27, v102, v103
    ds_write_b128 v10, v[24:27] offset:640
    v_pk_fma_f32 v[104:105], v[104:105], v[18:19], v[18:19] op_sel:[0,0,1] op_sel_hi:[1,0,1]
    v_pk_fma_f32 v[106:107], v[106:107], v[18:19], v[18:19] op_sel:[0,0,1] op_sel_hi:[1,0,1]
    v_pk_fma_f32 v[108:109], v[108:109], v[18:19], v[18:19] op_sel:[0,0,1] op_sel_hi:[1,0,1]
    v_pk_fma_f32 v[110:111], v[110:111], v[18:19], v[18:19] op_sel:[0,0,1] op_sel_hi:[1,0,1]
    v_cvt_pk_bf16_f32 v28, v104, v105
    v_cvt_pk_bf16_f32 v29, v106, v107
    v_cvt_pk_bf16_f32 v30, v108, v109
    v_cvt_pk_bf16_f32 v31, v110, v111
    ds_write_b128 v10, v[28:31] offset:768
    v_pk_fma_f32 v[112:113], v[112:113], v[18:19], v[18:19] op_sel:[0,0,1] op_sel_hi:[1,0,1]
    v_pk_fma_f32 v[114:115], v[114:115], v[18:19], v[18:19] op_sel:[0,0,1] op_sel_hi:[1,0,1]
    v_pk_fma_f32 v[116:117], v[116:117], v[18:19], v[18:19] op_sel:[0,0,1] op_sel_hi:[1,0,1]
    v_pk_fma_f32 v[118:119], v[118:119], v[18:19], v[18:19] op_sel:[0,0,1] op_sel_hi:[1,0,1]
    v_cvt_pk_bf16_f32 v32, v112, v113
    v_cvt_pk_bf16_f32 v33, v114, v115
    v_cvt_pk_bf16_f32 v34, v116, v117
    v_cvt_pk_bf16_f32 v35, v118, v119
    ds_write_b128 v10, v[32:35] offset:896
    v_pk_fma_f32 v[120:121], v[120:121], v[18:19], v[18:19] op_sel:[0,0,1] op_sel_hi:[1,0,1]
    v_pk_fma_f32 v[122:123], v[122:123], v[18:19], v[18:19] op_sel:[0,0,1] op_sel_hi:[1,0,1]
    v_pk_fma_f32 v[124:125], v[124:125], v[18:19], v[18:19] op_sel:[0,0,1] op_sel_hi:[1,0,1]
    v_pk_fma_f32 v[126:127], v[126:127], v[18:19], v[18:19] op_sel:[0,0,1] op_sel_hi:[1,0,1]
    v_cvt_pk_bf16_f32 v20, v120, v121
    v_cvt_pk_bf16_f32 v21, v122, v123
    v_cvt_pk_bf16_f32 v22, v124, v125
    v_cvt_pk_bf16_f32 v23, v126, v127
    ds_write_b128 v10, v[20:23] offset:1024
    ds_read_b128 v[56:59], v11 offset:0
    ds_read_b128 v[60:63], v11 offset:128
    ds_read_b128 v[64:67], v11 offset:256
    ds_read_b128 v[68:71], v11 offset:384
    ds_read_b128 v[72:75], v11 offset:512
    ds_read_b128 v[76:79], v11 offset:640
    ds_read_b128 v[80:83], v11 offset:768
    ds_read_b128 v[84:87], v11 offset:896
    ds_read_b128 v[88:91], v11 offset:1024
    s_waitcnt lgkmcnt(8)
    buffer_store_dwordx4 v[56:59], v12, s[16:19], s80 offen sc1
    s_add_u32 s80, s80, 8192
    s_waitcnt lgkmcnt(7)
    buffer_store_dwordx4 v[60:63], v12, s[16:19], s80 offen sc1
    s_add_u32 s80, s80, 8192
    s_waitcnt lgkmcnt(6)
    buffer_store_dwordx4 v[64:67], v12, s[16:19], s80 offen sc1
    s_add_u32 s80, s80, 8192
    s_waitcnt lgkmcnt(5)
    buffer_store_dwordx4 v[68:71], v12, s[16:19], s80 offen sc1
    s_add_u32 s80, s80, 8192
    s_waitcnt lgkmcnt(4)
    buffer_store_dwordx4 v[72:75], v12, s[16:19], s80 offen sc1
    s_add_u32 s80, s80, 8192
    s_waitcnt lgkmcnt(3)
    buffer_store_dwordx4 v[76:79], v12, s[16:19], s80 offen sc1
    s_add_u32 s80, s80, 8192
    s_waitcnt lgkmcnt(2)
    buffer_store_dwordx4 v[80:83], v12, s[16:19], s80 offen sc1
    s_add_u32 s80, s80, 8192
    s_waitcnt lgkmcnt(1)
    buffer_store_dwordx4 v[84:87], v12, s[16:19], s80 offen sc1
    s_add_u32 s80, s80, 8192
    s_waitcnt lgkmcnt(0)
    buffer_store_dwordx4 v[88:91], v12, s[16:19], s80 offen sc1
    buffer_load_dwordx2 v[248:249], off, s[76:79], 0 sc1
    s_lshl_b32 s80, s2, 7
    s_add_u32 s80, s80, 9437184
    v_add_u32 v2, 0, v237
    v_add_u32 v3, 73728, v237
    v_xor_b32 v3, 32, v3
    v_add_u32 v4, 0, v239
    s_mov_b32 m0, 0
    s_nop 0
    buffer_load_dwordx4 v2, s[4:7], s40 offen lds
    buffer_load_dwordx4 v2, s[8:11], s40 offen offset:1024 lds
    s_mov_b32 m0, 2048
    s_nop 0
    buffer_load_dwordx4 v3, s[4:7], s40 offen lds
    buffer_load_dwordx4 v3, s[8:11], s40 offen offset:1024 lds
    s_mov_b32 m0, 8192
    s_nop 0
    buffer_load_dwordx4 v2, s[4:7], s41 offen lds
    buffer_load_dwordx4 v2, s[8:11], s41 offen offset:1024 lds
    s_mov_b32 m0, 10240
    s_nop 0
    buffer_load_dwordx4 v3, s[4:7], s41 offen lds
    buffer_load_dwordx4 v3, s[8:11], s41 offen offset:1024 lds
    s_mov_b32 m0, 16384
    s_nop 0
    buffer_load_dwordx4 v2, s[4:7], s42 offen lds
    buffer_load_dwordx4 v2, s[8:11], s42 offen offset:1024 lds
    s_mov_b32 m0, 18432
    s_nop 0
    buffer_load_dwordx4 v3, s[4:7], s42 offen lds
    buffer_load_dwordx4 v3, s[8:11], s42 offen offset:1024 lds
    s_mov_b32 m0, 24576
    s_nop 0
    buffer_load_dwordx4 v2, s[4:7], s43 offen lds
    buffer_load_dwordx4 v2, s[8:11], s43 offen offset:1024 lds
    s_mov_b32 m0, 26624
    s_nop 0
    buffer_load_dwordx4 v3, s[4:7], s43 offen lds
    buffer_load_dwordx4 v3, s[8:11], s43 offen offset:1024 lds
    s_waitcnt vmcnt(16)
    v_cmp_eq_u32 vcc, 0, v248
    s_cbranch_vccnz L_slow_2
L_back_3:
    buffer_store_dwordx4 v[248:251], v252, s[16:19], s80 offen sc1
    buffer_load_dword v212, v5, s[4:7], 0 offen
    buffer_load_dword v213, v5, s[8:11], 0 offen offset:1024
    s_mov_b32 m0, 32768
    s_nop 0
    buffer_load_dwordx4 v2, s[4:7], s44 offen lds
    buffer_load_dwordx4 v2, s[8:11], s44 offen offset:1024 lds
    s_mov_b32 m0, 34816
    s_nop 0
    buffer_load_dwordx4 v3, s[4:7], s44 offen lds
    buffer_load_dwordx4 v3, s[8:11], s44 offen offset:1024 lds
    s_mov_b32 m0, 40960
    s_nop 0
    buffer_load_dwordx4 v2, s[4:7], s45 offen lds
    buffer_load_dwordx4 v2, s[8:11], s45 offen offset:1024 lds
    s_mov_b32 m0, 43008
    s_nop 0
    buffer_load_dwordx4 v3, s[4:7], s45 offen lds
    buffer_load_dwordx4 v3, s[8:11], s45 offen offset:1024 lds
    s_mov_b32 m0, 57344
    s_nop 0
    buffer_load_dwordx4 v4, s[4:7], s40 offen lds
    buffer_load_dwordx4 v4, s[8:11], s40 offen offset:1024 lds
    s_mov_b32 m0, 61440
    s_nop 0
    buffer_load_dwordx4 v4, s[4:7], s42 offen lds
    buffer_load_dwordx4 v4, s[8:11], s42 offen offset:1024 lds
    s_mov_b32 m0, 65536
    s_nop 0
    buffer_load_dwordx4 v4, s[4:7], s44 offen lds
    buffer_load_dwordx4 v4, s[8:11], s44 offen offset:1024 lds
    s_mov_b32 m0, 69632
    s_nop 0
    buffer_load_dwordx4 v4, s[4:7], s46 offen lds
    buffer_load_dwordx4 v4, s[8:11], s46 offen offset:1024 lds
    s_mov_b32 m0, 73728
    s_nop 0
    buffer_load_dwordx4 v4, s[4:7], s48 offen lds
    buffer_load_dwordx4 v4, s[8:11], s48 offen offset:1024 lds
    s_mov_b32 m0, 77824
    s_nop 0
    buffer_load_dwordx4 v4, s[4:7], s50 offen lds
    buffer_load_dwordx4 v4, s[8:11], s50 offen offset:1024 lds
    s_mov_b32 m0, 81920
    s_nop 0
    buffer_load_dwordx4 v4, s[4:7], s52 offen lds
    buffer_load_dwordx4 v4, s[8:11], s52 offen offset:1024 lds
    s_lshl_b32 s80, s36, 10
    s_add_u32 s80, s80, 9437184
    buffer_load_dwordx2 v[250:251], v253, s[16:19], s80 offen sc1
    s_mov_b32 m0, 86016
    s_nop 0
    buffer_load_dwordx4 v4, s[4:7], s54 offen lds
    buffer_load_dwordx4 v4, s[8:11], s54 offen offset:1024 lds
    s_mov_b32 m0, 90112
    s_nop 0
    buffer_load_dwordx4 v4, s[4:7], s56 offen lds
    buffer_load_dwordx4 v4, s[8:11], s56 offen offset:1024 lds
    s_cmp_ge_u32 s2, 64
    s_cbranch_scc1 L_chk
    v_add_u32 v2, 147456, v237
    v_add_u32 v3, 221184, v237
    v_xor_b32 v3, 32, v3
    v_add_u32 v4, 294912, v239
L_dma2:
    s_mov_b32 m0, 4096
    s_nop 0
    buffer_load_dwordx4 v2, s[4:7], s40 offen lds
    buffer_load_dwordx4 v2, s[8:11], s40 offen offset:1024 lds
    s_mov_b32 m0, 6144
    s_nop 0
    buffer_load_dwordx4 v3, s[4:7], s40 offen lds
    buffer_load_dwordx4 v3, s[8:11], s40 offen offset:1024 lds
    s_mov_b32 m0, 12288
    s_nop 0
    buffer_load_dwordx4 v2, s[4:7], s41 offen lds
    buffer_load_dwordx4 v2, s[8:11], s41 offen offset:1024 lds
    s_mov_b32 m0, 14336
    s_nop 0
    buffer_load_dwordx4 v3, s[4:7], s41 offen lds
    buffer_load_dwordx4 v3, s[8:11], s41 offen offset:1024 lds
    s_mov_b32 m0, 20480
    s_nop 0
    buffer_load_dwordx4 v2, s[4:7], s42 offen lds
    buffer_load_dwordx4 v2, s[8:11], s42 offen offset:1024 lds
    s_mov_b32 m0, 22528
    s_nop 0
    buffer_load_dwordx4 v3, s[4:7], s42 offen lds
    buffer_load_dwordx4 v3, s[8:11], s42 offen offset:1024 lds
    s_mov_b32 m0, 28672
    s_nop 0
    buffer_load_dwordx4 v2, s[4:7], s43 offen lds
    buffer_load_dwordx4 v2, s[8:11], s43 offen offset:1024 lds
    s_mov_b32 m0, 30720
    s_nop 0
    buffer_load_dwordx4 v3, s[4:7], s43 offen lds
    buffer_load_dwordx4 v3, s[8:11], s43 offen offset:1024 lds
    s_mov_b32 m0, 36864
    s_nop 0
    buffer_load_dwordx4 v2, s[4:7], s44 offen lds
    buffer_load_dwordx4 v2, s[8:11], s44 offen offset:1024 lds
    s_mov_b32 m0, 38912
    s_nop 0
    buffer_load_dwordx4 v3, s[4:7], s44 offen lds
    buffer_load_dwordx4 v3, s[8:11], s44 offen offset:1024 lds
    s_mov_b32 m0, 45056
    s_nop 0
    buffer_load_dwordx4 v2, s[4:7], s45 offen lds
    buffer_load_dwordx4 v2, s[8:11], s45 offen offset:1024 lds
    s_mov_b32 m0, 47104
    s_nop 0
    buffer_load_dwordx4 v3, s[4:7], s45 offen lds
    buffer_load_dwordx4 v3, s[8:11], s45 offen offset:1024 lds
    s_mov_b32 m0, 59392
    s_nop 0
    buffer_load_dwordx4 v4, s[4:7], s40 offen lds
    buffer_load_dwordx4 v4, s[8:11], s40 offen offset:1024 lds
    s_mov_b32 m0, 63488
    s_nop 0
    buffer_load_dwordx4 v4, s[4:7], s42 offen lds
    buffer_load_dwordx4 v4, s[8:11], s42 offen offset:1024 lds
    s_mov_b32 m0, 67584
    s_nop 0
    buffer_load_dwordx4 v4, s[4:7], s44 offen lds
    buffer_load_dwordx4 v4, s[8:11], s44 offen offset:1024 lds
    s_mov_b32 m0, 71680
    s_nop 0
    buffer_load_dwordx4 v4, s[4:7], s46 offen lds
    buffer_load_dwordx4 v4, s[8:11], s46 offen offset:1024 lds
    s_mov_b32 m0, 75776
    s_nop 0
    buffer_load_dwordx4 v4, s[4:7], s48 offen lds
    buffer_load_dwordx4 v4, s[8:11], s48 offen offset:1024 lds
    s_mov_b32 m0, 79872
    s_nop 0
    buffer_load_dwordx4 v4, s[4:7], s50 offen lds
    buffer_load_dwordx4 v4, s[8:11], s50 offen offset:1024 lds
    s_mov_b32 m0, 83968
    s_nop 0
    buffer_load_dwordx4 v4, s[4:7], s52 offen lds
    buffer_load_dwordx4 v4, s[8:11], s52 offen offset:1024 lds
    s_lshl_b32 s80, s36, 10
    s_add_u32 s80, s80, 9437184
    buffer_load_dwordx2 v[250:251], v253, s[16:19], s80 offen sc1
    s_mov_b32 m0, 88064
    s_nop 0
    buffer_load_dwordx4 v4, s[4:7], s54 offen lds
    buffer_load_dwordx4 v4, s[8:11], s54 offen offset:1024 lds
    s_mov_b32 m0, 92160
    s_nop 0
    buffer_load_dwordx4 v4, s[4:7], s56 offen lds
    buffer_load_dwordx4 v4, s[8:11], s56 offen offset:1024 lds
L_chk:
    s_waitcnt vmcnt(4)
    v_cmp_eq_u32 vcc, 0, v248
    s_cbranch_vccnz L_slow_4
L_back_5:
    v_cmp_ne_u64 vcc, v[250:251], v[248:249]
    s_cbranch_vccnz L_slow_6
L_back_7:
    s_xor_b32 s79, s39, 2048
    buffer_load_dwordx4 a[0:3], v240, s[16:19], s39 offen offset:0 sc1
    buffer_load_dwordx4 a[4:7], v240, s[16:19], s39 offen offset:1024 sc1
    buffer_load_dwordx4 a[8:11], v240, s[16:19], s79 offen offset:0 sc1
    buffer_load_dwordx4 a[12:15], v240, s[16:19], s79 offen offset:1024 sc1
    buffer_load_dwordx4 a[16:19], v241, s[16:19], s39 offen offset:0 sc1
    buffer_load_dwordx4 a[20:23], v241, s[16:19], s39 offen offset:1024 sc1
    buffer_load_dwordx4 a[24:27], v241, s[16:19], s79 offen offset:0 sc1
    buffer_load_dwordx4 a[28:31], v241, s[16:19], s79 offen offset:1024 sc1
    s_add_u32 s39, s39, 8192
    s_xor_b32 s79, s39, 2048
    buffer_load_dwordx4 a[32:35], v240, s[16:19], s39 offen offset:0 sc1
    buffer_load_dwordx4 a[36:39], v240, s[16:19], s39 offen offset:1024 sc1
    buffer_load_dwordx4 a[40:43], v240, s[16:19], s79 offen offset:0 sc1
    buffer_load_dwordx4 a[44:47], v240, s[16:19], s79 offen offset:1024 sc1
    buffer_load_dwordx4 a[48:51], v241, s[16:19], s39 offen offset:0 sc1
    buffer_load_dwordx4 a[52:55], v241, s[16:19], s39 offen offset:1024 sc1
    buffer_load_dwordx4 a[56:59], v241, s[16:19], s79 offen offset:0 sc1
    buffer_load_dwordx4 a[60:63], v241, s[16:19], s79 offen offset:1024 sc1
    s_add_u32 s39, s39, 8192
    s_waitcnt vmcnt(16)
    s_branch L_go
L_kg:
    s_mov_b32 s18, 67108864
    s_mov_b32 s19, s27
    s_mov_b32 s6, 5308416
    s_mov_b32 s7, s27
    s_mov_b32 s10, 5309440
    s_mov_b32 s11, s27
    s_mov_b32 s22, 5308416
    s_mov_b32 s23, s27
    s_mov_b32 s30, 2359296
    s_mov_b32 s31, s27
    s_mov_b32 s78, 256
    s_mov_b32 s79, s27
    s_lshl_b32 s83, s2, 1
    s_lshr_b32 s80, s32, 1
    s_add_u32 s83, s83, s80
    s_add_u32 s80, s2, 512
    s_cmp_eq_u32 s32, 2
    s_cselect_b32 s83, s80, s83
    s_mov_b32 s54, 147456
    s_mov_b32 s55, s27
    s_mov_b32 s58, 147456
    s_mov_b32 s59, s27
    s_mov_b32 s62, 147456
    s_mov_b32 s63, s27
    s_mov_b32 s66, 147456
    s_mov_b32 s67, s27
    s_mov_b32 s70, 1152
    s_mov_b32 s71, s27
    s_mov_b32 s74, 1152
    s_mov_b32 s75, s27
    s_waitcnt lgkmcnt(0)
    s_mov_b64 s[52:53], s[38:39]
    s_mov_b64 s[56:57], s[40:41]
    s_mov_b64 s[60:61], s[42:43]
    s_mov_b64 s[64:65], s[44:45]
    s_mov_b64 s[68:69], s[46:47]
    s_mov_b64 s[72:73], s[84:85]
    s_mov_b64 s[4:5], s[88:89]
    s_mov_b64 s[8:9], s[90:91]
    s_mov_b64 s[76:77], s[96:97]
    s_mov_b64 s[24:25], s[36:37]
    s_mov_b64 s[16:17], s[98:99]
    s_mov_b64 s[20:21], s[92:93]
    s_mov_b64 s[28:29], s[94:95]
    s_cmp_lg_u32 s83, 0
    s_cbranch_scc1 L_notok
    s_memrealtime s[100:101]
    s_waitcnt lgkmcnt(0)
    s_or_b32 s100, s100, 1
    v_mov_b32 v248, s100
    v_mov_b32 v249, s101
    buffer_store_dwordx2 v[248:249], off, s[76:79], 0 sc1
L_notok:
    v_lshlrev_b32 v176, 2, v243
    s_lshl_b32 s80, s83, 8
    s_lshl_b32 s81, s83, 1
    v_mov_b32 v178, 0
    buffer_load_ushort v164, v178, s[68:71], s81 offen
    buffer_load_dword v160, v176, s[52:55], s80 offen
    buffer_load_dword v161, v176, s[56:59], s80 offen
    buffer_load_dword v162, v176, s[60:63], s80 offen
    buffer_load_dword v163, v176, s[64:67], s80 offen
    buffer_load_ushort v165, v178, s[72:75], s81 offen
    s_and_b32 s33, s2, 7
    s_bfe_u32 s34, s2, 0x30003
    s_lshr_b32 s35, s2, 6
    s_lshl_b32 s36, s34, 2
    s_add_u32 s36, s36, s32
    s_lshl_b32 s37, s32, 11
    s_lshl_b32 s38, s32, 10
    s_and_b32 s58, s32, 1
    s_sub_u32 s8, s8, 1024
    s_subb_u32 s9, s9, 0
    v_lshrrev_b32 v244, 3, v243
    v_and_b32 v245, 3, v244
    v_xor_b32 v245, s58, v245
    v_lshlrev_b32 v245, 1, v245
    v_and_b32 v246, 7, v243
    v_xor_b32 v245, v245, v246
    v_mul_u32_u24 v244, 9216, v244
    v_lshl_add_u32 v244, v245, 4, v244
    s_mul_i32 s59, s32, 73728
    s_mul_i32 s60, s33, 1152
    s_lshl_b32 s61, s35, 7
    s_add_u32 s59, s59, s60
    s_add_u32 s59, s59, s61
    v_add_u32 v237, s59, v244
    v_add_u32 v238, 640, v237
    v_lshrrev_b32 v244, 1, v243
    v_and_b32 v245, 19, v244
    v_bfe_u32 v246, v244, 2, 1
    v_lshl_add_u32 v245, v246, 3, v245
    v_bfe_u32 v246, v244, 3, 1
    v_lshl_add_u32 v245, v246, 2, v245
    v_mul_u32_u24 v245, 9216, v245
    v_and_b32 v246, 1, v243
    v_lshl_add_u32 v245, v246, 4, v245
    s_lshr_b32 s59, s32, 1
    s_mul_i32 s59, s59, 294912
    s_add_u32 s59, s59, s60
    s_lshl_b32 s61, s35, 5
    s_add_u32 s59, s59, s61
    s_add_u32 s59, s59, 512
    v_add_u32 v239, s59, v245
    s_mov_b32 s40, 0
    s_mov_b32 s41, 294912
    s_mov_b32 s42, 589824
    s_mov_b32 s43, 884736
    s_mov_b32 s44, 1179648
    s_mov_b32 s45, 1474560
    s_mov_b32 s46, 1769472
    s_mov_b32 s47, 2064384
    s_mov_b32 s48, 2359296
    s_mov_b32 s49, 2654208
    s_mov_b32 s50, 2949120
    s_mov_b32 s51, 3244032
    s_mov_b32 s52, 3538944
    s_mov_b32 s53, 3833856
    s_mov_b32 s54, 4128768
    s_mov_b32 s55, 4423680
    s_mov_b32 s56, 4718592
    s_mov_b32 s57, 5013504
    s_lshr_b32 s80, s2, 3
    s_mul_i32 s80, s80, 3
    s_add_u32 s80, s80, s32
    s_sub_u32 s80, s80, 1
    s_mul_i32 s82, s80, 18432
    s_mul_i32 s80, s80, 55296
    s_and_b32 s81, s2, 7
    s_mul_i32 s81, s81, 1152
    s_add_u32 s80, s80, s81
    s_add_u32 s82, s82, s81
    s_sub_u32 s80, s80, 73216
    v_cmp_gt_u32 vcc, 8, v243
    v_min_u32 v244, 13, v243
    v_mul_u32_u24 v244, 9216, v244
    v_add_u32 v244, s80, v244
    v_lshrrev_b32 v245, 2, v243
    v_mul_u32_u24 v245, 9216, v245
    v_and_b32 v246, 3, v243
    v_lshlrev_b32 v246, 7, v246
    v_add3_u32 v245, v245, v246, s82
    v_cndmask_b32 v2, v244, v245, vcc
    buffer_load_dword v4, v2, s[4:7], 0 offen
    buffer_load_dword v5, v2, s[8:11], 0 offen offset:1024
    s_mul_i32 s39, s36, 73728
    v_lshlrev_b32 v240, 4, v243
    v_add_u32 v241, 4096, v240
    v_lshrrev_b32 v244, 4, v243
    v_bfe_u32 v245, v243, 2, 2
    v_and_b32 v246, 3, v243
    v_lshlrev_b32 v246, 3, v246
    v_lshl_add_u32 v247, v245, 7, v246
    v_lshl_add_u32 v247, v244, 11, v247
    v_lshl_add_u32 v236, v245, 5, v246
    v_and_b32 v246, 1, v244
    v_lshl_add_u32 v236, v246, 7, v236
    v_xor_b32 v245, v245, v246
    v_lshrrev_b32 v244, 1, v244
    v_lshl_add_u32 v236, v244, 9, v236
    v_add_u32 v236, 57344, v236
    v_xor_b32 v244, 0, v245
    v_lshl_add_u32 v232, v244, 5, v247
    v_xor_b32 v244, 1, v245
    v_lshl_add_u32 v233, v244, 5, v247
    v_xor_b32 v244, 2, v245
    v_lshl_add_u32 v234, v244, 5, v247
    v_xor_b32 v244, 3, v245
    v_lshl_add_u32 v235, v244, 5, v247
    s_mul_i32 s100, s33, 2359296
    s_add_u32 s100, s100, s39
    s_add_u32 s100, s100, 16777216
    s_mul_i32 s101, s33, 663552
    s_xor_b32 s67, s35, 0
    s_lshl_b32 s58, s67, 13
    s_add_u32 s58, s58, s100
    s_mul_i32 s67, s67, 73728
    s_add_u32 s67, s67, s101
    s_xor_b32 s68, s35, 1
    s_lshl_b32 s59, s68, 13
    s_add_u32 s59, s59, s100
    s_mul_i32 s68, s68, 73728
    s_add_u32 s68, s68, s101
    s_xor_b32 s69, s35, 2
    s_lshl_b32 s60, s69, 13
    s_add_u32 s60, s60, s100
    s_mul_i32 s69, s69, 73728
    s_add_u32 s69, s69, s101
    s_xor_b32 s70, s35, 3
    s_lshl_b32 s61, s70, 13
    s_add_u32 s61, s61, s100
    s_mul_i32 s70, s70, 73728
    s_add_u32 s70, s70, s101
    s_mov_b32 s71, 4
    s_lshl_b32 s62, s71, 13
    s_add_u32 s62, s62, s100
    s_mul_i32 s71, s71, 73728
    s_add_u32 s71, s71, s101
    s_xor_b32 s72, s35, 3
    s_add_u32 s72, s72, 5
    s_lshl_b32 s63, s72, 13
    s_add_u32 s63, s63, s100
    s_mul_i32 s72, s72, 73728
    s_add_u32 s72, s72, s101
    s_xor_b32 s73, s35, 2
    s_add_u32 s73, s73, 5
    s_lshl_b32 s64, s73, 13
    s_add_u32 s64, s64, s100
    s_mul_i32 s73, s73, 73728
    s_add_u32 s73, s73, s101
    s_xor_b32 s74, s35, 1
    s_add_u32 s74, s74, 5
    s_lshl_b32 s65, s74, 13
    s_add_u32 s65, s65, s100
    s_mul_i32 s74, s74, 73728
    s_add_u32 s74, s74, s101
    s_xor_b32 s75, s35, 0
    s_add_u32 s75, s75, 5
    s_lshl_b32 s66, s75, 13
    s_add_u32 s66, s66, s100
    s_mul_i32 s75, s75, 73728
    s_add_u32 s75, s75, s101
    s_lshr_b32 s100, s35, 1
    s_lshl_b32 s100, s100, 12
    s_and_b32 s101, s35, 1
    s_lshl_b32 s101, s101, 9
    s_add_u32 s100, s100, s101
    v_lshrrev_b32 v244, 5, v243
    v_lshlrev_b32 v244, 9, v244
    v_add3_u32 v242, v240, v244, s100
    s_lshl_b32 s101, s34, 2
    s_add_u32 s101, s101, s35
    s_lshl_b32 s101, s101, 19
    s_add_u32 s101, s101, 35651584
    s_lshl_b32 s100, s33, 16
    s_add_u32 s100, s100, s37
    s_add_u32 s100, s100, s101
    s_lshl_b32 m0, s32, 17
    s_add_u32 s101, s101, m0
    s_lshl_b32 m0, s33, 10
    s_add_u32 s101, s101, m0
    s_and_b32 m0, s100, 65536
    s_add_u32 s101, s101, m0
    s_lshr_b32 m0, m0, 5
    s_add_u32 s39, s39, m0
    v_lshrrev_b32 v252, 3, v243
    v_min_u32 v252, 1, v252
    v_lshl_add_u32 v252, v252, 30, v240
    v_and_b32 v253, 7, v243
    v_lshlrev_b32 v253, 7, v253
    v_lshrrev_b32 v244, 4, v243
    v_lshlrev_b32 v244, 1, v244
    v_and_b32 v245, 7, v243
    v_xor_b32 v244, v244, v245
    s_lshr_b32 m0, s33, 2
    s_lshl1_add_u32 m0, s35, m0
    s_lshl_b32 m0, m0, 7
    v_lshl_add_u32 v244, v244, 4, m0
    v_lshrrev_b32 v245, 3, v243
    s_lshl_b32 m0, s32, 3
    v_add_u32 v246, m0, v245
    v_mul_u32_u24 v254, 1152, v246
    v_add_u32 v254, v254, v244
    v_add_u32 v255, 36864, v254
    s_mul_i32 vcc_lo, s32, 21760
    s_add_u32 vcc_hi, vcc_lo, 93440
    s_add_u32 vcc_lo, vcc_lo, 84736
    s_cmp_ge_u32 s83, 576
    s_cbranch_scc1 L_pref
    s_waitcnt vmcnt(2)
    v_lshl_add_u32 v166, v243, 3, vcc_lo
    v_and_b32 v176, 15, v243
    v_lshrrev_b32 v178, 4, v243
    v_mul_u32_u24 v168, 544, v176
    v_lshl_add_u32 v168, v178, 4, v168
    v_add_u32 v168, vcc_lo, v168
    v_lshlrev_b32 v176, 4, v176
    v_lshl_add_u32 v172, v178, 8, v176
    v_sub_u32 v172, 1008, v172
    v_lshrrev_b32 v180, 1, v178
    v_lshl_add_u32 v176, v180, 8, v176
    v_and_b32 v180, 1, v178
    v_lshl_add_u32 v176, v180, 3, v176
    v_sub_u32 v170, 3576, v176
    v_add_u32 v170, vcc_hi, v170
    v_add_u32 v172, vcc_hi, v172
    s_mov_b32 s81, 0xffff0000
    s_mov_b32 s82, 0x3fb8aa3b
    v_mov_b32 v88, 0
    v_mov_b32 v89, 0
    v_lshlrev_b32 v176, 3, v243
    v_add_u32 v176, 4096, v176
    v_add_u32 v176, vcc_hi, v176
    ds_write_b64 v176, v[88:89] offset:0
    v_lshlrev_b32 v164, 16, v164
    v_mul_f32 v178, s82, v164
    v_fma_f32 v180, v164, s82, -v178
    v_exp_f32 v178, v178
    v_fmamk_f32 v180, v164, 0x32a57060, v180
    v_mul_f32 v180, 0x3f317218, v180
    v_fma_f32 v178, v178, v180, v178
    v_cvt_pk_bf16_f32 v164, v178, v178
    v_lshlrev_b32 v164, 16, v164
    v_lshlrev_b32 v152, 16, v160
    v_and_b32 v153, s81, v160
    v_lshlrev_b32 v154, 16, v161
    v_and_b32 v155, s81, v161
    v_mul_f32 v178, s82, v152
    v_fma_f32 v180, v152, s82, -v178
    v_exp_f32 v178, v178
    v_fmamk_f32 v180, v152, 0x32a57060, v180
    v_mul_f32 v180, 0x3f317218, v180
    v_fma_f32 v178, v178, v180, v178
    v_cvt_pk_bf16_f32 v152, v178, v178
    v_lshlrev_b32 v152, 16, v152
    v_mul_f32 v152, v152, v164
    v_mul_f32 v154, v154, v164
    v_mul_f32 v178, s82, v153
    v_fma_f32 v180, v153, s82, -v178
    v_exp_f32 v178, v178
    v_fmamk_f32 v180, v153, 0x32a57060, v180
    v_mul_f32 v180, 0x3f317218, v180
    v_fma_f32 v178, v178, v180, v178
    v_cvt_pk_bf16_f32 v153, v178, v178
    v_lshlrev_b32 v153, 16, v153
    v_mul_f32 v153, v153, v164
    v_mul_f32 v155, v155, v164
    v_mul_f32 v156, 0xc138aa3b, v152
    v_mul_f32 v157, 0x3fa2f983, v154
    v_exp_f32 v156, v156
    v_fract_f32 v157, v157
    v_cos_f32 v136, v157
    v_sin_f32 v137, v157
    s_nop 0
    v_pk_mul_f32 v[136:137], v[136:137], v[156:157] op_sel_hi:[1,0]
    v_mul_f32 v158, 0xc138aa3b, v153
    v_mul_f32 v159, 0x3fa2f983, v155
    v_exp_f32 v158, v158
    v_fract_f32 v159, v159
    v_cos_f32 v138, v159
    v_sin_f32 v139, v159
    s_nop 0
    v_pk_mul_f32 v[138:139], v[138:139], v[158:159] op_sel_hi:[1,0]
    v_mul_f32 v156, 0xbfb8aa3b, v152
    v_mul_f32 v157, 0x3e22f983, v154
    v_exp_f32 v156, v156
    v_fract_f32 v157, v157
    v_cos_f32 v132, v157
    v_sin_f32 v133, v157
    s_nop 0
    v_pk_mul_f32 v[132:133], v[132:133], v[156:157] op_sel_hi:[1,0]
    v_mul_f32 v158, 0xbfb8aa3b, v153
    v_mul_f32 v159, 0x3e22f983, v155
    v_exp_f32 v158, v158
    v_fract_f32 v159, v159
    v_cos_f32 v134, v159
    v_sin_f32 v135, v159
    s_nop 0
    v_pk_mul_f32 v[134:135], v[134:135], v[158:159] op_sel_hi:[1,0]
    v_mul_f32 v156, 0xc338aa3b, v152
    v_mul_f32 v157, 0x41a2f983, v154
    v_exp_f32 v156, v156
    v_fract_f32 v157, v157
    v_cos_f32 v144, v157
    v_sin_f32 v145, v157
    s_nop 0
    v_pk_mul_f32 v[144:145], v[144:145], v[156:157] op_sel_hi:[1,0]
    v_mul_f32 v158, 0xc338aa3b, v153
    v_mul_f32 v159, 0x41a2f983, v155
    v_exp_f32 v158, v158
    v_fract_f32 v159, v159
    v_cos_f32 v146, v159
    v_sin_f32 v147, v159
    s_nop 0
    v_pk_mul_f32 v[146:147], v[146:147], v[158:159] op_sel_hi:[1,0]
    v_mov_b32 v140, v136
    v_sub_f32 v141, 0, v137
    v_mov_b32 v142, v138
    v_sub_f32 v143, 0, v139
    v_add_f32 v164, v164, v164
    v_lshlrev_b32 v96, 16, v162
    v_and_b32 v98, s81, v162
    v_lshlrev_b32 v97, 16, v163
    v_and_b32 v99, s81, v163
    v_mul_f32 v96, v96, v164
    v_mul_f32 v97, v97, v164
    v_mul_f32 v98, v98, v164
    v_mul_f32 v99, v99, v164
    v_lshlrev_b32 v174, 16, v165
    v_cmp_eq_u32 vcc, 0, v243
    v_and_b32 v176, 1, v243
    s_nop 0
    v_cndmask_b32 v174, 0, v174, vcc
    v_mov_b32 v94, 0x00003f80
    v_mov_b32 v95, 0x00003f80
    ds_write_b64 v166, v[94:95]
    v_cvt_pk_bf16_f32 v88, v140, v141
    v_cvt_pk_bf16_f32 v89, v142, v143
    ds_write_b64 v166, v[88:89] offset:544
    v_pk_mul_f32 v[152:153], v[140:141], v[140:141] op_sel_hi:[0,1]
    v_pk_mul_f32 v[154:155], v[142:143], v[142:143] op_sel_hi:[0,1]
    v_pk_fma_f32 v[148:149], v[140:141], v[140:141], v[152:153] op_sel:[1,1,0] op_sel_hi:[1,0,1] neg_lo:[0,1,0]
    v_pk_fma_f32 v[150:151], v[142:143], v[142:143], v[154:155] op_sel:[1,1,0] op_sel_hi:[1,0,1] neg_lo:[0,1,0]
    v_cvt_pk_bf16_f32 v90, v148, v149
    v_cvt_pk_bf16_f32 v91, v150, v151
    ds_write_b64 v166, v[90:91] offset:1088
    v_pk_mul_f32 v[152:153], v[148:149], v[140:141] op_sel_hi:[0,1]
    v_pk_mul_f32 v[154:155], v[150:151], v[142:143] op_sel_hi:[0,1]
    v_pk_fma_f32 v[148:149], v[148:149], v[140:141], v[152:153] op_sel:[1,1,0] op_sel_hi:[1,0,1] neg_lo:[0,1,0]
    v_pk_fma_f32 v[150:151], v[150:151], v[142:143], v[154:155] op_sel:[1,1,0] op_sel_hi:[1,0,1] neg_lo:[0,1,0]
    v_cvt_pk_bf16_f32 v92, v148, v149
    v_cvt_pk_bf16_f32 v93, v150, v151
    ds_write_b64 v166, v[92:93] offset:1632
    v_pk_mul_f32 v[152:153], v[148:149], v[140:141] op_sel_hi:[0,1]
    v_pk_mul_f32 v[154:155], v[150:151], v[142:143] op_sel_hi:[0,1]
    v_pk_fma_f32 v[148:149], v[148:149], v[140:141], v[152:153] op_sel:[1,1,0] op_sel_hi:[1,0,1] neg_lo:[0,1,0]
    v_pk_fma_f32 v[150:151], v[150:151], v[142:143], v[154:155] op_sel:[1,1,0] op_sel_hi:[1,0,1] neg_lo:[0,1,0]
    v_cvt_pk_bf16_f32 v94, v148, v149
    v_cvt_pk_bf16_f32 v95, v150, v151
    ds_write_b64 v166, v[94:95] offset:2176
    v_pk_mul_f32 v[152:153], v[148:149], v[140:141] op_sel_hi:[0,1]
    v_pk_mul_f32 v[154:155], v[150:151], v[142:143] op_sel_hi:[0,1]
    v_pk_fma_f32 v[148:149], v[148:149], v[140:141], v[152:153] op_sel:[1,1,0] op_sel_hi:[1,0,1] neg_lo:[0,1,0]
    v_pk_fma_f32 v[150:151], v[150:151], v[142:143], v[154:155] op_sel:[1,1,0] op_sel_hi:[1,0,1] neg_lo:[0,1,0]
    v_cvt_pk_bf16_f32 v88, v148, v149
    v_cvt_pk_bf16_f32 v89, v150, v151
    ds_write_b64 v166, v[88:89] offset:2720
    v_pk_mul_f32 v[152:153], v[148:149], v[140:141] op_sel_hi:[0,1]
    v_pk_mul_f32 v[154:155], v[150:151], v[142:143] op_sel_hi:[0,1]
    v_pk_fma_f32 v[148:149], v[148:149], v[140:141], v[152:153] op_sel:[1,1,0] op_sel_hi:[1,0,1] neg_lo:[0,1,0]
    v_pk_fma_f32 v[150:151], v[150:151], v[142:143], v[154:155] op_sel:[1,1,0] op_sel_hi:[1,0,1] neg_lo:[0,1,0]
    v_cvt_pk_bf16_f32 v90, v148, v149
    v_cvt_pk_bf16_f32 v91, v150, v151
    ds_write_b64 v166, v[90:91] offset:3264
    v_pk_mul_f32 v[152:153], v[148:149], v[140:141] op_sel_hi:[0,1]
    v_pk_mul_f32 v[154:155], v[150:151], v[142:143] op_sel_hi:[0,1]
    v_pk_fma_f32 v[148:149], v[148:149], v[140:141], v[152:153] op_sel:[1,1,0] op_sel_hi:[1,0,1] neg_lo:[0,1,0]
    v_pk_fma_f32 v[150:151], v[150:151], v[142:143], v[154:155] op_sel:[1,1,0] op_sel_hi:[1,0,1] neg_lo:[0,1,0]
    v_cvt_pk_bf16_f32 v92, v148, v149
    v_cvt_pk_bf16_f32 v93, v150, v151
    ds_write_b64 v166, v[92:93] offset:3808
    v_pk_mul_f32 v[152:153], v[148:149], v[140:141] op_sel_hi:[0,1]
    v_pk_mul_f32 v[154:155], v[150:151], v[142:143] op_sel_hi:[0,1]
    v_pk_fma_f32 v[148:149], v[148:149], v[140:141], v[152:153] op_sel:[1,1,0] op_sel_hi:[1,0,1] neg_lo:[0,1,0]
    v_pk_fma_f32 v[150:151], v[150:151], v[142:143], v[154:155] op_sel:[1,1,0] op_sel_hi:[1,0,1] neg_lo:[0,1,0]
    v_cvt_pk_bf16_f32 v94, v148, v149
    v_cvt_pk_bf16_f32 v95, v150, v151
    ds_write_b64 v166, v[94:95] offset:4352
    v_pk_mul_f32 v[152:153], v[148:149], v[140:141] op_sel_hi:[0,1]
    v_pk_mul_f32 v[154:155], v[150:151], v[142:143] op_sel_hi:[0,1]
    v_pk_fma_f32 v[148:149], v[148:149], v[140:141], v[152:153] op_sel:[1,1,0] op_sel_hi:[1,0,1] neg_lo:[0,1,0]
    v_pk_fma_f32 v[150:151], v[150:151], v[142:143], v[154:155] op_sel:[1,1,0] op_sel_hi:[1,0,1] neg_lo:[0,1,0]
    v_cvt_pk_bf16_f32 v88, v148, v149
    v_cvt_pk_bf16_f32 v89, v150, v151
    ds_write_b64 v166, v[88:89] offset:4896
    v_pk_mul_f32 v[152:153], v[148:149], v[140:141] op_sel_hi:[0,1]
    v_pk_mul_f32 v[154:155], v[150:151], v[142:143] op_sel_hi:[0,1]
    v_pk_fma_f32 v[148:149], v[148:149], v[140:141], v[152:153] op_sel:[1,1,0] op_sel_hi:[1,0,1] neg_lo:[0,1,0]
    v_pk_fma_f32 v[150:151], v[150:151], v[142:143], v[154:155] op_sel:[1,1,0] op_sel_hi:[1,0,1] neg_lo:[0,1,0]
    v_cvt_pk_bf16_f32 v90, v148, v149
    v_cvt_pk_bf16_f32 v91, v150, v151
    ds_write_b64 v166, v[90:91] offset:5440
    v_pk_mul_f32 v[152:153], v[148:149], v[140:141] op_sel_hi:[0,1]
    v_pk_mul_f32 v[154:155], v[150:151], v[142:143] op_sel_hi:[0,1]
    v_pk_fma_f32 v[148:149], v[148:149], v[140:141], v[152:153] op_sel:[1,1,0] op_sel_hi:[1,0,1] neg_lo:[0,1,0]
    v_pk_fma_f32 v[150:151], v[150:151], v[142:143], v[154:155] op_sel:[1,1,0] op_sel_hi:[1,0,1] neg_lo:[0,1,0]
    v_cvt_pk_bf16_f32 v92, v148, v149
    v_cvt_pk_bf16_f32 v93, v150, v151
    ds_write_b64 v166, v[92:93] offset:5984
    v_pk_mul_f32 v[152:153], v[148:149], v[140:141] op_sel_hi:[0,1]
    v_pk_mul_f32 v[154:155], v[150:151], v[142:143] op_sel_hi:[0,1]
    v_pk_fma_f32 v[148:149], v[148:149], v[140:141], v[152:153] op_sel:[1,1,0] op_sel_hi:[1,0,1] neg_lo:[0,1,0]
    v_pk_fma_f32 v[150:151], v[150:151], v[142:143], v[154:155] op_sel:[1,1,0] op_sel_hi:[1,0,1] neg_lo:[0,1,0]
    v_cvt_pk_bf16_f32 v94, v148, v149
    v_cvt_pk_bf16_f32 v95, v150, v151
    ds_write_b64 v166, v[94:95] offset:6528
    v_pk_mul_f32 v[152:153], v[148:149], v[140:141] op_sel_hi:[0,1]
    v_pk_mul_f32 v[154:155], v[150:151], v[142:143] op_sel_hi:[0,1]
    v_pk_fma_f32 v[148:149], v[148:149], v[140:141], v[152:153] op_sel:[1,1,0] op_sel_hi:[1,0,1] neg_lo:[0,1,0]
    v_pk_fma_f32 v[150:151], v[150:151], v[142:143], v[154:155] op_sel:[1,1,0] op_sel_hi:[1,0,1] neg_lo:[0,1,0]
    v_cvt_pk_bf16_f32 v88, v148, v149
    v_cvt_pk_bf16_f32 v89, v150, v151
    ds_write_b64 v166, v[88:89] offset:7072
    v_pk_mul_f32 v[152:153], v[148:149], v[140:141] op_sel_hi:[0,1]
    v_pk_mul_f32 v[154:155], v[150:151], v[142:143] op_sel_hi:[0,1]
    v_pk_fma_f32 v[148:149], v[148:149], v[140:141], v[152:153] op_sel:[1,1,0] op_sel_hi:[1,0,1] neg_lo:[0,1,0]
    v_pk_fma_f32 v[150:151], v[150:151], v[142:143], v[154:155] op_sel:[1,1,0] op_sel_hi:[1,0,1] neg_lo:[0,1,0]
    v_cvt_pk_bf16_f32 v90, v148, v149
    v_cvt_pk_bf16_f32 v91, v150, v151
    ds_write_b64 v166, v[90:91] offset:7616
    v_pk_mul_f32 v[152:153], v[148:149], v[140:141] op_sel_hi:[0,1]
    v_pk_mul_f32 v[154:155], v[150:151], v[142:143] op_sel_hi:[0,1]
    v_pk_fma_f32 v[148:149], v[148:149], v[140:141], v[152:153] op_sel:[1,1,0] op_sel_hi:[1,0,1] neg_lo:[0,1,0]
    v_pk_fma_f32 v[150:151], v[150:151], v[142:143], v[154:155] op_sel:[1,1,0] op_sel_hi:[1,0,1] neg_lo:[0,1,0]
    v_cvt_pk_bf16_f32 v92, v148, v149
    v_cvt_pk_bf16_f32 v93, v150, v151
    ds_write_b64 v166, v[92:93] offset:8160
    ds_read_b128 v[8:11], v168 offset:0
    ds_read_b128 v[12:15], v168 offset:64
    ds_read_b128 v[16:19], v168 offset:128
    ds_read_b128 v[20:23], v168 offset:192
    ds_read_b128 v[24:27], v168 offset:256
    ds_read_b128 v[28:31], v168 offset:320
    ds_read_b128 v[32:35], v168 offset:384
    ds_read_b128 v[36:39], v168 offset:448
    v_cvt_pk_bf16_f32 v94, v96, v97
    v_cvt_pk_bf16_f32 v95, v98, v99
    ds_write_b64 v166, v[94:95] offset:0
    v_pk_mul_f32 v[152:153], v[96:97], v[132:133] op_sel_hi:[0,1]
    v_pk_mul_f32 v[154:155], v[98:99], v[134:135] op_sel_hi:[0,1]
    v_pk_fma_f32 v[100:101], v[96:97], v[132:133], v[152:153] op_sel:[1,1,0] op_sel_hi:[1,0,1] neg_lo:[0,1,0]
    v_pk_fma_f32 v[102:103], v[98:99], v[134:135], v[154:155] op_sel:[1,1,0] op_sel_hi:[1,0,1] neg_lo:[0,1,0]
    v_cvt_pk_bf16_f32 v88, v100, v101
    v_cvt_pk_bf16_f32 v89, v102, v103
    ds_write_b64 v166, v[88:89] offset:544
    v_pk_mul_f32 v[152:153], v[100:101], v[132:133] op_sel_hi:[0,1]
    v_pk_mul_f32 v[154:155], v[102:103], v[134:135] op_sel_hi:[0,1]
    v_pk_fma_f32 v[104:105], v[100:101], v[132:133], v[152:153] op_sel:[1,1,0] op_sel_hi:[1,0,1] neg_lo:[0,1,0]
    v_pk_fma_f32 v[106:107], v[102:103], v[134:135], v[154:155] op_sel:[1,1,0] op_sel_hi:[1,0,1] neg_lo:[0,1,0]
    v_cvt_pk_bf16_f32 v90, v104, v105
    v_cvt_pk_bf16_f32 v91, v106, v107
    ds_write_b64 v166, v[90:91] offset:1088
    v_pk_mul_f32 v[152:153], v[104:105], v[132:133] op_sel_hi:[0,1]
    v_pk_mul_f32 v[154:155], v[106:107], v[134:135] op_sel_hi:[0,1]
    v_pk_fma_f32 v[108:109], v[104:105], v[132:133], v[152:153] op_sel:[1,1,0] op_sel_hi:[1,0,1] neg_lo:[0,1,0]
    v_pk_fma_f32 v[110:111], v[106:107], v[134:135], v[154:155] op_sel:[1,1,0] op_sel_hi:[1,0,1] neg_lo:[0,1,0]
    v_cvt_pk_bf16_f32 v92, v108, v109
    v_cvt_pk_bf16_f32 v93, v110, v111
    ds_write_b64 v166, v[92:93] offset:1632
    v_pk_mul_f32 v[152:153], v[108:109], v[132:133] op_sel_hi:[0,1]
    v_pk_mul_f32 v[154:155], v[110:111], v[134:135] op_sel_hi:[0,1]
    v_pk_fma_f32 v[112:113], v[108:109], v[132:133], v[152:153] op_sel:[1,1,0] op_sel_hi:[1,0,1] neg_lo:[0,1,0]
    v_pk_fma_f32 v[114:115], v[110:111], v[134:135], v[154:155] op_sel:[1,1,0] op_sel_hi:[1,0,1] neg_lo:[0,1,0]
    v_cvt_pk_bf16_f32 v94, v112, v113
    v_cvt_pk_bf16_f32 v95, v114, v115
    ds_write_b64 v166, v[94:95] offset:2176
    v_pk_mul_f32 v[152:153], v[112:113], v[132:133] op_sel_hi:[0,1]
    v_pk_mul_f32 v[154:155], v[114:115], v[134:135] op_sel_hi:[0,1]
    v_pk_fma_f32 v[116:117], v[112:113], v[132:133], v[152:153] op_sel:[1,1,0] op_sel_hi:[1,0,1] neg_lo:[0,1,0]
    v_pk_fma_f32 v[118:119], v[114:115], v[134:135], v[154:155] op_sel:[1,1,0] op_sel_hi:[1,0,1] neg_lo:[0,1,0]
    v_cvt_pk_bf16_f32 v88, v116, v117
    v_cvt_pk_bf16_f32 v89, v118, v119
    ds_write_b64 v166, v[88:89] offset:2720
    v_pk_mul_f32 v[152:153], v[116:117], v[132:133] op_sel_hi:[0,1]
    v_pk_mul_f32 v[154:155], v[118:119], v[134:135] op_sel_hi:[0,1]
    v_pk_fma_f32 v[120:121], v[116:117], v[132:133], v[152:153] op_sel:[1,1,0] op_sel_hi:[1,0,1] neg_lo:[0,1,0]
    v_pk_fma_f32 v[122:123], v[118:119], v[134:135], v[154:155] op_sel:[1,1,0] op_sel_hi:[1,0,1] neg_lo:[0,1,0]
    v_cvt_pk_bf16_f32 v90, v120, v121
    v_cvt_pk_bf16_f32 v91, v122, v123
    ds_write_b64 v166, v[90:91] offset:3264
    v_pk_mul_f32 v[152:153], v[120:121], v[132:133] op_sel_hi:[0,1]
    v_pk_mul_f32 v[154:155], v[122:123], v[134:135] op_sel_hi:[0,1]
    v_pk_fma_f32 v[124:125], v[120:121], v[132:133], v[152:153] op_sel:[1,1,0] op_sel_hi:[1,0,1] neg_lo:[0,1,0]
    v_pk_fma_f32 v[126:127], v[122:123], v[134:135], v[154:155] op_sel:[1,1,0] op_sel_hi:[1,0,1] neg_lo:[0,1,0]
    v_cvt_pk_bf16_f32 v92, v124, v125
    v_cvt_pk_bf16_f32 v93, v126, v127
    ds_write_b64 v166, v[92:93] offset:3808
    v_pk_mul_f32 v[152:153], v[96:97], v[136:137] op_sel_hi:[0,1]
    v_pk_mul_f32 v[154:155], v[98:99], v[138:139] op_sel_hi:[0,1]
    v_pk_fma_f32 v[128:129], v[96:97], v[136:137], v[152:153] op_sel:[1,1,0] op_sel_hi:[1,0,1] neg_lo:[0,1,0]
    v_pk_fma_f32 v[130:131], v[98:99], v[138:139], v[154:155] op_sel:[1,1,0] op_sel_hi:[1,0,1] neg_lo:[0,1,0]
    v_pk_mul_f32 v[152:153], v[96:97], v[144:145] op_sel_hi:[0,1]
    v_pk_mul_f32 v[154:155], v[98:99], v[146:147] op_sel_hi:[0,1]
    v_pk_fma_f32 v[96:97], v[96:97], v[144:145], v[152:153] op_sel:[1,1,0] op_sel_hi:[1,0,1] neg_lo:[0,1,0]
    v_pk_fma_f32 v[98:99], v[98:99], v[146:147], v[154:155] op_sel:[1,1,0] op_sel_hi:[1,0,1] neg_lo:[0,1,0]
    v_cvt_pk_bf16_f32 v94, v96, v97
    v_cvt_pk_bf16_f32 v95, v98, v99
    ds_write_b64 v166, v[94:95] offset:4352
    v_pk_mul_f32 v[152:153], v[100:101], v[144:145] op_sel_hi:[0,1]
    v_pk_mul_f32 v[154:155], v[102:103], v[146:147] op_sel_hi:[0,1]
    v_pk_fma_f32 v[100:101], v[100:101], v[144:145], v[152:153] op_sel:[1,1,0] op_sel_hi:[1,0,1] neg_lo:[0,1,0]
    v_pk_fma_f32 v[102:103], v[102:103], v[146:147], v[154:155] op_sel:[1,1,0] op_sel_hi:[1,0,1] neg_lo:[0,1,0]
    v_cvt_pk_bf16_f32 v88, v100, v101
    v_cvt_pk_bf16_f32 v89, v102, v103
    ds_write_b64 v166, v[88:89] offset:4896
    v_pk_mul_f32 v[152:153], v[104:105], v[144:145] op_sel_hi:[0,1]
    v_pk_mul_f32 v[154:155], v[106:107], v[146:147] op_sel_hi:[0,1]
    v_pk_fma_f32 v[104:105], v[104:105], v[144:145], v[152:153] op_sel:[1,1,0] op_sel_hi:[1,0,1] neg_lo:[0,1,0]
    v_pk_fma_f32 v[106:107], v[106:107], v[146:147], v[154:155] op_sel:[1,1,0] op_sel_hi:[1,0,1] neg_lo:[0,1,0]
    v_cvt_pk_bf16_f32 v90, v104, v105
    v_cvt_pk_bf16_f32 v91, v106, v107
    ds_write_b64 v166, v[90:91] offset:5440
    v_pk_mul_f32 v[152:153], v[108:109], v[144:145] op_sel_hi:[0,1]
    v_pk_mul_f32 v[154:155], v[110:111], v[146:147] op_sel_hi:[0,1]
    v_pk_fma_f32 v[108:109], v[108:109], v[144:145], v[152:153] op_sel:[1,1,0] op_sel_hi:[1,0,1] neg_lo:[0,1,0]
    v_pk_fma_f32 v[110:111], v[110:111], v[146:147], v[154:155] op_sel:[1,1,0] op_sel_hi:[1,0,1] neg_lo:[0,1,0]
    v_cvt_pk_bf16_f32 v92, v108, v109
    v_cvt_pk_bf16_f32 v93, v110, v111
    ds_write_b64 v166, v[92:93] offset:5984
    v_pk_mul_f32 v[152:153], v[112:113], v[144:145] op_sel_hi:[0,1]
    v_pk_mul_f32 v[154:155], v[114:115], v[146:147] op_sel_hi:[0,1]
    v_pk_fma_f32 v[112:113], v[112:113], v[144:145], v[152:153] op_sel:[1,1,0] op_sel_hi:[1,0,1] neg_lo:[0,1,0]
    v_pk_fma_f32 v[114:115], v[114:115], v[146:147], v[154:155] op_sel:[1,1,0] op_sel_hi:[1,0,1] neg_lo:[0,1,0]
    v_cvt_pk_bf16_f32 v94, v112, v113
    v_cvt_pk_bf16_f32 v95, v114, v115
    ds_write_b64 v166, v[94:95] offset:6528
    v_pk_mul_f32 v[152:153], v[116:117], v[144:145] op_sel_hi:[0,1]
    v_pk_mul_f32 v[154:155], v[118:119], v[146:147] op_sel_hi:[0,1]
    v_pk_fma_f32 v[116:117], v[116:117], v[144:145], v[152:153] op_sel:[1,1,0] op_sel_hi:[1,0,1] neg_lo:[0,1,0]
    v_pk_fma_f32 v[118:119], v[118:119], v[146:147], v[154:155] op_sel:[1,1,0] op_sel_hi:[1,0,1] neg_lo:[0,1,0]
    v_cvt_pk_bf16_f32 v88, v116, v117
    v_cvt_pk_bf16_f32 v89, v118, v119
    ds_write_b64 v166, v[88:89] offset:7072
    v_pk_mul_f32 v[152:153], v[120:121], v[144:145] op_sel_hi:[0,1]
    v_pk_mul_f32 v[154:155], v[122:123], v[146:147] op_sel_hi:[0,1]
    v_pk_fma_f32 v[120:121], v[120:121], v[144:145], v[152:153] op_sel:[1,1,0] op_sel_hi:[1,0,1] neg_lo:[0,1,0]
    v_pk_fma_f32 v[122:123], v[122:123], v[146:147], v[154:155] op_sel:[1,1,0] op_sel_hi:[1,0,1] neg_lo:[0,1,0]
    v_cvt_pk_bf16_f32 v90, v120, v121
    v_cvt_pk_bf16_f32 v91, v122, v123
    ds_write_b64 v166, v[90:91] offset:7616
    v_pk_mul_f32 v[152:153], v[124:125], v[144:145] op_sel_hi:[0,1]
    v_pk_mul_f32 v[154:155], v[126:127], v[146:147] op_sel_hi:[0,1]
    v_pk_fma_f32 v[124:125], v[124:125], v[144:145], v[152:153] op_sel:[1,1,0] op_sel_hi:[1,0,1] neg_lo:[0,1,0]
    v_pk_fma_f32 v[126:127], v[126:127], v[146:147], v[154:155] op_sel:[1,1,0] op_sel_hi:[1,0,1] neg_lo:[0,1,0]
    v_cvt_pk_bf16_f32 v92, v124, v125
    v_cvt_pk_bf16_f32 v93, v126, v127
    ds_write_b64 v166, v[92:93] offset:8160
    v_pk_mul_f32 v[152:153], v[128:129], v[144:145] op_sel_hi:[0,1]
    v_pk_mul_f32 v[154:155], v[130:131], v[146:147] op_sel_hi:[0,1]
    v_pk_fma_f32 v[128:129], v[128:129], v[144:145], v[152:153] op_sel:[1,1,0] op_sel_hi:[1,0,1] neg_lo:[0,1,0]
    v_pk_fma_f32 v[130:131], v[130:131], v[146:147], v[154:155] op_sel:[1,1,0] op_sel_hi:[1,0,1] neg_lo:[0,1,0]
    buffer_load_dwordx2 v[248:249], off, s[76:79], 0 sc1
    ds_read_b128 v[40:43], v168 offset:0
    ds_read_b128 v[44:47], v168 offset:64
    ds_read_b128 v[48:51], v168 offset:128
    ds_read_b128 v[52:55], v168 offset:192
    ds_read_b128 v[56:59], v168 offset:256
    ds_read_b128 v[60:63], v168 offset:320
    ds_read_b128 v[64:67], v168 offset:384
    ds_read_b128 v[68:71], v168 offset:448
    v_pk_mul_f32 v[152:153], v[96:97], v[144:145] op_sel_hi:[0,1]
    v_pk_mul_f32 v[154:155], v[98:99], v[146:147] op_sel_hi:[0,1]
    v_pk_fma_f32 v[96:97], v[96:97], v[144:145], v[152:153] op_sel:[1,1,0] op_sel_hi:[1,0,1] neg_lo:[0,1,0]
    v_pk_fma_f32 v[98:99], v[98:99], v[146:147], v[154:155] op_sel:[1,1,0] op_sel_hi:[1,0,1] neg_lo:[0,1,0]
    v_cvt_pk_bf16_f32 v94, v96, v97
    v_cvt_pk_bf16_f32 v95, v98, v99
    ds_write_b64 v166, v[94:95] offset:0
    v_pk_mul_f32 v[152:153], v[104:105], v[144:145] op_sel_hi:[0,1]
    v_pk_mul_f32 v[154:155], v[106:107], v[146:147] op_sel_hi:[0,1]
    v_pk_fma_f32 v[104:105], v[104:105], v[144:145], v[152:153] op_sel:[1,1,0] op_sel_hi:[1,0,1] neg_lo:[0,1,0]
    v_pk_fma_f32 v[106:107], v[106:107], v[146:147], v[154:155] op_sel:[1,1,0] op_sel_hi:[1,0,1] neg_lo:[0,1,0]
    v_cvt_pk_bf16_f32 v88, v104, v105
    v_cvt_pk_bf16_f32 v89, v106, v107
    ds_write_b64 v166, v[88:89] offset:544
    v_pk_mul_f32 v[152:153], v[112:113], v[144:145] op_sel_hi:[0,1]
    v_pk_mul_f32 v[154:155], v[114:115], v[146:147] op_sel_hi:[0,1]
    v_pk_fma_f32 v[112:113], v[112:113], v[144:145], v[152:153] op_sel:[1,1,0] op_sel_hi:[1,0,1] neg_lo:[0,1,0]
    v_pk_fma_f32 v[114:115], v[114:115], v[146:147], v[154:155] op_sel:[1,1,0] op_sel_hi:[1,0,1] neg_lo:[0,1,0]
    v_cvt_pk_bf16_f32 v90, v112, v113
    v_cvt_pk_bf16_f32 v91, v114, v115
    ds_write_b64 v166, v[90:91] offset:1088
    ds_write_b64 v166, v[90:91] offset:2176
    v_pk_mul_f32 v[152:153], v[120:121], v[144:145] op_sel_hi:[0,1]
    v_pk_mul_f32 v[154:155], v[122:123], v[146:147] op_sel_hi:[0,1]
    v_pk_fma_f32 v[120:121], v[120:121], v[144:145], v[152:153] op_sel:[1,1,0] op_sel_hi:[1,0,1] neg_lo:[0,1,0]
    v_pk_fma_f32 v[122:123], v[122:123], v[146:147], v[154:155] op_sel:[1,1,0] op_sel_hi:[1,0,1] neg_lo:[0,1,0]
    v_cvt_pk_bf16_f32 v92, v120, v121
    v_cvt_pk_bf16_f32 v93, v122, v123
    ds_write_b64 v166, v[92:93] offset:2720
    v_pk_mul_f32 v[152:153], v[128:129], v[144:145] op_sel_hi:[0,1]
    v_pk_mul_f32 v[154:155], v[130:131], v[146:147] op_sel_hi:[0,1]
    v_pk_fma_f32 v[128:129], v[128:129], v[144:145], v[152:153] op_sel:[1,1,0] op_sel_hi:[1,0,1] neg_lo:[0,1,0]
    v_pk_fma_f32 v[130:131], v[130:131], v[146:147], v[154:155] op_sel:[1,1,0] op_sel_hi:[1,0,1] neg_lo:[0,1,0]
    v_cvt_pk_bf16_f32 v94, v128, v129
    v_cvt_pk_bf16_f32 v95, v130, v131
    ds_write_b64 v166, v[94:95] offset:3264
    v_pk_mul_f32 v[152:153], v[96:97], v[144:145] op_sel_hi:[0,1]
    v_pk_mul_f32 v[154:155], v[98:99], v[146:147] op_sel_hi:[0,1]
    v_pk_fma_f32 v[96:97], v[96:97], v[144:145], v[152:153] op_sel:[1,1,0] op_sel_hi:[1,0,1] neg_lo:[0,1,0]
    v_pk_fma_f32 v[98:99], v[98:99], v[146:147], v[154:155] op_sel:[1,1,0] op_sel_hi:[1,0,1] neg_lo:[0,1,0]
    v_cvt_pk_bf16_f32 v88, v96, v97
    v_cvt_pk_bf16_f32 v89, v98, v99
    ds_write_b64 v166, v[88:89] offset:4352
    v_pk_mul_f32 v[152:153], v[104:105], v[144:145] op_sel_hi:[0,1]
    v_pk_mul_f32 v[154:155], v[106:107], v[146:147] op_sel_hi:[0,1]
    v_pk_fma_f32 v[104:105], v[104:105], v[144:145], v[152:153] op_sel:[1,1,0] op_sel_hi:[1,0,1] neg_lo:[0,1,0]
    v_pk_fma_f32 v[106:107], v[106:107], v[146:147], v[154:155] op_sel:[1,1,0] op_sel_hi:[1,0,1] neg_lo:[0,1,0]
    v_cvt_pk_bf16_f32 v90, v104, v105
    v_cvt_pk_bf16_f32 v91, v106, v107
    ds_write_b64 v166, v[90:91] offset:4896
    v_pk_mul_f32 v[152:153], v[112:113], v[144:145] op_sel_hi:[0,1]
    v_pk_mul_f32 v[154:155], v[114:115], v[146:147] op_sel_hi:[0,1]
    v_pk_fma_f32 v[112:113], v[112:113], v[144:145], v[152:153] op_sel:[1,1,0] op_sel_hi:[1,0,1] neg_lo:[0,1,0]
    v_pk_fma_f32 v[114:115], v[114:115], v[146:147], v[154:155] op_sel:[1,1,0] op_sel_hi:[1,0,1] neg_lo:[0,1,0]
    v_cvt_pk_bf16_f32 v92, v112, v113
    v_cvt_pk_bf16_f32 v93, v114, v115
    ds_write_b64 v166, v[92:93] offset:5440
    ds_write_b64 v166, v[92:93] offset:6528
    v_pk_mul_f32 v[152:153], v[120:121], v[144:145] op_sel_hi:[0,1]
    v_pk_mul_f32 v[154:155], v[122:123], v[146:147] op_sel_hi:[0,1]
    v_pk_fma_f32 v[120:121], v[120:121], v[144:145], v[152:153] op_sel:[1,1,0] op_sel_hi:[1,0,1] neg_lo:[0,1,0]
    v_pk_fma_f32 v[122:123], v[122:123], v[146:147], v[154:155] op_sel:[1,1,0] op_sel_hi:[1,0,1] neg_lo:[0,1,0]
    v_cvt_pk_bf16_f32 v94, v120, v121
    v_cvt_pk_bf16_f32 v95, v122, v123
    ds_write_b64 v166, v[94:95] offset:7072
    v_pk_mul_f32 v[152:153], v[128:129], v[144:145] op_sel_hi:[0,1]
    v_pk_mul_f32 v[154:155], v[130:131], v[146:147] op_sel_hi:[0,1]
    v_pk_fma_f32 v[128:129], v[128:129], v[144:145], v[152:153] op_sel:[1,1,0] op_sel_hi:[1,0,1] neg_lo:[0,1,0]
    v_pk_fma_f32 v[130:131], v[130:131], v[146:147], v[154:155] op_sel:[1,1,0] op_sel_hi:[1,0,1] neg_lo:[0,1,0]
    v_cvt_pk_bf16_f32 v88, v128, v129
    v_cvt_pk_bf16_f32 v89, v130, v131
    ds_write_b64 v166, v[88:89] offset:7616
    s_waitcnt lgkmcnt(12)
    v_mfma_f32_16x16x32_bf16 v[72:75], v[40:43], v[8:11], 0
    v_mfma_f32_16x16x32_bf16 v[72:75], v[44:47], v[12:15], v[72:75]
    v_mfma_f32_16x16x32_bf16 v[72:75], v[48:51], v[16:19], v[72:75]
    v_mfma_f32_16x16x32_bf16 v[72:75], v[52:55], v[20:23], v[72:75]
    v_mfma_f32_16x16x32_bf16 v[72:75], v[56:59], v[24:27], v[72:75]
    v_mfma_f32_16x16x32_bf16 v[72:75], v[60:63], v[28:31], v[72:75]
    v_mfma_f32_16x16x32_bf16 v[72:75], v[64:67], v[32:35], v[72:75]
    v_mfma_f32_16x16x32_bf16 v[72:75], v[68:71], v[36:39], v[72:75]
    ds_read_b128 v[40:43], v168 offset:0
    ds_read_b128 v[44:47], v168 offset:64
    ds_read_b128 v[48:51], v168 offset:128
    ds_read_b128 v[52:55], v168 offset:192
    ds_read_b128 v[56:59], v168 offset:256
    ds_read_b128 v[60:63], v168 offset:320
    ds_read_b128 v[64:67], v168 offset:384
    ds_read_b128 v[68:71], v168 offset:448
    v_pk_mul_f32 v[152:153], v[96:97], v[144:145] op_sel_hi:[0,1]
    v_pk_mul_f32 v[154:155], v[98:99], v[146:147] op_sel_hi:[0,1]
    v_pk_fma_f32 v[96:97], v[96:97], v[144:145], v[152:153] op_sel:[1,1,0] op_sel_hi:[1,0,1] neg_lo:[0,1,0]
    v_pk_fma_f32 v[98:99], v[98:99], v[146:147], v[154:155] op_sel:[1,1,0] op_sel_hi:[1,0,1] neg_lo:[0,1,0]
    v_cvt_pk_bf16_f32 v90, v96, v97
    v_cvt_pk_bf16_f32 v91, v98, v99
    ds_write_b64 v166, v[90:91] offset:0
    v_pk_mul_f32 v[152:153], v[112:113], v[144:145] op_sel_hi:[0,1]
    v_pk_mul_f32 v[154:155], v[114:115], v[146:147] op_sel_hi:[0,1]
    v_pk_fma_f32 v[112:113], v[112:113], v[144:145], v[152:153] op_sel:[1,1,0] op_sel_hi:[1,0,1] neg_lo:[0,1,0]
    v_pk_fma_f32 v[114:115], v[114:115], v[146:147], v[154:155] op_sel:[1,1,0] op_sel_hi:[1,0,1] neg_lo:[0,1,0]
    v_cvt_pk_bf16_f32 v92, v112, v113
    v_cvt_pk_bf16_f32 v93, v114, v115
    ds_write_b64 v166, v[92:93] offset:544
    v_pk_mul_f32 v[152:153], v[128:129], v[144:145] op_sel_hi:[0,1]
    v_pk_mul_f32 v[154:155], v[130:131], v[146:147] op_sel_hi:[0,1]
    v_pk_fma_f32 v[128:129], v[128:129], v[144:145], v[152:153] op_sel:[1,1,0] op_sel_hi:[1,0,1] neg_lo:[0,1,0]
    v_pk_fma_f32 v[130:131], v[130:131], v[146:147], v[154:155] op_sel:[1,1,0] op_sel_hi:[1,0,1] neg_lo:[0,1,0]
    v_cvt_pk_bf16_f32 v94, v128, v129
    v_cvt_pk_bf16_f32 v95, v130, v131
    ds_write_b64 v166, v[94:95] offset:1088
    v_pk_mul_f32 v[152:153], v[96:97], v[144:145] op_sel_hi:[0,1]
    v_pk_mul_f32 v[154:155], v[98:99], v[146:147] op_sel_hi:[0,1]
    v_pk_fma_f32 v[96:97], v[96:97], v[144:145], v[152:153] op_sel:[1,1,0] op_sel_hi:[1,0,1] neg_lo:[0,1,0]
    v_pk_fma_f32 v[98:99], v[98:99], v[146:147], v[154:155] op_sel:[1,1,0] op_sel_hi:[1,0,1] neg_lo:[0,1,0]
    v_cvt_pk_bf16_f32 v88, v96, v97
    v_cvt_pk_bf16_f32 v89, v98, v99
    ds_write_b64 v166, v[88:89] offset:2176
    v_pk_mul_f32 v[152:153], v[112:113], v[144:145] op_sel_hi:[0,1]
    v_pk_mul_f32 v[154:155], v[114:115], v[146:147] op_sel_hi:[0,1]
    v_pk_fma_f32 v[112:113], v[112:113], v[144:145], v[152:153] op_sel:[1,1,0] op_sel_hi:[1,0,1] neg_lo:[0,1,0]
    v_pk_fma_f32 v[114:115], v[114:115], v[146:147], v[154:155] op_sel:[1,1,0] op_sel_hi:[1,0,1] neg_lo:[0,1,0]
    v_cvt_pk_bf16_f32 v90, v112, v113
    v_cvt_pk_bf16_f32 v91, v114, v115
    ds_write_b64 v166, v[90:91] offset:2720
    v_pk_mul_f32 v[152:153], v[128:129], v[144:145] op_sel_hi:[0,1]
    v_pk_mul_f32 v[154:155], v[130:131], v[146:147] op_sel_hi:[0,1]
    v_pk_fma_f32 v[128:129], v[128:129], v[144:145], v[152:153] op_sel:[1,1,0] op_sel_hi:[1,0,1] neg_lo:[0,1,0]
    v_pk_fma_f32 v[130:131], v[130:131], v[146:147], v[154:155] op_sel:[1,1,0] op_sel_hi:[1,0,1] neg_lo:[0,1,0]
    v_cvt_pk_bf16_f32 v92, v128, v129
    v_cvt_pk_bf16_f32 v93, v130, v131
    ds_write_b64 v166, v[92:93] offset:3264
    v_pk_mul_f32 v[152:153], v[96:97], v[144:145] op_sel_hi:[0,1]
    v_pk_mul_f32 v[154:155], v[98:99], v[146:147] op_sel_hi:[0,1]
    v_pk_fma_f32 v[96:97], v[96:97], v[144:145], v[152:153] op_sel:[1,1,0] op_sel_hi:[1,0,1] neg_lo:[0,1,0]
    v_pk_fma_f32 v[98:99], v[98:99], v[146:147], v[154:155] op_sel:[1,1,0] op_sel_hi:[1,0,1] neg_lo:[0,1,0]
    v_cvt_pk_bf16_f32 v94, v96, v97
    v_cvt_pk_bf16_f32 v95, v98, v99
    ds_write_b64 v166, v[94:95] offset:4352
    v_pk_mul_f32 v[152:153], v[112:113], v[144:145] op_sel_hi:[0,1]
    v_pk_mul_f32 v[154:155], v[114:115], v[146:147] op_sel_hi:[0,1]
    v_pk_fma_f32 v[112:113], v[112:113], v[144:145], v[152:153] op_sel:[1,1,0] op_sel_hi:[1,0,1] neg_lo:[0,1,0]
    v_pk_fma_f32 v[114:115], v[114:115], v[146:147], v[154:155] op_sel:[1,1,0] op_sel_hi:[1,0,1] neg_lo:[0,1,0]
    v_cvt_pk_bf16_f32 v88, v112, v113
    v_cvt_pk_bf16_f32 v89, v114, v115
    ds_write_b64 v166, v[88:89] offset:4896
    v_pk_mul_f32 v[152:153], v[128:129], v[144:145] op_sel_hi:[0,1]
    v_pk_mul_f32 v[154:155], v[130:131], v[146:147] op_sel_hi:[0,1]
    v_pk_fma_f32 v[128:129], v[128:129], v[144:145], v[152:153] op_sel:[1,1,0] op_sel_hi:[1,0,1] neg_lo:[0,1,0]
    v_pk_fma_f32 v[130:131], v[130:131], v[146:147], v[154:155] op_sel:[1,1,0] op_sel_hi:[1,0,1] neg_lo:[0,1,0]
    v_cvt_pk_bf16_f32 v90, v128, v129
    v_cvt_pk_bf16_f32 v91, v130, v131
    ds_write_b64 v166, v[90:91] offset:5440
    v_pk_mul_f32 v[152:153], v[96:97], v[144:145] op_sel_hi:[0,1]
    v_pk_mul_f32 v[154:155], v[98:99], v[146:147] op_sel_hi:[0,1]
    v_pk_fma_f32 v[96:97], v[96:97], v[144:145], v[152:153] op_sel:[1,1,0] op_sel_hi:[1,0,1] neg_lo:[0,1,0]
    v_pk_fma_f32 v[98:99], v[98:99], v[146:147], v[154:155] op_sel:[1,1,0] op_sel_hi:[1,0,1] neg_lo:[0,1,0]
    s_lshl_b32 s80, s36, 10
    s_add_u32 s80, s80, 9437184
    buffer_load_dwordx2 v[250:251], v253, s[16:19], s80 offen sc1
    v_cvt_pk_bf16_f32 v92, v96, v97
    v_cvt_pk_bf16_f32 v93, v98, v99
    ds_write_b64 v166, v[92:93] offset:6528
    v_pk_mul_f32 v[152:153], v[112:113], v[144:145] op_sel_hi:[0,1]
    v_pk_mul_f32 v[154:155], v[114:115], v[146:147] op_sel_hi:[0,1]
    v_pk_fma_f32 v[112:113], v[112:113], v[144:145], v[152:153] op_sel:[1,1,0] op_sel_hi:[1,0,1] neg_lo:[0,1,0]
    v_pk_fma_f32 v[114:115], v[114:115], v[146:147], v[154:155] op_sel:[1,1,0] op_sel_hi:[1,0,1] neg_lo:[0,1,0]
    v_cvt_pk_bf16_f32 v94, v112, v113
    v_cvt_pk_bf16_f32 v95, v114, v115
    ds_write_b64 v166, v[94:95] offset:7072
    v_pk_mul_f32 v[152:153], v[128:129], v[144:145] op_sel_hi:[0,1]
    v_pk_mul_f32 v[154:155], v[130:131], v[146:147] op_sel_hi:[0,1]
    v_pk_fma_f32 v[128:129], v[128:129], v[144:145], v[152:153] op_sel:[1,1,0] op_sel_hi:[1,0,1] neg_lo:[0,1,0]
    v_pk_fma_f32 v[130:131], v[130:131], v[146:147], v[154:155] op_sel:[1,1,0] op_sel_hi:[1,0,1] neg_lo:[0,1,0]
    v_cvt_pk_bf16_f32 v88, v128, v129
    v_cvt_pk_bf16_f32 v89, v130, v131
    ds_write_b64 v166, v[88:89] offset:7616
    s_waitcnt lgkmcnt(12)
    v_mfma_f32_16x16x32_bf16 v[76:79], v[40:43], v[8:11], 0
    v_mfma_f32_16x16x32_bf16 v[76:79], v[44:47], v[12:15], v[76:79]
    v_mfma_f32_16x16x32_bf16 v[76:79], v[48:51], v[16:19], v[76:79]
    v_mfma_f32_16x16x32_bf16 v[76:79], v[52:55], v[20:23], v[76:79]
    v_mfma_f32_16x16x32_bf16 v[76:79], v[56:59], v[24:27], v[76:79]
    v_mfma_f32_16x16x32_bf16 v[76:79], v[60:63], v[28:31], v[76:79]
    v_mfma_f32_16x16x32_bf16 v[76:79], v[64:67], v[32:35], v[76:79]
    v_mfma_f32_16x16x32_bf16 v[76:79], v[68:71], v[36:39], v[76:79]
    ds_read_b128 v[40:43], v168 offset:0
    ds_read_b128 v[44:47], v168 offset:64
    ds_read_b128 v[48:51], v168 offset:128
    ds_read_b128 v[52:55], v168 offset:192
    ds_read_b128 v[56:59], v168 offset:256
    ds_read_b128 v[60:63], v168 offset:320
    ds_read_b128 v[64:67], v168 offset:384
    ds_read_b128 v[68:71], v168 offset:448
    v_pk_mul_f32 v[152:153], v[96:97], v[144:145] op_sel_hi:[0,1]
    v_pk_mul_f32 v[154:155], v[98:99], v[146:147] op_sel_hi:[0,1]
    v_pk_fma_f32 v[96:97], v[96:97], v[144:145], v[152:153] op_sel:[1,1,0] op_sel_hi:[1,0,1] neg_lo:[0,1,0]
    v_pk_fma_f32 v[98:99], v[98:99], v[146:147], v[154:155] op_sel:[1,1,0] op_sel_hi:[1,0,1] neg_lo:[0,1,0]
    v_cvt_pk_bf16_f32 v90, v96, v97
    v_cvt_pk_bf16_f32 v91, v98, v99
    ds_write_b64 v166, v[90:91] offset:0
    v_pk_mul_f32 v[152:153], v[128:129], v[144:145] op_sel_hi:[0,1]
    v_pk_mul_f32 v[154:155], v[130:131], v[146:147] op_sel_hi:[0,1]
    v_pk_fma_f32 v[128:129], v[128:129], v[144:145], v[152:153] op_sel:[1,1,0] op_sel_hi:[1,0,1] neg_lo:[0,1,0]
    v_pk_fma_f32 v[130:131], v[130:131], v[146:147], v[154:155] op_sel:[1,1,0] op_sel_hi:[1,0,1] neg_lo:[0,1,0]
    v_cvt_pk_bf16_f32 v92, v128, v129
    v_cvt_pk_bf16_f32 v93, v130, v131
    ds_write_b64 v166, v[92:93] offset:544
    v_pk_mul_f32 v[152:153], v[96:97], v[144:145] op_sel_hi:[0,1]
    v_pk_mul_f32 v[154:155], v[98:99], v[146:147] op_sel_hi:[0,1]
    v_pk_fma_f32 v[96:97], v[96:97], v[144:145], v[152:153] op_sel:[1,1,0] op_sel_hi:[1,0,1] neg_lo:[0,1,0]
    v_pk_fma_f32 v[98:99], v[98:99], v[146:147], v[154:155] op_sel:[1,1,0] op_sel_hi:[1,0,1] neg_lo:[0,1,0]
    v_cvt_pk_bf16_f32 v94, v96, v97
    v_cvt_pk_bf16_f32 v95, v98, v99
    ds_write_b64 v166, v[94:95] offset:2176
    v_pk_mul_f32 v[152:153], v[128:129], v[144:145] op_sel_hi:[0,1]
    v_pk_mul_f32 v[154:155], v[130:131], v[146:147] op_sel_hi:[0,1]
    v_pk_fma_f32 v[128:129], v[128:129], v[144:145], v[152:153] op_sel:[1,1,0] op_sel_hi:[1,0,1] neg_lo:[0,1,0]
    v_pk_fma_f32 v[130:131], v[130:131], v[146:147], v[154:155] op_sel:[1,1,0] op_sel_hi:[1,0,1] neg_lo:[0,1,0]
    v_cvt_pk_bf16_f32 v88, v128, v129
    v_cvt_pk_bf16_f32 v89, v130, v131
    ds_write_b64 v166, v[88:89] offset:2720
    v_pk_mul_f32 v[152:153], v[96:97], v[144:145] op_sel_hi:[0,1]
    v_pk_mul_f32 v[154:155], v[98:99], v[146:147] op_sel_hi:[0,1]
    v_pk_fma_f32 v[96:97], v[96:97], v[144:145], v[152:153] op_sel:[1,1,0] op_sel_hi:[1,0,1] neg_lo:[0,1,0]
    v_pk_fma_f32 v[98:99], v[98:99], v[146:147], v[154:155] op_sel:[1,1,0] op_sel_hi:[1,0,1] neg_lo:[0,1,0]
    v_cvt_pk_bf16_f32 v90, v96, v97
    v_cvt_pk_bf16_f32 v91, v98, v99
    ds_write_b64 v166, v[90:91] offset:4352
    v_pk_mul_f32 v[152:153], v[128:129], v[144:145] op_sel_hi:[0,1]
    v_pk_mul_f32 v[154:155], v[130:131], v[146:147] op_sel_hi:[0,1]
    v_pk_fma_f32 v[128:129], v[128:129], v[144:145], v[152:153] op_sel:[1,1,0] op_sel_hi:[1,0,1] neg_lo:[0,1,0]
    v_pk_fma_f32 v[130:131], v[130:131], v[146:147], v[154:155] op_sel:[1,1,0] op_sel_hi:[1,0,1] neg_lo:[0,1,0]
    v_cvt_pk_bf16_f32 v92, v128, v129
    v_cvt_pk_bf16_f32 v93, v130, v131
    ds_write_b64 v166, v[92:93] offset:4896
    v_pk_mul_f32 v[152:153], v[96:97], v[144:145] op_sel_hi:[0,1]
    v_pk_mul_f32 v[154:155], v[98:99], v[146:147] op_sel_hi:[0,1]
    v_pk_fma_f32 v[96:97], v[96:97], v[144:145], v[152:153] op_sel:[1,1,0] op_sel_hi:[1,0,1] neg_lo:[0,1,0]
    v_pk_fma_f32 v[98:99], v[98:99], v[146:147], v[154:155] op_sel:[1,1,0] op_sel_hi:[1,0,1] neg_lo:[0,1,0]
    v_cvt_pk_bf16_f32 v94, v96, v97
    v_cvt_pk_bf16_f32 v95, v98, v99
    ds_write_b64 v166, v[94:95] offset:6528
    v_pk_mul_f32 v[152:153], v[128:129], v[144:145] op_sel_hi:[0,1]
    v_pk_mul_f32 v[154:155], v[130:131], v[146:147] op_sel_hi:[0,1]
    v_pk_fma_f32 v[128:129], v[128:129], v[144:145], v[152:153] op_sel:[1,1,0] op_sel_hi:[1,0,1] neg_lo:[0,1,0]
    v_pk_fma_f32 v[130:131], v[130:131], v[146:147], v[154:155] op_sel:[1,1,0] op_sel_hi:[1,0,1] neg_lo:[0,1,0]
    v_cvt_pk_bf16_f32 v88, v128, v129
    v_cvt_pk_bf16_f32 v89, v130, v131
    ds_write_b64 v166, v[88:89] offset:7072
    v_pk_mul_f32 v[152:153], v[96:97], v[144:145] op_sel_hi:[0,1]
    v_pk_mul_f32 v[154:155], v[98:99], v[146:147] op_sel_hi:[0,1]
    v_pk_fma_f32 v[96:97], v[96:97], v[144:145], v[152:153] op_sel:[1,1,0] op_sel_hi:[1,0,1] neg_lo:[0,1,0]
    v_pk_fma_f32 v[98:99], v[98:99], v[146:147], v[154:155] op_sel:[1,1,0] op_sel_hi:[1,0,1] neg_lo:[0,1,0]
    v_cvt_pk_bf16_f32 v90, v96, v97
    v_cvt_pk_bf16_f32 v91, v98, v99
    ds_write_b64 v166, v[90:91] offset:1088
    v_pk_mul_f32 v[152:153], v[128:129], v[144:145] op_sel_hi:[0,1]
    v_pk_mul_f32 v[154:155], v[130:131], v[146:147] op_sel_hi:[0,1]
    v_pk_fma_f32 v[128:129], v[128:129], v[144:145], v[152:153] op_sel:[1,1,0] op_sel_hi:[1,0,1] neg_lo:[0,1,0]
    v_pk_fma_f32 v[130:131], v[130:131], v[146:147], v[154:155] op_sel:[1,1,0] op_sel_hi:[1,0,1] neg_lo:[0,1,0]
    s_waitcnt vmcnt(0)
    v_cmp_eq_u32 vcc, 0, v248
    s_cbranch_vccnz L_slow_8
L_back_9:
    v_cmp_ne_u64 vcc, v[250:251], v[248:249]
    s_cbranch_vccnz L_slow_10
L_back_11:
    s_xor_b32 s79, s39, 2048
    buffer_load_dwordx4 a[0:3], v240, s[16:19], s39 offen offset:0 sc1
    v_cvt_pk_bf16_f32 v92, v128, v129
    v_cvt_pk_bf16_f32 v93, v130, v131
    ds_write_b64 v166, v[92:93] offset:1632
    v_pk_mul_f32 v[152:153], v[96:97], v[144:145] op_sel_hi:[0,1]
    v_pk_mul_f32 v[154:155], v[98:99], v[146:147] op_sel_hi:[0,1]
    v_pk_fma_f32 v[96:97], v[96:97], v[144:145], v[152:153] op_sel:[1,1,0] op_sel_hi:[1,0,1] neg_lo:[0,1,0]
    v_pk_fma_f32 v[98:99], v[98:99], v[146:147], v[154:155] op_sel:[1,1,0] op_sel_hi:[1,0,1] neg_lo:[0,1,0]
    buffer_load_dwordx4 a[4:7], v240, s[16:19], s39 offen offset:1024 sc1
    buffer_load_dwordx4 a[8:11], v240, s[16:19], s79 offen offset:0 sc1
    v_cvt_pk_bf16_f32 v94, v96, v97
    v_cvt_pk_bf16_f32 v95, v98, v99
    ds_write_b64 v166, v[94:95] offset:3264
    v_pk_mul_f32 v[152:153], v[128:129], v[144:145] op_sel_hi:[0,1]
    v_pk_mul_f32 v[154:155], v[130:131], v[146:147] op_sel_hi:[0,1]
    v_pk_fma_f32 v[128:129], v[128:129], v[144:145], v[152:153] op_sel:[1,1,0] op_sel_hi:[1,0,1] neg_lo:[0,1,0]
    v_pk_fma_f32 v[130:131], v[130:131], v[146:147], v[154:155] op_sel:[1,1,0] op_sel_hi:[1,0,1] neg_lo:[0,1,0]
    buffer_load_dwordx4 a[12:15], v240, s[16:19], s79 offen offset:1024 sc1
    buffer_load_dwordx4 a[16:19], v241, s[16:19], s39 offen offset:0 sc1
    v_cvt_pk_bf16_f32 v88, v128, v129
    v_cvt_pk_bf16_f32 v89, v130, v131
    ds_write_b64 v166, v[88:89] offset:3808
    v_pk_mul_f32 v[152:153], v[96:97], v[144:145] op_sel_hi:[0,1]
    v_pk_mul_f32 v[154:155], v[98:99], v[146:147] op_sel_hi:[0,1]
    v_pk_fma_f32 v[96:97], v[96:97], v[144:145], v[152:153] op_sel:[1,1,0] op_sel_hi:[1,0,1] neg_lo:[0,1,0]
    v_pk_fma_f32 v[98:99], v[98:99], v[146:147], v[154:155] op_sel:[1,1,0] op_sel_hi:[1,0,1] neg_lo:[0,1,0]
    buffer_load_dwordx4 a[20:23], v241, s[16:19], s39 offen offset:1024 sc1
    buffer_load_dwordx4 a[24:27], v241, s[16:19], s79 offen offset:0 sc1
    v_cvt_pk_bf16_f32 v90, v96, v97
    v_cvt_pk_bf16_f32 v91, v98, v99
    ds_write_b64 v166, v[90:91] offset:5440
    v_pk_mul_f32 v[152:153], v[128:129], v[144:145] op_sel_hi:[0,1]
    v_pk_mul_f32 v[154:155], v[130:131], v[146:147] op_sel_hi:[0,1]
    v_pk_fma_f32 v[128:129], v[128:129], v[144:145], v[152:153] op_sel:[1,1,0] op_sel_hi:[1,0,1] neg_lo:[0,1,0]
    v_pk_fma_f32 v[130:131], v[130:131], v[146:147], v[154:155] op_sel:[1,1,0] op_sel_hi:[1,0,1] neg_lo:[0,1,0]
    buffer_load_dwordx4 a[28:31], v241, s[16:19], s79 offen offset:1024 sc1
    s_add_u32 s39, s39, 8192
    v_cvt_pk_bf16_f32 v92, v128, v129
    v_cvt_pk_bf16_f32 v93, v130, v131
    ds_write_b64 v166, v[92:93] offset:5984
    v_pk_mul_f32 v[152:153], v[96:97], v[144:145] op_sel_hi:[0,1]
    v_pk_mul_f32 v[154:155], v[98:99], v[146:147] op_sel_hi:[0,1]
    v_pk_fma_f32 v[96:97], v[96:97], v[144:145], v[152:153] op_sel:[1,1,0] op_sel_hi:[1,0,1] neg_lo:[0,1,0]
    v_pk_fma_f32 v[98:99], v[98:99], v[146:147], v[154:155] op_sel:[1,1,0] op_sel_hi:[1,0,1] neg_lo:[0,1,0]
    s_xor_b32 s79, s39, 2048
    buffer_load_dwordx4 a[32:35], v240, s[16:19], s39 offen offset:0 sc1
    v_cvt_pk_bf16_f32 v94, v96, v97
    v_cvt_pk_bf16_f32 v95, v98, v99
    ds_write_b64 v166, v[94:95] offset:7616
    v_pk_mul_f32 v[152:153], v[128:129], v[144:145] op_sel_hi:[0,1]
    v_pk_mul_f32 v[154:155], v[130:131], v[146:147] op_sel_hi:[0,1]
    v_pk_fma_f32 v[128:129], v[128:129], v[144:145], v[152:153] op_sel:[1,1,0] op_sel_hi:[1,0,1] neg_lo:[0,1,0]
    v_pk_fma_f32 v[130:131], v[130:131], v[146:147], v[154:155] op_sel:[1,1,0] op_sel_hi:[1,0,1] neg_lo:[0,1,0]
    buffer_load_dwordx4 a[36:39], v240, s[16:19], s39 offen offset:1024 sc1
    buffer_load_dwordx4 a[40:43], v240, s[16:19], s79 offen offset:0 sc1
    v_cvt_pk_bf16_f32 v88, v128, v129
    v_cvt_pk_bf16_f32 v89, v130, v131
    ds_write_b64 v166, v[88:89] offset:8160
    s_waitcnt lgkmcnt(15)
    v_mfma_f32_16x16x32_bf16 v[80:83], v[40:43], v[8:11], 0
    v_mfma_f32_16x16x32_bf16 v[80:83], v[44:47], v[12:15], v[80:83]
    v_mfma_f32_16x16x32_bf16 v[80:83], v[48:51], v[16:19], v[80:83]
    v_mfma_f32_16x16x32_bf16 v[80:83], v[52:55], v[20:23], v[80:83]
    v_mfma_f32_16x16x32_bf16 v[80:83], v[56:59], v[24:27], v[80:83]
    v_mfma_f32_16x16x32_bf16 v[80:83], v[60:63], v[28:31], v[80:83]
    v_mfma_f32_16x16x32_bf16 v[80:83], v[64:67], v[32:35], v[80:83]
    v_mfma_f32_16x16x32_bf16 v[80:83], v[68:71], v[36:39], v[80:83]
    ds_read_b128 v[40:43], v168 offset:0
    ds_read_b128 v[44:47], v168 offset:64
    ds_read_b128 v[48:51], v168 offset:128
    ds_read_b128 v[52:55], v168 offset:192
    ds_read_b128 v[56:59], v168 offset:256
    ds_read_b128 v[60:63], v168 offset:320
    ds_read_b128 v[64:67], v168 offset:384
    ds_read_b128 v[68:71], v168 offset:448
    v_add_f32 v72, v72, v174
    v_cvt_pk_bf16_f32 v96, v75, v74
    v_cvt_pk_bf16_f32 v97, v73, v72
    ds_write_b64 v170, v[96:97] offset:512
    v_cvt_pk_bf16_f32 v98, v78, v77
    v_cvt_pk_bf16_f32 v99, v76, v76
    ds_write_b64 v170, v[98:99] offset:0
    s_waitcnt lgkmcnt(2)
    v_mfma_f32_16x16x32_bf16 v[84:87], v[40:43], v[8:11], 0
    v_mfma_f32_16x16x32_bf16 v[84:87], v[44:47], v[12:15], v[84:87]
    v_mfma_f32_16x16x32_bf16 v[84:87], v[48:51], v[16:19], v[84:87]
    v_mfma_f32_16x16x32_bf16 v[84:87], v[52:55], v[20:23], v[84:87]
    v_mfma_f32_16x16x32_bf16 v[84:87], v[56:59], v[24:27], v[84:87]
    v_mfma_f32_16x16x32_bf16 v[84:87], v[60:63], v[28:31], v[84:87]
    v_mfma_f32_16x16x32_bf16 v[84:87], v[64:67], v[32:35], v[84:87]
    v_mfma_f32_16x16x32_bf16 v[84:87], v[68:71], v[36:39], v[84:87]
    v_cvt_pk_bf16_f32 v100, v82, v82
    v_cvt_pk_bf16_f32 v101, v81, v81
    v_cvt_pk_bf16_f32 v102, v81, v80
    v_cvt_pk_bf16_f32 v103, v80, v80
    ds_write_b128 v172, v[100:103] offset:2048
    v_cmp_eq_u32 vcc, 0, v176
    s_nop 2
    v_cndmask_b32 v176, v85, v84, vcc
    v_cvt_pk_bf16_f32 v104, v85, v85
    v_cvt_pk_bf16_f32 v105, v85, v176
    v_cvt_pk_bf16_f32 v106, v84, v84
    v_cvt_pk_bf16_f32 v107, v84, v84
    ds_write_b128 v172, v[104:107] offset:1024
    v_cndmask_b32 v176, v87, v86, vcc
    v_cvt_pk_bf16_f32 v108, v87, v87
    v_cvt_pk_bf16_f32 v109, v87, v176
    v_cvt_pk_bf16_f32 v110, v86, v86
    v_cvt_pk_bf16_f32 v111, v86, v86
    ds_write_b128 v172, v[108:111] offset:0
    buffer_load_dwordx4 a[44:47], v240, s[16:19], s79 offen offset:1024 sc1
    buffer_load_dwordx4 a[48:51], v241, s[16:19], s39 offen offset:0 sc1
    buffer_load_dwordx4 a[52:55], v241, s[16:19], s39 offen offset:1024 sc1
    buffer_load_dwordx4 a[56:59], v241, s[16:19], s79 offen offset:0 sc1
    buffer_load_dwordx4 a[60:63], v241, s[16:19], s79 offen offset:1024 sc1
    s_add_u32 s39, s39, 8192
L_go:
    s_waitcnt lgkmcnt(0)
    s_barrier
    ds_read_b64_tr_b16 v[192:193], v232 offset:0
    ds_read_b64_tr_b16 v[194:195], v232 offset:512
    ds_read_b64_tr_b16 v[196:197], v232 offset:8192
    ds_read_b64_tr_b16 v[198:199], v232 offset:8704
    ds_read_b64_tr_b16 v[200:201], v232 offset:1024
    ds_read_b64_tr_b16 v[202:203], v232 offset:1536
    ds_read_b64_tr_b16 v[204:205], v232 offset:9216
    ds_read_b64_tr_b16 v[206:207], v232 offset:9728
    s_waitcnt vmcnt(15) lgkmcnt(6)
    v_mfma_f32_16x16x32_bf16 v[0:3], v[192:195], a[0:3], 0
    s_waitcnt vmcnt(11) lgkmcnt(4)
    v_mfma_f32_16x16x32_bf16 v[0:3], v[196:199], a[16:19], v[0:3]
    v_mfma_f32_16x16x32_bf16 v[4:7], v[192:195], a[4:7], 0
    s_xor_b32 s79, s39, 2048
    s_waitcnt vmcnt(10)
    v_mfma_f32_16x16x32_bf16 v[4:7], v[196:199], a[20:23], v[4:7]
    ds_read_b64_tr_b16 v[208:209], v233 offset:0
    buffer_load_dwordx4 a[64:67], v240, s[16:19], s39 offen offset:0 sc1
    v_mfma_f32_16x16x32_bf16 v[8:11], v[192:195], a[8:11], 0
    ds_read_b64_tr_b16 v[210:211], v233 offset:512
    s_waitcnt vmcnt(10)
    v_mfma_f32_16x16x32_bf16 v[8:11], v[196:199], a[24:27], v[8:11]
    v_mfma_f32_16x16x32_bf16 v[12:15], v[192:195], a[12:15], 0
    s_waitcnt vmcnt(9)
    v_mfma_f32_16x16x32_bf16 v[12:15], v[196:199], a[28:31], v[12:15]
    ds_read_b64_tr_b16 v[192:193], v233 offset:8192
    s_waitcnt lgkmcnt(3)
    v_mfma_f32_16x16x32_bf16 v[64:67], v[200:203], a[0:3], 0
    ds_read_b64_tr_b16 v[194:195], v233 offset:8704
    buffer_load_dwordx4 a[68:71], v240, s[16:19], s39 offen offset:1024 sc1
    v_mfma_f32_16x16x32_bf16 v[64:67], v[204:207], a[16:19], v[64:67]
    v_mfma_f32_16x16x32_bf16 v[68:71], v[200:203], a[4:7], 0
    s_add_u32 s81, s32, 1
    s_lshr_b32 s81, s81, 1
    v_mfma_f32_16x16x32_bf16 v[68:71], v[204:207], a[20:23], v[68:71]
    ds_read_b64_tr_b16 v[196:197], v233 offset:1024
    s_mul_i32 s81, s81, 294912
    v_mfma_f32_16x16x32_bf16 v[72:75], v[200:203], a[8:11], 0
    ds_read_b64_tr_b16 v[198:199], v233 offset:1536
    v_add_u32 v239, s81, v239
    v_mfma_f32_16x16x32_bf16 v[72:75], v[204:207], a[24:27], v[72:75]
    buffer_load_dwordx4 a[72:75], v240, s[16:19], s79 offen offset:0 sc1
    s_lshl3_add_u32 s12, s35, s33
    v_mfma_f32_16x16x32_bf16 v[76:79], v[200:203], a[12:15], 0
    s_xor_b32 s12, s12, 0
    s_mul_i32 s13, s36, 18
    v_mfma_f32_16x16x32_bf16 v[76:79], v[204:207], a[28:31], v[76:79]
    ds_read_b64_tr_b16 v[200:201], v233 offset:9216
    s_waitcnt lgkmcnt(3)
    v_mfma_f32_16x16x32_bf16 v[16:19], v[208:211], a[0:3], 0
    ds_read_b64_tr_b16 v[202:203], v233 offset:9728
    s_add_u32 s13, s13, s12
    v_mfma_f32_16x16x32_bf16 v[16:19], v[192:195], a[16:19], v[16:19]
    s_lshl_b32 s13, s13, 12
    s_mul_i32 s14, s12, 135168
    v_mfma_f32_16x16x32_bf16 v[20:23], v[208:211], a[4:7], 0
    buffer_load_dwordx4 a[76:79], v240, s[16:19], s79 offen offset:1024 sc1
    s_add_u32 s14, s14, 3145856
    v_mfma_f32_16x16x32_bf16 v[20:23], v[192:195], a[20:23], v[20:23]
    ds_read_b64_tr_b16 v[204:205], v234 offset:0
    s_lshl_b32 s15, s12, 5
    v_mfma_f32_16x16x32_bf16 v[24:27], v[208:211], a[8:11], 0
    ds_read_b64_tr_b16 v[206:207], v234 offset:512
    s_add_u32 s15, s15, s36
    v_mfma_f32_16x16x32_bf16 v[24:27], v[192:195], a[24:27], v[24:27]
    s_lshl_b32 s15, s15, 7
    s_add_u32 s15, s15, 9502720
    v_mfma_f32_16x16x32_bf16 v[28:31], v[208:211], a[12:15], 0
    buffer_load_dwordx4 a[80:83], v241, s[16:19], s39 offen offset:0 sc1
    s_cmp_lt_u32 s12, 18
    s_cselect_b32 s12, 0, 1073741824
    v_mfma_f32_16x16x32_bf16 v[28:31], v[192:195], a[28:31], v[28:31]
    ds_read_b64_tr_b16 v[208:209], v234 offset:8192
    s_waitcnt lgkmcnt(3)
    v_mfma_f32_16x16x32_bf16 v[80:83], v[196:199], a[0:3], 0
    ds_read_b64_tr_b16 v[210:211], v234 offset:8704
    s_add_u32 s13, s13, s12
    v_mfma_f32_16x16x32_bf16 v[80:83], v[200:203], a[16:19], v[80:83]
    s_add_u32 s14, s14, s12
    s_add_u32 s15, s15, s12
    v_mfma_f32_16x16x32_bf16 v[84:87], v[196:199], a[4:7], 0
    s_lshl_b32 s81, s36, 7
    s_add_u32 s14, s14, s81
    v_mfma_f32_16x16x32_bf16 v[84:87], v[200:203], a[20:23], v[84:87]
    ds_read_b64_tr_b16 v[192:193], v234 offset:1024
    buffer_load_dwordx4 a[84:87], v241, s[16:19], s39 offen offset:1024 sc1
    v_mfma_f32_16x16x32_bf16 v[88:91], v[196:199], a[8:11], 0
    ds_read_b64_tr_b16 v[194:195], v234 offset:1536
    v_lshrrev_b32 v244, 5, v243
    v_mfma_f32_16x16x32_bf16 v[88:91], v[200:203], a[24:27], v[88:91]
    v_bfe_u32 v245, v243, 1, 1
    v_lshlrev_b32 v245, 11, v245
    v_mfma_f32_16x16x32_bf16 v[92:95], v[196:199], a[12:15], 0
    v_lshl_add_u32 v144, v244, 10, v245
    v_bfe_u32 v244, v243, 4, 1
    v_mfma_f32_16x16x32_bf16 v[92:95], v[200:203], a[28:31], v[92:95]
    ds_read_b64_tr_b16 v[196:197], v234 offset:9216
    s_waitcnt lgkmcnt(3)
    v_mfma_f32_16x16x32_bf16 v[32:35], v[204:207], a[0:3], 0
    ds_read_b64_tr_b16 v[198:199], v234 offset:9728
    buffer_load_dwordx4 a[88:91], v241, s[16:19], s79 offen offset:0 sc1
    v_mfma_f32_16x16x32_bf16 v[32:35], v[208:211], a[16:19], v[32:35]
    v_lshl_add_u32 v144, v244, 7, v144
    v_bfe_u32 v244, v243, 2, 2
    v_mfma_f32_16x16x32_bf16 v[36:39], v[204:207], a[4:7], 0
    v_lshl_add_u32 v144, v244, 4, v144
    v_and_b32 v244, 1, v243
    v_mfma_f32_16x16x32_bf16 v[36:39], v[208:211], a[20:23], v[36:39]
    ds_read_b64_tr_b16 v[200:201], v235 offset:0
    v_lshl_add_u32 v144, v244, 3, v144
    v_mfma_f32_16x16x32_bf16 v[40:43], v[204:207], a[8:11], 0
    ds_read_b64_tr_b16 v[202:203], v235 offset:512
    s_lshl_b32 s81, s32, 12
    v_mfma_f32_16x16x32_bf16 v[40:43], v[208:211], a[24:27], v[40:43]
    buffer_load_dwordx4 a[92:95], v241, s[16:19], s79 offen offset:1024 sc1
    s_add_u32 s39, s39, 8192
    v_mfma_f32_16x16x32_bf16 v[44:47], v[204:207], a[12:15], 0
    s_add_u32 s81, s81, 98560
    v_add_u32 v144, s81, v144
    v_mfma_f32_16x16x32_bf16 v[44:47], v[208:211], a[28:31], v[44:47]
    ds_read_b64_tr_b16 v[204:205], v235 offset:8192
    s_waitcnt lgkmcnt(3)
    v_mfma_f32_16x16x32_bf16 v[96:99], v[192:195], a[0:3], 0
    ds_read_b64_tr_b16 v[206:207], v235 offset:8704
    v_and_b32 v244, 7, v243
    v_mfma_f32_16x16x32_bf16 v[96:99], v[196:199], a[16:19], v[96:99]
    v_mul_u32_u24 v244, 4224, v244
    v_and_b32 v245, 48, v243
    v_mfma_f32_16x16x32_bf16 v[100:103], v[192:195], a[4:7], 0
    s_xor_b32 s79, s39, 2048
    buffer_load_dwordx4 a[96:99], v240, s[16:19], s39 offen offset:0 sc1
    v_mfma_f32_16x16x32_bf16 v[100:103], v[196:199], a[20:23], v[100:103]
    ds_read_b64_tr_b16 v[208:209], v235 offset:1024
    v_add_u32 v145, v244, v245
    v_mfma_f32_16x16x32_bf16 v[104:107], v[192:195], a[8:11], 0
    ds_read_b64_tr_b16 v[210:211], v235 offset:1536
    v_and_b32 v245, 8, v243
    v_mfma_f32_16x16x32_bf16 v[104:107], v[196:199], a[24:27], v[104:107]
    v_lshl_add_u32 v145, v245, 3, v145
    v_mfma_f32_16x16x32_bf16 v[108:111], v[192:195], a[12:15], 0
    s_lshr_b32 s76, s2, 3
    s_lshl2_add_u32 s76, s76, s32
    v_mfma_f32_16x16x32_bf16 v[108:111], v[196:199], a[28:31], v[108:111]
    ds_read_b64_tr_b16 v[192:193], v235 offset:9216
    s_waitcnt lgkmcnt(3)
    v_mfma_f32_16x16x32_bf16 v[48:51], v[200:203], a[0:3], 0
    ds_read_b64_tr_b16 v[194:195], v235 offset:9728
    buffer_load_dwordx4 a[100:103], v240, s[16:19], s39 offen offset:1024 sc1
    v_mfma_f32_16x16x32_bf16 v[48:51], v[204:207], a[16:19], v[48:51]
    v_lshrrev_b32 v244, 2, v243
    v_min_u32 v244, 4, v244
    v_mfma_f32_16x16x32_bf16 v[52:55], v[200:203], a[4:7], 0
    s_waitcnt lgkmcnt(2)
    s_barrier
    v_mfma_f32_16x16x32_bf16 v[52:55], v[204:207], a[20:23], v[52:55]
    ds_read_b64_tr_b16 v[196:197], v232 offset:16384
    v_mul_u32_u24 v244, 9216, v244
    v_mfma_f32_16x16x32_bf16 v[56:59], v[200:203], a[8:11], 0
    ds_read_b64_tr_b16 v[198:199], v232 offset:16896
    v_and_b32 v245, 3, v243
    v_mfma_f32_16x16x32_bf16 v[56:59], v[204:207], a[24:27], v[56:59]
    s_add_u32 m0, s37, 49152
    v_lshl_add_u32 v244, v245, 7, v244
    v_mfma_f32_16x16x32_bf16 v[60:63], v[200:203], a[12:15], 0
    buffer_load_dwordx4 v237, s[4:7], s46 offen lds
    s_mul_i32 s77, s76, 46080
    v_mfma_f32_16x16x32_bf16 v[60:63], v[204:207], a[28:31], v[60:63]
    ds_read_b64_tr_b16 v[200:201], v232 offset:24576
    s_waitcnt lgkmcnt(3)
    v_mfma_f32_16x16x32_bf16 v[112:115], v[208:211], a[0:3], 0
    ds_read_b64_tr_b16 v[202:203], v232 offset:25088
    s_mul_i32 s78, s33, 1152
    v_mfma_f32_16x16x32_bf16 v[112:115], v[192:195], a[16:19], v[112:115]
    buffer_load_dwordx4 a[104:107], v240, s[16:19], s79 offen offset:0 sc1
    s_add_u32 s77, s77, s78
    v_mfma_f32_16x16x32_bf16 v[116:119], v[208:211], a[4:7], 0
    v_min_u32 v245, 4, v243
    v_mul_u32_u24 v245, 1152, v245
    v_mfma_f32_16x16x32_bf16 v[116:119], v[192:195], a[20:23], v[116:119]
    ds_read_b64_tr_b16 v[204:205], v232 offset:17408
    s_mul_i32 s78, s33, 576
    v_mfma_f32_16x16x32_bf16 v[120:123], v[208:211], a[8:11], 0
    ds_read_b64_tr_b16 v[206:207], v232 offset:17920
    s_mul_i32 s76, s76, 5
    v_mfma_f32_16x16x32_bf16 v[120:123], v[192:195], a[24:27], v[120:123]
    s_add_u32 m0, s37, 49152
    s_add_u32 s78, s78, s76
    v_mfma_f32_16x16x32_bf16 v[124:127], v[208:211], a[12:15], 0
    buffer_load_dwordx4 v237, s[8:11], s46 offen offset:1024 lds
    s_mul_i32 s78, s78, 1152
    v_mfma_f32_16x16x32_bf16 v[124:127], v[192:195], a[28:31], v[124:127]
    ds_read_b64_tr_b16 v[208:209], v232 offset:25600
    s_waitcnt vmcnt(13) lgkmcnt(3)
    v_mfma_f32_16x16x32_bf16 v[0:3], v[196:199], a[32:35], v[0:3]
    ds_read_b64_tr_b16 v[210:211], v232 offset:26112
    v_mfma_f32_16x16x32_bf16 v[0:3], v[200:203], a[48:51], v[0:3]
    buffer_load_dwordx4 a[108:111], v240, s[16:19], s79 offen offset:1024 sc1
    v_mfma_f32_16x16x32_bf16 v[4:7], v[196:199], a[36:39], v[4:7]
    v_mfma_f32_16x16x32_bf16 v[4:7], v[200:203], a[52:55], v[4:7]
    ds_read_b64_tr_b16 v[192:193], v233 offset:16384
    v_mfma_f32_16x16x32_bf16 v[8:11], v[196:199], a[40:43], v[8:11]
    ds_read_b64_tr_b16 v[194:195], v233 offset:16896
    v_mfma_f32_16x16x32_bf16 v[8:11], v[200:203], a[56:59], v[8:11]
    s_add_u32 m0, s37, 0
    v_mfma_f32_16x16x32_bf16 v[12:15], v[196:199], a[44:47], v[12:15]
    buffer_load_dwordx4 v237, s[4:7], s47 offen lds
    v_mfma_f32_16x16x32_bf16 v[12:15], v[200:203], a[60:63], v[12:15]
    ds_read_b64_tr_b16 v[196:197], v233 offset:24576
    s_waitcnt lgkmcnt(3)
    v_mfma_f32_16x16x32_bf16 v[64:67], v[204:207], a[32:35], v[64:67]
    ds_read_b64_tr_b16 v[198:199], v233 offset:25088
    v_mfma_f32_16x16x32_bf16 v[64:67], v[208:211], a[48:51], v[64:67]
    buffer_load_dwordx4 a[112:115], v241, s[16:19], s39 offen offset:0 sc1
    v_mfma_f32_16x16x32_bf16 v[68:71], v[204:207], a[36:39], v[68:71]
    v_mfma_f32_16x16x32_bf16 v[68:71], v[208:211], a[52:55], v[68:71]
    ds_read_b64_tr_b16 v[200:201], v233 offset:17408
    v_mfma_f32_16x16x32_bf16 v[72:75], v[204:207], a[40:43], v[72:75]
    ds_read_b64_tr_b16 v[202:203], v233 offset:17920
    v_mfma_f32_16x16x32_bf16 v[72:75], v[208:211], a[56:59], v[72:75]
    s_add_u32 m0, s37, 0
    v_mfma_f32_16x16x32_bf16 v[76:79], v[204:207], a[44:47], v[76:79]
    buffer_load_dwordx4 v237, s[8:11], s47 offen offset:1024 lds
    v_mfma_f32_16x16x32_bf16 v[76:79], v[208:211], a[60:63], v[76:79]
    ds_read_b64_tr_b16 v[204:205], v233 offset:25600
    s_waitcnt lgkmcnt(3)
    v_mfma_f32_16x16x32_bf16 v[16:19], v[192:195], a[32:35], v[16:19]
    ds_read_b64_tr_b16 v[206:207], v233 offset:26112
    v_mfma_f32_16x16x32_bf16 v[16:19], v[196:199], a[48:51], v[16:19]
    buffer_load_dwordx4 a[116:119], v241, s[16:19], s39 offen offset:1024 sc1
    v_mfma_f32_16x16x32_bf16 v[20:23], v[192:195], a[36:39], v[20:23]
    v_mfma_f32_16x16x32_bf16 v[20:23], v[196:199], a[52:55], v[20:23]
    ds_read_b64_tr_b16 v[208:209], v234 offset:16384
    v_mfma_f32_16x16x32_bf16 v[24:27], v[192:195], a[40:43], v[24:27]
    ds_read_b64_tr_b16 v[210:211], v234 offset:16896
    v_mfma_f32_16x16x32_bf16 v[24:27], v[196:199], a[56:59], v[24:27]
    v_mfma_f32_16x16x32_bf16 v[28:31], v[192:195], a[44:47], v[28:31]
    buffer_load_dwordx4 a[120:123], v241, s[16:19], s79 offen offset:0 sc1
    v_mfma_f32_16x16x32_bf16 v[28:31], v[196:199], a[60:63], v[28:31]
    ds_read_b64_tr_b16 v[192:193], v234 offset:24576
    s_waitcnt lgkmcnt(3)
    v_mfma_f32_16x16x32_bf16 v[80:83], v[200:203], a[32:35], v[80:83]
    ds_read_b64_tr_b16 v[194:195], v234 offset:25088
    v_mfma_f32_16x16x32_bf16 v[80:83], v[204:207], a[48:51], v[80:83]
    v_mfma_f32_16x16x32_bf16 v[84:87], v[200:203], a[36:39], v[84:87]
    v_mfma_f32_16x16x32_bf16 v[84:87], v[204:207], a[52:55], v[84:87]
    ds_read_b64_tr_b16 v[196:197], v234 offset:17408
    buffer_load_dwordx4 a[124:127], v241, s[16:19], s79 offen offset:1024 sc1
    v_mfma_f32_16x16x32_bf16 v[88:91], v[200:203], a[40:43], v[88:91]
    ds_read_b64_tr_b16 v[198:199], v234 offset:17920
    s_add_u32 s39, s39, 8192
    v_mfma_f32_16x16x32_bf16 v[88:91], v[204:207], a[56:59], v[88:91]
    s_xor_b32 s79, s39, 2048
    v_mfma_f32_16x16x32_bf16 v[92:95], v[200:203], a[44:47], v[92:95]
    buffer_load_dwordx4 a[128:131], v240, s[16:19], s39 offen offset:0 sc1
    v_mfma_f32_16x16x32_bf16 v[92:95], v[204:207], a[60:63], v[92:95]
    ds_read_b64_tr_b16 v[200:201], v234 offset:25600
    s_waitcnt lgkmcnt(3)
    v_mfma_f32_16x16x32_bf16 v[32:35], v[208:211], a[32:35], v[32:35]
    ds_read_b64_tr_b16 v[202:203], v234 offset:26112
    v_mfma_f32_16x16x32_bf16 v[32:35], v[192:195], a[48:51], v[32:35]
    v_mfma_f32_16x16x32_bf16 v[36:39], v[208:211], a[36:39], v[36:39]
    v_mfma_f32_16x16x32_bf16 v[36:39], v[192:195], a[52:55], v[36:39]
    ds_read_b64_tr_b16 v[204:205], v235 offset:16384
    buffer_load_dwordx4 a[132:135], v240, s[16:19], s39 offen offset:1024 sc1
    v_mfma_f32_16x16x32_bf16 v[40:43], v[208:211], a[40:43], v[40:43]
    ds_read_b64_tr_b16 v[206:207], v235 offset:16896
    v_mfma_f32_16x16x32_bf16 v[40:43], v[192:195], a[56:59], v[40:43]
    v_mfma_f32_16x16x32_bf16 v[44:47], v[208:211], a[44:47], v[44:47]
    v_mfma_f32_16x16x32_bf16 v[44:47], v[192:195], a[60:63], v[44:47]
    ds_read_b64_tr_b16 v[208:209], v235 offset:24576
    s_waitcnt lgkmcnt(3)
    v_mfma_f32_16x16x32_bf16 v[96:99], v[196:199], a[32:35], v[96:99]
    ds_read_b64_tr_b16 v[210:211], v235 offset:25088
    buffer_load_dwordx4 a[136:139], v240, s[16:19], s79 offen offset:0 sc1
    v_mfma_f32_16x16x32_bf16 v[96:99], v[200:203], a[48:51], v[96:99]
    v_mfma_f32_16x16x32_bf16 v[100:103], v[196:199], a[36:39], v[100:103]
    v_mfma_f32_16x16x32_bf16 v[100:103], v[200:203], a[52:55], v[100:103]
    ds_read_b64_tr_b16 v[192:193], v235 offset:17408
    v_mfma_f32_16x16x32_bf16 v[104:107], v[196:199], a[40:43], v[104:107]
    ds_read_b64_tr_b16 v[194:195], v235 offset:17920
    v_mfma_f32_16x16x32_bf16 v[104:107], v[200:203], a[56:59], v[104:107]
    buffer_load_dwordx4 a[140:143], v240, s[16:19], s79 offen offset:1024 sc1
    v_mfma_f32_16x16x32_bf16 v[108:111], v[196:199], a[44:47], v[108:111]
    v_mfma_f32_16x16x32_bf16 v[108:111], v[200:203], a[60:63], v[108:111]
    ds_read_b64_tr_b16 v[196:197], v235 offset:25600
    s_waitcnt lgkmcnt(3)
    v_mfma_f32_16x16x32_bf16 v[48:51], v[204:207], a[32:35], v[48:51]
    ds_read_b64_tr_b16 v[198:199], v235 offset:26112
    v_mfma_f32_16x16x32_bf16 v[48:51], v[208:211], a[48:51], v[48:51]
    buffer_load_dwordx4 a[144:147], v241, s[16:19], s39 offen offset:0 sc1
    v_mfma_f32_16x16x32_bf16 v[52:55], v[204:207], a[36:39], v[52:55]
    s_waitcnt lgkmcnt(2)
    s_barrier
    v_mfma_f32_16x16x32_bf16 v[52:55], v[208:211], a[52:55], v[52:55]
    ds_read_b64_tr_b16 v[200:201], v232 offset:32768
    v_mfma_f32_16x16x32_bf16 v[56:59], v[204:207], a[40:43], v[56:59]
    ds_read_b64_tr_b16 v[202:203], v232 offset:33280
    v_mfma_f32_16x16x32_bf16 v[56:59], v[208:211], a[56:59], v[56:59]
    s_add_u32 m0, s37, 8192
    v_mfma_f32_16x16x32_bf16 v[60:63], v[204:207], a[44:47], v[60:63]
    buffer_load_dwordx4 v237, s[4:7], s48 offen lds
    v_mfma_f32_16x16x32_bf16 v[60:63], v[208:211], a[60:63], v[60:63]
    ds_read_b64_tr_b16 v[204:205], v232 offset:40960
    s_waitcnt lgkmcnt(3)
    v_mfma_f32_16x16x32_bf16 v[112:115], v[192:195], a[32:35], v[112:115]
    ds_read_b64_tr_b16 v[206:207], v232 offset:41472
    v_mfma_f32_16x16x32_bf16 v[112:115], v[196:199], a[48:51], v[112:115]
    buffer_load_dwordx4 a[148:151], v241, s[16:19], s39 offen offset:1024 sc1
    v_mfma_f32_16x16x32_bf16 v[116:119], v[192:195], a[36:39], v[116:119]
    v_mfma_f32_16x16x32_bf16 v[116:119], v[196:199], a[52:55], v[116:119]
    ds_read_b64_tr_b16 v[208:209], v232 offset:33792
    v_mfma_f32_16x16x32_bf16 v[120:123], v[192:195], a[40:43], v[120:123]
    ds_read_b64_tr_b16 v[210:211], v232 offset:34304
    v_mfma_f32_16x16x32_bf16 v[120:123], v[196:199], a[56:59], v[120:123]
    s_add_u32 m0, s37, 8192
    v_mfma_f32_16x16x32_bf16 v[124:127], v[192:195], a[44:47], v[124:127]
    buffer_load_dwordx4 v237, s[8:11], s48 offen offset:1024 lds
    v_mfma_f32_16x16x32_bf16 v[124:127], v[196:199], a[60:63], v[124:127]
    ds_read_b64_tr_b16 v[192:193], v232 offset:41984
    s_waitcnt vmcnt(20) lgkmcnt(3)
    v_mfma_f32_16x16x32_bf16 v[0:3], v[200:203], a[64:67], v[0:3]
    ds_read_b64_tr_b16 v[194:195], v232 offset:42496
    v_mfma_f32_16x16x32_bf16 v[0:3], v[204:207], a[80:83], v[0:3]
    buffer_load_dwordx4 a[152:155], v241, s[16:19], s79 offen offset:0 sc1
    v_mfma_f32_16x16x32_bf16 v[4:7], v[200:203], a[68:71], v[4:7]
    v_mfma_f32_16x16x32_bf16 v[4:7], v[204:207], a[84:87], v[4:7]
    ds_read_b64_tr_b16 v[196:197], v233 offset:32768
    v_mfma_f32_16x16x32_bf16 v[8:11], v[200:203], a[72:75], v[8:11]
    ds_read_b64_tr_b16 v[198:199], v233 offset:33280
    v_mfma_f32_16x16x32_bf16 v[8:11], v[204:207], a[88:91], v[8:11]
    s_add_u32 m0, s37, 16384
    v_mfma_f32_16x16x32_bf16 v[12:15], v[200:203], a[76:79], v[12:15]
    buffer_load_dwordx4 v237, s[4:7], s49 offen lds
    v_mfma_f32_16x16x32_bf16 v[12:15], v[204:207], a[92:95], v[12:15]
    ds_read_b64_tr_b16 v[200:201], v233 offset:40960
    s_waitcnt lgkmcnt(3)
    v_mfma_f32_16x16x32_bf16 v[64:67], v[208:211], a[64:67], v[64:67]
    ds_read_b64_tr_b16 v[202:203], v233 offset:41472
    v_mfma_f32_16x16x32_bf16 v[64:67], v[192:195], a[80:83], v[64:67]
    buffer_load_dwordx4 a[156:159], v241, s[16:19], s79 offen offset:1024 sc1
    s_add_u32 s39, s39, 8192
    v_mfma_f32_16x16x32_bf16 v[68:71], v[208:211], a[68:71], v[68:71]
    s_xor_b32 s79, s39, 2048
    v_mfma_f32_16x16x32_bf16 v[68:71], v[192:195], a[84:87], v[68:71]
    ds_read_b64_tr_b16 v[204:205], v233 offset:33792
    v_mfma_f32_16x16x32_bf16 v[72:75], v[208:211], a[72:75], v[72:75]
    ds_read_b64_tr_b16 v[206:207], v233 offset:34304
    v_mfma_f32_16x16x32_bf16 v[72:75], v[192:195], a[88:91], v[72:75]
    s_add_u32 m0, s37, 16384
    v_mfma_f32_16x16x32_bf16 v[76:79], v[208:211], a[76:79], v[76:79]
    buffer_load_dwordx4 v237, s[8:11], s49 offen offset:1024 lds
    v_mfma_f32_16x16x32_bf16 v[76:79], v[192:195], a[92:95], v[76:79]
    ds_read_b64_tr_b16 v[208:209], v233 offset:41984
    s_waitcnt lgkmcnt(3)
    v_mfma_f32_16x16x32_bf16 v[16:19], v[196:199], a[64:67], v[16:19]
    ds_read_b64_tr_b16 v[210:211], v233 offset:42496
    v_mfma_f32_16x16x32_bf16 v[16:19], v[200:203], a[80:83], v[16:19]
    buffer_load_dwordx4 a[160:163], v240, s[16:19], s39 offen offset:0 sc1
    v_mfma_f32_16x16x32_bf16 v[20:23], v[196:199], a[68:71], v[20:23]
    v_mfma_f32_16x16x32_bf16 v[20:23], v[200:203], a[84:87], v[20:23]
    ds_read_b64_tr_b16 v[192:193], v234 offset:32768
    v_mfma_f32_16x16x32_bf16 v[24:27], v[196:199], a[72:75], v[24:27]
    ds_read_b64_tr_b16 v[194:195], v234 offset:33280
    v_mfma_f32_16x16x32_bf16 v[24:27], v[200:203], a[88:91], v[24:27]
    v_mfma_f32_16x16x32_bf16 v[28:31], v[196:199], a[76:79], v[28:31]
    buffer_load_dwordx4 a[164:167], v240, s[16:19], s39 offen offset:1024 sc1
    v_mfma_f32_16x16x32_bf16 v[28:31], v[200:203], a[92:95], v[28:31]
    ds_read_b64_tr_b16 v[196:197], v234 offset:40960
    s_waitcnt lgkmcnt(3)
    v_mfma_f32_16x16x32_bf16 v[80:83], v[204:207], a[64:67], v[80:83]
    ds_read_b64_tr_b16 v[198:199], v234 offset:41472
    v_mfma_f32_16x16x32_bf16 v[80:83], v[208:211], a[80:83], v[80:83]
    v_mfma_f32_16x16x32_bf16 v[84:87], v[204:207], a[68:71], v[84:87]
    v_mfma_f32_16x16x32_bf16 v[84:87], v[208:211], a[84:87], v[84:87]
    ds_read_b64_tr_b16 v[200:201], v234 offset:33792
    buffer_load_dwordx4 a[168:171], v240, s[16:19], s79 offen offset:0 sc1
    v_mfma_f32_16x16x32_bf16 v[88:91], v[204:207], a[72:75], v[88:91]
    ds_read_b64_tr_b16 v[202:203], v234 offset:34304
    v_mfma_f32_16x16x32_bf16 v[88:91], v[208:211], a[88:91], v[88:91]
    v_mfma_f32_16x16x32_bf16 v[92:95], v[204:207], a[76:79], v[92:95]
    v_mfma_f32_16x16x32_bf16 v[92:95], v[208:211], a[92:95], v[92:95]
    ds_read_b64_tr_b16 v[204:205], v234 offset:41984
    s_waitcnt lgkmcnt(3)
    v_mfma_f32_16x16x32_bf16 v[32:35], v[192:195], a[64:67], v[32:35]
    ds_read_b64_tr_b16 v[206:207], v234 offset:42496
    buffer_load_dwordx4 a[172:175], v240, s[16:19], s79 offen offset:1024 sc1
    v_mfma_f32_16x16x32_bf16 v[32:35], v[196:199], a[80:83], v[32:35]
    v_mfma_f32_16x16x32_bf16 v[36:39], v[192:195], a[68:71], v[36:39]
    v_mfma_f32_16x16x32_bf16 v[36:39], v[196:199], a[84:87], v[36:39]
    ds_read_b64_tr_b16 v[208:209], v235 offset:32768
    buffer_load_dwordx4 a[176:179], v241, s[16:19], s39 offen offset:0 sc1
    v_mfma_f32_16x16x32_bf16 v[40:43], v[192:195], a[72:75], v[40:43]
    ds_read_b64_tr_b16 v[210:211], v235 offset:33280
    v_mfma_f32_16x16x32_bf16 v[40:43], v[196:199], a[88:91], v[40:43]
    v_mfma_f32_16x16x32_bf16 v[44:47], v[192:195], a[76:79], v[44:47]
    v_mfma_f32_16x16x32_bf16 v[44:47], v[196:199], a[92:95], v[44:47]
    ds_read_b64_tr_b16 v[192:193], v235 offset:40960
    s_waitcnt lgkmcnt(3)
    v_mfma_f32_16x16x32_bf16 v[96:99], v[200:203], a[64:67], v[96:99]
    ds_read_b64_tr_b16 v[194:195], v235 offset:41472
    buffer_load_dwordx4 a[180:183], v241, s[16:19], s39 offen offset:1024 sc1
    v_mfma_f32_16x16x32_bf16 v[96:99], v[204:207], a[80:83], v[96:99]
    v_mfma_f32_16x16x32_bf16 v[100:103], v[200:203], a[68:71], v[100:103]
    v_mfma_f32_16x16x32_bf16 v[100:103], v[204:207], a[84:87], v[100:103]
    ds_read_b64_tr_b16 v[196:197], v235 offset:33792
    v_mfma_f32_16x16x32_bf16 v[104:107], v[200:203], a[72:75], v[104:107]
    ds_read_b64_tr_b16 v[198:199], v235 offset:34304
    v_mfma_f32_16x16x32_bf16 v[104:107], v[204:207], a[88:91], v[104:107]
    buffer_load_dwordx4 a[184:187], v241, s[16:19], s79 offen offset:0 sc1
    v_mfma_f32_16x16x32_bf16 v[108:111], v[200:203], a[76:79], v[108:111]
    v_mfma_f32_16x16x32_bf16 v[108:111], v[204:207], a[92:95], v[108:111]
    ds_read_b64_tr_b16 v[200:201], v235 offset:41984
    s_waitcnt lgkmcnt(3)
    v_mfma_f32_16x16x32_bf16 v[48:51], v[208:211], a[64:67], v[48:51]
    ds_read_b64_tr_b16 v[202:203], v235 offset:42496
    v_mfma_f32_16x16x32_bf16 v[48:51], v[192:195], a[80:83], v[48:51]
    v_mfma_f32_16x16x32_bf16 v[52:55], v[208:211], a[68:71], v[52:55]
    s_waitcnt vmcnt(22) lgkmcnt(2)
    s_barrier
    v_mfma_f32_16x16x32_bf16 v[52:55], v[192:195], a[84:87], v[52:55]
    ds_read_b64_tr_b16 v[204:205], v232 offset:49152
    buffer_load_dwordx4 a[188:191], v241, s[16:19], s79 offen offset:1024 sc1
    v_mfma_f32_16x16x32_bf16 v[56:59], v[208:211], a[72:75], v[56:59]
    ds_read_b64_tr_b16 v[206:207], v232 offset:49664
    s_add_u32 s39, s39, 8192
    v_mfma_f32_16x16x32_bf16 v[56:59], v[192:195], a[88:91], v[56:59]
    s_add_u32 m0, s37, 24576
    s_xor_b32 s79, s39, 2048
    v_mfma_f32_16x16x32_bf16 v[60:63], v[208:211], a[76:79], v[60:63]
    buffer_load_dwordx4 v237, s[4:7], s50 offen lds
    v_mfma_f32_16x16x32_bf16 v[60:63], v[192:195], a[92:95], v[60:63]
    ds_read_b64_tr_b16 v[208:209], v232 offset:0
    s_waitcnt lgkmcnt(3)
    v_mfma_f32_16x16x32_bf16 v[112:115], v[196:199], a[64:67], v[112:115]
    ds_read_b64_tr_b16 v[210:211], v232 offset:512
    v_mfma_f32_16x16x32_bf16 v[112:115], v[200:203], a[80:83], v[112:115]
    buffer_load_dwordx4 a[192:195], v240, s[16:19], s39 offen offset:0 sc1
    v_mfma_f32_16x16x32_bf16 v[116:119], v[196:199], a[68:71], v[116:119]
    v_mfma_f32_16x16x32_bf16 v[116:119], v[200:203], a[84:87], v[116:119]
    ds_read_b64_tr_b16 v[192:193], v232 offset:50176
    v_mfma_f32_16x16x32_bf16 v[120:123], v[196:199], a[72:75], v[120:123]
    ds_read_b64_tr_b16 v[194:195], v232 offset:50688
    v_mfma_f32_16x16x32_bf16 v[120:123], v[200:203], a[88:91], v[120:123]
    s_add_u32 m0, s37, 24576
    v_mfma_f32_16x16x32_bf16 v[124:127], v[196:199], a[76:79], v[124:127]
    buffer_load_dwordx4 v237, s[8:11], s50 offen offset:1024 lds
    v_mfma_f32_16x16x32_bf16 v[124:127], v[200:203], a[92:95], v[124:127]
    ds_read_b64_tr_b16 v[196:197], v232 offset:1024
    s_waitcnt vmcnt(23) lgkmcnt(3)
    v_mfma_f32_16x16x32_bf16 v[0:3], v[204:207], a[96:99], v[0:3]
    ds_read_b64_tr_b16 v[198:199], v232 offset:1536
    v_mfma_f32_16x16x32_bf16 v[0:3], v[208:211], a[112:115], v[0:3]
    buffer_load_dwordx4 a[196:199], v240, s[16:19], s39 offen offset:1024 sc1
    v_mfma_f32_16x16x32_bf16 v[4:7], v[204:207], a[100:103], v[4:7]
    v_mfma_f32_16x16x32_bf16 v[4:7], v[208:211], a[116:119], v[4:7]
    ds_read_b64_tr_b16 v[200:201], v233 offset:49152
    v_mfma_f32_16x16x32_bf16 v[8:11], v[204:207], a[104:107], v[8:11]
    ds_read_b64_tr_b16 v[202:203], v233 offset:49664
    v_mfma_f32_16x16x32_bf16 v[8:11], v[208:211], a[120:123], v[8:11]
    s_add_u32 m0, s37, 32768
    v_mfma_f32_16x16x32_bf16 v[12:15], v[204:207], a[108:111], v[12:15]
    buffer_load_dwordx4 v237, s[4:7], s51 offen lds
    v_mfma_f32_16x16x32_bf16 v[12:15], v[208:211], a[124:127], v[12:15]
    ds_read_b64_tr_b16 v[204:205], v233 offset:0
    s_waitcnt lgkmcnt(3)
    v_mfma_f32_16x16x32_bf16 v[64:67], v[192:195], a[96:99], v[64:67]
    ds_read_b64_tr_b16 v[206:207], v233 offset:512
    v_mfma_f32_16x16x32_bf16 v[64:67], v[196:199], a[112:115], v[64:67]
    buffer_load_dwordx4 a[200:203], v240, s[16:19], s79 offen offset:0 sc1
    v_mfma_f32_16x16x32_bf16 v[68:71], v[192:195], a[100:103], v[68:71]
    v_mfma_f32_16x16x32_bf16 v[68:71], v[196:199], a[116:119], v[68:71]
    ds_read_b64_tr_b16 v[208:209], v233 offset:50176
    v_mfma_f32_16x16x32_bf16 v[72:75], v[192:195], a[104:107], v[72:75]
    ds_read_b64_tr_b16 v[210:211], v233 offset:50688
    v_mfma_f32_16x16x32_bf16 v[72:75], v[196:199], a[120:123], v[72:75]
    s_add_u32 m0, s37, 32768
    v_mfma_f32_16x16x32_bf16 v[76:79], v[192:195], a[108:111], v[76:79]
    buffer_load_dwordx4 v237, s[8:11], s51 offen offset:1024 lds
    v_mfma_f32_16x16x32_bf16 v[76:79], v[196:199], a[124:127], v[76:79]
    ds_read_b64_tr_b16 v[192:193], v233 offset:1024
    s_waitcnt lgkmcnt(3)
    v_mfma_f32_16x16x32_bf16 v[16:19], v[200:203], a[96:99], v[16:19]
    ds_read_b64_tr_b16 v[194:195], v233 offset:1536
    v_mfma_f32_16x16x32_bf16 v[16:19], v[204:207], a[112:115], v[16:19]
    buffer_load_dwordx4 a[204:207], v240, s[16:19], s79 offen offset:1024 sc1
    v_mfma_f32_16x16x32_bf16 v[20:23], v[200:203], a[100:103], v[20:23]
    v_mfma_f32_16x16x32_bf16 v[20:23], v[204:207], a[116:119], v[20:23]
    ds_read_b64_tr_b16 v[196:197], v234 offset:49152
    v_mfma_f32_16x16x32_bf16 v[24:27], v[200:203], a[104:107], v[24:27]
    ds_read_b64_tr_b16 v[198:199], v234 offset:49664
    buffer_load_dwordx4 a[208:211], v241, s[16:19], s39 offen offset:0 sc1
    v_mfma_f32_16x16x32_bf16 v[24:27], v[204:207], a[120:123], v[24:27]
    v_mfma_f32_16x16x32_bf16 v[28:31], v[200:203], a[108:111], v[28:31]
    v_mfma_f32_16x16x32_bf16 v[28:31], v[204:207], a[124:127], v[28:31]
    ds_read_b64_tr_b16 v[200:201], v234 offset:0
    s_waitcnt lgkmcnt(3)
    v_mfma_f32_16x16x32_bf16 v[80:83], v[208:211], a[96:99], v[80:83]
    ds_read_b64_tr_b16 v[202:203], v234 offset:512
    v_mfma_f32_16x16x32_bf16 v[80:83], v[192:195], a[112:115], v[80:83]
    buffer_load_dwordx4 a[212:215], v241, s[16:19], s39 offen offset:1024 sc1
    v_mfma_f32_16x16x32_bf16 v[84:87], v[208:211], a[100:103], v[84:87]
    v_mfma_f32_16x16x32_bf16 v[84:87], v[192:195], a[116:119], v[84:87]
    ds_read_b64_tr_b16 v[204:205], v234 offset:50176
    v_mfma_f32_16x16x32_bf16 v[88:91], v[208:211], a[104:107], v[88:91]
    ds_read_b64_tr_b16 v[206:207], v234 offset:50688
    v_mfma_f32_16x16x32_bf16 v[88:91], v[192:195], a[120:123], v[88:91]
    v_mfma_f32_16x16x32_bf16 v[92:95], v[208:211], a[108:111], v[92:95]
    buffer_load_dwordx4 a[216:219], v241, s[16:19], s79 offen offset:0 sc1
    v_mfma_f32_16x16x32_bf16 v[92:95], v[192:195], a[124:127], v[92:95]
    ds_read_b64_tr_b16 v[208:209], v234 offset:1024
    s_waitcnt lgkmcnt(3)
    v_mfma_f32_16x16x32_bf16 v[32:35], v[196:199], a[96:99], v[32:35]
    ds_read_b64_tr_b16 v[210:211], v234 offset:1536
    v_mfma_f32_16x16x32_bf16 v[32:35], v[200:203], a[112:115], v[32:35]
    buffer_load_dword v212, v244, s[4:7], s77 offen offset:640
    v_mfma_f32_16x16x32_bf16 v[36:39], v[196:199], a[100:103], v[36:39]
    v_mfma_f32_16x16x32_bf16 v[36:39], v[200:203], a[116:119], v[36:39]
    ds_read_b64_tr_b16 v[192:193], v235 offset:49152
    buffer_load_dwordx4 a[220:223], v241, s[16:19], s79 offen offset:1024 sc1
    v_mfma_f32_16x16x32_bf16 v[40:43], v[196:199], a[104:107], v[40:43]
    ds_read_b64_tr_b16 v[194:195], v235 offset:49664
    s_add_u32 s39, s39, 8192
    v_mfma_f32_16x16x32_bf16 v[40:43], v[200:203], a[120:123], v[40:43]
    buffer_load_dword v213, v244, s[8:11], s77 offen offset:1664
    v_mfma_f32_16x16x32_bf16 v[44:47], v[196:199], a[108:111], v[44:47]
    v_mfma_f32_16x16x32_bf16 v[44:47], v[200:203], a[124:127], v[44:47]
    ds_read_b64_tr_b16 v[196:197], v235 offset:0
    s_waitcnt lgkmcnt(3)
    v_mfma_f32_16x16x32_bf16 v[96:99], v[204:207], a[96:99], v[96:99]
    ds_read_b64_tr_b16 v[198:199], v235 offset:512
    v_mfma_f32_16x16x32_bf16 v[96:99], v[208:211], a[112:115], v[96:99]
    buffer_load_dword v214, v245, s[20:23], s78 offen offset:1024
    v_mfma_f32_16x16x32_bf16 v[100:103], v[204:207], a[100:103], v[100:103]
    v_mfma_f32_16x16x32_bf16 v[100:103], v[208:211], a[116:119], v[100:103]
    ds_read_b64_tr_b16 v[200:201], v235 offset:50176
    v_mfma_f32_16x16x32_bf16 v[104:107], v[204:207], a[104:107], v[104:107]
    ds_read_b64_tr_b16 v[202:203], v235 offset:50688
    v_mfma_f32_16x16x32_bf16 v[104:107], v[208:211], a[120:123], v[104:107]
    v_mfma_f32_16x16x32_bf16 v[108:111], v[204:207], a[108:111], v[108:111]
    v_mfma_f32_16x16x32_bf16 v[108:111], v[208:211], a[124:127], v[108:111]
    ds_read_b64_tr_b16 v[204:205], v235 offset:1024
    s_waitcnt lgkmcnt(3)
    v_mfma_f32_16x16x32_bf16 v[48:51], v[192:195], a[96:99], v[48:51]
    ds_read_b64_tr_b16 v[206:207], v235 offset:1536
    v_mfma_f32_16x16x32_bf16 v[48:51], v[196:199], a[112:115], v[48:51]
    v_mfma_f32_16x16x32_bf16 v[52:55], v[192:195], a[100:103], v[52:55]
    s_waitcnt vmcnt(23) lgkmcnt(2)
    s_barrier
    v_mfma_f32_16x16x32_bf16 v[52:55], v[196:199], a[116:119], v[52:55]
    ds_read_b64_tr_b16 v[208:209], v232 offset:8192
    v_mfma_f32_16x16x32_bf16 v[56:59], v[192:195], a[104:107], v[56:59]
    ds_read_b64_tr_b16 v[210:211], v232 offset:8704
    v_mfma_f32_16x16x32_bf16 v[56:59], v[196:199], a[120:123], v[56:59]
    s_add_u32 m0, s37, 40960
    v_mfma_f32_16x16x32_bf16 v[60:63], v[192:195], a[108:111], v[60:63]
    buffer_load_dwordx4 v237, s[4:7], s52 offen lds
    v_mfma_f32_16x16x32_bf16 v[60:63], v[196:199], a[124:127], v[60:63]
    ds_read_b64_tr_b16 v[192:193], v232 offset:16384
    s_waitcnt lgkmcnt(3)
    v_mfma_f32_16x16x32_bf16 v[112:115], v[200:203], a[96:99], v[112:115]
    ds_read_b64_tr_b16 v[194:195], v232 offset:16896
    v_mfma_f32_16x16x32_bf16 v[112:115], v[204:207], a[112:115], v[112:115]
    v_mfma_f32_16x16x32_bf16 v[116:119], v[200:203], a[100:103], v[116:119]
    v_mfma_f32_16x16x32_bf16 v[116:119], v[204:207], a[116:119], v[116:119]
    ds_read_b64_tr_b16 v[196:197], v232 offset:9216
    v_mfma_f32_16x16x32_bf16 v[120:123], v[200:203], a[104:107], v[120:123]
    ds_read_b64_tr_b16 v[198:199], v232 offset:9728
    v_mfma_f32_16x16x32_bf16 v[120:123], v[204:207], a[120:123], v[120:123]
    s_add_u32 m0, s37, 40960
    v_mfma_f32_16x16x32_bf16 v[124:127], v[200:203], a[108:111], v[124:127]
    buffer_load_dwordx4 v237, s[8:11], s52 offen offset:1024 lds
    v_mfma_f32_16x16x32_bf16 v[124:127], v[204:207], a[124:127], v[124:127]
    ds_read_b64_tr_b16 v[200:201], v232 offset:17408
    s_waitcnt lgkmcnt(3)
    v_mfma_f32_16x16x32_bf16 v[0:3], v[208:211], a[128:131], v[0:3]
    ds_read_b64_tr_b16 v[202:203], v232 offset:17920
    v_mfma_f32_16x16x32_bf16 v[0:3], v[192:195], a[144:147], v[0:3]
    v_mfma_f32_16x16x32_bf16 v[4:7], v[208:211], a[132:135], v[4:7]
    v_mfma_f32_16x16x32_bf16 v[4:7], v[192:195], a[148:151], v[4:7]
    ds_read_b64_tr_b16 v[204:205], v233 offset:8192
    v_mfma_f32_16x16x32_bf16 v[8:11], v[208:211], a[136:139], v[8:11]
    ds_read_b64_tr_b16 v[206:207], v233 offset:8704
    v_mfma_f32_16x16x32_bf16 v[8:11], v[192:195], a[152:155], v[8:11]
    s_add_u32 m0, s37, 49152
    v_mfma_f32_16x16x32_bf16 v[12:15], v[208:211], a[140:143], v[12:15]
    buffer_load_dwordx4 v237, s[4:7], s53 offen lds
    v_mfma_f32_16x16x32_bf16 v[12:15], v[192:195], a[156:159], v[12:15]
    ds_read_b64_tr_b16 v[208:209], v233 offset:16384
    s_waitcnt lgkmcnt(3)
    v_mfma_f32_16x16x32_bf16 v[64:67], v[196:199], a[128:131], v[64:67]
    ds_read_b64_tr_b16 v[210:211], v233 offset:16896
    v_mfma_f32_16x16x32_bf16 v[64:67], v[200:203], a[144:147], v[64:67]
    v_mfma_f32_16x16x32_bf16 v[68:71], v[196:199], a[132:135], v[68:71]
    v_mfma_f32_16x16x32_bf16 v[68:71], v[200:203], a[148:151], v[68:71]
    ds_read_b64_tr_b16 v[192:193], v233 offset:9216
    v_mfma_f32_16x16x32_bf16 v[72:75], v[196:199], a[136:139], v[72:75]
    ds_read_b64_tr_b16 v[194:195], v233 offset:9728
    v_mfma_f32_16x16x32_bf16 v[72:75], v[200:203], a[152:155], v[72:75]
    s_add_u32 m0, s37, 49152
    v_mfma_f32_16x16x32_bf16 v[76:79], v[196:199], a[140:143], v[76:79]
    buffer_load_dwordx4 v237, s[8:11], s53 offen offset:1024 lds
    v_mfma_f32_16x16x32_bf16 v[76:79], v[200:203], a[156:159], v[76:79]
    ds_read_b64_tr_b16 v[196:197], v233 offset:17408
    s_waitcnt lgkmcnt(3)
    v_mfma_f32_16x16x32_bf16 v[16:19], v[204:207], a[128:131], v[16:19]
    ds_read_b64_tr_b16 v[198:199], v233 offset:17920
    v_mfma_f32_16x16x32_bf16 v[16:19], v[208:211], a[144:147], v[16:19]
    v_mfma_f32_16x16x32_bf16 v[20:23], v[204:207], a[132:135], v[20:23]
    v_mfma_f32_16x16x32_bf16 v[20:23], v[208:211], a[148:151], v[20:23]
    ds_read_b64_tr_b16 v[200:201], v234 offset:8192
    v_mfma_f32_16x16x32_bf16 v[24:27], v[204:207], a[136:139], v[24:27]
    ds_read_b64_tr_b16 v[202:203], v234 offset:8704
    v_mfma_f32_16x16x32_bf16 v[24:27], v[208:211], a[152:155], v[24:27]
    v_mfma_f32_16x16x32_bf16 v[28:31], v[204:207], a[140:143], v[28:31]
    v_mfma_f32_16x16x32_bf16 v[28:31], v[208:211], a[156:159], v[28:31]
    ds_read_b64_tr_b16 v[204:205], v234 offset:16384
    s_waitcnt lgkmcnt(3)
    v_mfma_f32_16x16x32_bf16 v[80:83], v[192:195], a[128:131], v[80:83]
    ds_read_b64_tr_b16 v[206:207], v234 offset:16896
    v_mfma_f32_16x16x32_bf16 v[80:83], v[196:199], a[144:147], v[80:83]
    v_mfma_f32_16x16x32_bf16 v[84:87], v[192:195], a[132:135], v[84:87]
    v_mfma_f32_16x16x32_bf16 v[84:87], v[196:199], a[148:151], v[84:87]
    ds_read_b64_tr_b16 v[208:209], v234 offset:9216
    v_mfma_f32_16x16x32_bf16 v[88:91], v[192:195], a[136:139], v[88:91]
    ds_read_b64_tr_b16 v[210:211], v234 offset:9728
    v_mfma_f32_16x16x32_bf16 v[88:91], v[196:199], a[152:155], v[88:91]
    v_mfma_f32_16x16x32_bf16 v[92:95], v[192:195], a[140:143], v[92:95]
    v_mfma_f32_16x16x32_bf16 v[92:95], v[196:199], a[156:159], v[92:95]
    ds_read_b64_tr_b16 v[192:193], v234 offset:17408
    s_waitcnt lgkmcnt(3)
    v_mfma_f32_16x16x32_bf16 v[32:35], v[200:203], a[128:131], v[32:35]
    ds_read_b64_tr_b16 v[194:195], v234 offset:17920
    v_mfma_f32_16x16x32_bf16 v[32:35], v[204:207], a[144:147], v[32:35]
    v_mfma_f32_16x16x32_bf16 v[36:39], v[200:203], a[132:135], v[36:39]
    v_mfma_f32_16x16x32_bf16 v[36:39], v[204:207], a[148:151], v[36:39]
    ds_read_b64_tr_b16 v[196:197], v235 offset:8192
    v_mfma_f32_16x16x32_bf16 v[40:43], v[200:203], a[136:139], v[40:43]
    ds_read_b64_tr_b16 v[198:199], v235 offset:8704
    v_mfma_f32_16x16x32_bf16 v[40:43], v[204:207], a[152:155], v[40:43]
    v_mfma_f32_16x16x32_bf16 v[44:47], v[200:203], a[140:143], v[44:47]
    v_mfma_f32_16x16x32_bf16 v[44:47], v[204:207], a[156:159], v[44:47]
    ds_read_b64_tr_b16 v[200:201], v235 offset:16384
    s_waitcnt lgkmcnt(3)
    v_mfma_f32_16x16x32_bf16 v[96:99], v[208:211], a[128:131], v[96:99]
    ds_read_b64_tr_b16 v[202:203], v235 offset:16896
    v_mfma_f32_16x16x32_bf16 v[96:99], v[192:195], a[144:147], v[96:99]
    v_mfma_f32_16x16x32_bf16 v[100:103], v[208:211], a[132:135], v[100:103]
    v_mfma_f32_16x16x32_bf16 v[100:103], v[192:195], a[148:151], v[100:103]
    ds_read_b64_tr_b16 v[204:205], v235 offset:9216
    v_mfma_f32_16x16x32_bf16 v[104:107], v[208:211], a[136:139], v[104:107]
    ds_read_b64_tr_b16 v[206:207], v235 offset:9728
    s_xor_b32 s79, s39, 2048
    v_mfma_f32_16x16x32_bf16 v[104:107], v[192:195], a[152:155], v[104:107]
    buffer_load_dwordx4 a[224:227], v240, s[16:19], s39 offen offset:0 sc1
    v_mfma_f32_16x16x32_bf16 v[108:111], v[208:211], a[140:143], v[108:111]
    v_mfma_f32_16x16x32_bf16 v[108:111], v[192:195], a[156:159], v[108:111]
    ds_read_b64_tr_b16 v[208:209], v235 offset:17408
    s_waitcnt lgkmcnt(3)
    v_mfma_f32_16x16x32_bf16 v[48:51], v[196:199], a[128:131], v[48:51]
    ds_read_b64_tr_b16 v[210:211], v235 offset:17920
    v_mfma_f32_16x16x32_bf16 v[48:51], v[200:203], a[144:147], v[48:51]
    v_mfma_f32_16x16x32_bf16 v[52:55], v[196:199], a[132:135], v[52:55]
    s_waitcnt vmcnt(13) lgkmcnt(2)
    s_barrier
    v_mfma_f32_16x16x32_bf16 v[52:55], v[200:203], a[148:151], v[52:55]
    ds_read_b64_tr_b16 v[192:193], v232 offset:24576
    buffer_load_dwordx4 a[228:231], v240, s[16:19], s39 offen offset:1024 sc1
    v_mfma_f32_16x16x32_bf16 v[56:59], v[196:199], a[136:139], v[56:59]
    ds_read_b64_tr_b16 v[194:195], v232 offset:25088
    v_mfma_f32_16x16x32_bf16 v[56:59], v[200:203], a[152:155], v[56:59]
    s_add_u32 m0, s37, 0
    v_mfma_f32_16x16x32_bf16 v[60:63], v[196:199], a[140:143], v[60:63]
    buffer_load_dwordx4 v237, s[4:7], s54 offen lds
    v_mfma_f32_16x16x32_bf16 v[60:63], v[200:203], a[156:159], v[60:63]
    ds_read_b64_tr_b16 v[196:197], v232 offset:32768
    s_waitcnt lgkmcnt(3)
    v_mfma_f32_16x16x32_bf16 v[112:115], v[204:207], a[128:131], v[112:115]
    ds_read_b64_tr_b16 v[198:199], v232 offset:33280
    v_mfma_f32_16x16x32_bf16 v[112:115], v[208:211], a[144:147], v[112:115]
    buffer_load_dwordx4 a[232:235], v240, s[16:19], s79 offen offset:0 sc1
    v_mfma_f32_16x16x32_bf16 v[116:119], v[204:207], a[132:135], v[116:119]
    v_mfma_f32_16x16x32_bf16 v[116:119], v[208:211], a[148:151], v[116:119]
    ds_read_b64_tr_b16 v[200:201], v232 offset:25600
    v_mfma_f32_16x16x32_bf16 v[120:123], v[204:207], a[136:139], v[120:123]
    ds_read_b64_tr_b16 v[202:203], v232 offset:26112
    v_mfma_f32_16x16x32_bf16 v[120:123], v[208:211], a[152:155], v[120:123]
    s_add_u32 m0, s37, 0
    v_mfma_f32_16x16x32_bf16 v[124:127], v[204:207], a[140:143], v[124:127]
    buffer_load_dwordx4 v237, s[8:11], s54 offen offset:1024 lds
    v_mfma_f32_16x16x32_bf16 v[124:127], v[208:211], a[156:159], v[124:127]
    ds_read_b64_tr_b16 v[204:205], v232 offset:33792
    s_waitcnt lgkmcnt(3)
    v_mfma_f32_16x16x32_bf16 v[0:3], v[192:195], a[160:163], v[0:3]
    ds_read_b64_tr_b16 v[206:207], v232 offset:34304
    v_mfma_f32_16x16x32_bf16 v[0:3], v[196:199], a[176:179], v[0:3]
    buffer_load_dwordx4 a[236:239], v240, s[16:19], s79 offen offset:1024 sc1
    v_mfma_f32_16x16x32_bf16 v[4:7], v[192:195], a[164:167], v[4:7]
    v_mfma_f32_16x16x32_bf16 v[4:7], v[196:199], a[180:183], v[4:7]
    ds_read_b64_tr_b16 v[208:209], v233 offset:24576
    v_mfma_f32_16x16x32_bf16 v[8:11], v[192:195], a[168:171], v[8:11]
    ds_read_b64_tr_b16 v[210:211], v233 offset:25088
    v_mfma_f32_16x16x32_bf16 v[8:11], v[196:199], a[184:187], v[8:11]
    s_add_u32 m0, s37, 8192
    v_mfma_f32_16x16x32_bf16 v[12:15], v[192:195], a[172:175], v[12:15]
    buffer_load_dwordx4 v237, s[4:7], s55 offen lds
    v_mfma_f32_16x16x32_bf16 v[12:15], v[196:199], a[188:191], v[12:15]
    ds_read_b64_tr_b16 v[192:193], v233 offset:32768
    s_waitcnt lgkmcnt(3)
    v_mfma_f32_16x16x32_bf16 v[64:67], v[200:203], a[160:163], v[64:67]
    ds_read_b64_tr_b16 v[194:195], v233 offset:33280
    v_mfma_f32_16x16x32_bf16 v[64:67], v[204:207], a[176:179], v[64:67]
    buffer_load_dwordx4 a[240:243], v241, s[16:19], s39 offen offset:0 sc1
    v_mfma_f32_16x16x32_bf16 v[68:71], v[200:203], a[164:167], v[68:71]
    v_mfma_f32_16x16x32_bf16 v[68:71], v[204:207], a[180:183], v[68:71]
    ds_read_b64_tr_b16 v[196:197], v233 offset:25600
    v_mfma_f32_16x16x32_bf16 v[72:75], v[200:203], a[168:171], v[72:75]
    ds_read_b64_tr_b16 v[198:199], v233 offset:26112
    v_mfma_f32_16x16x32_bf16 v[72:75], v[204:207], a[184:187], v[72:75]
    s_add_u32 m0, s37, 8192
    v_mfma_f32_16x16x32_bf16 v[76:79], v[200:203], a[172:175], v[76:79]
    buffer_load_dwordx4 v237, s[8:11], s55 offen offset:1024 lds
    v_mfma_f32_16x16x32_bf16 v[76:79], v[204:207], a[188:191], v[76:79]
    ds_read_b64_tr_b16 v[200:201], v233 offset:33792
    s_waitcnt lgkmcnt(3)
    v_mfma_f32_16x16x32_bf16 v[16:19], v[208:211], a[160:163], v[16:19]
    ds_read_b64_tr_b16 v[202:203], v233 offset:34304
    v_mfma_f32_16x16x32_bf16 v[16:19], v[192:195], a[176:179], v[16:19]
    buffer_load_dwordx4 a[244:247], v241, s[16:19], s39 offen offset:1024 sc1
    v_mfma_f32_16x16x32_bf16 v[20:23], v[208:211], a[164:167], v[20:23]
    v_mfma_f32_16x16x32_bf16 v[20:23], v[192:195], a[180:183], v[20:23]
    ds_read_b64_tr_b16 v[204:205], v234 offset:24576
    v_mfma_f32_16x16x32_bf16 v[24:27], v[208:211], a[168:171], v[24:27]
    ds_read_b64_tr_b16 v[206:207], v234 offset:25088
    v_mfma_f32_16x16x32_bf16 v[24:27], v[192:195], a[184:187], v[24:27]
    v_mfma_f32_16x16x32_bf16 v[28:31], v[208:211], a[172:175], v[28:31]
    buffer_load_dwordx4 a[248:251], v241, s[16:19], s79 offen offset:0 sc1
    v_mfma_f32_16x16x32_bf16 v[28:31], v[192:195], a[188:191], v[28:31]
    ds_read_b64_tr_b16 v[208:209], v234 offset:32768
    s_waitcnt lgkmcnt(3)
    v_mfma_f32_16x16x32_bf16 v[80:83], v[196:199], a[160:163], v[80:83]
    ds_read_b64_tr_b16 v[210:211], v234 offset:33280
    v_mfma_f32_16x16x32_bf16 v[80:83], v[200:203], a[176:179], v[80:83]
    v_mfma_f32_16x16x32_bf16 v[84:87], v[196:199], a[164:167], v[84:87]
    v_mfma_f32_16x16x32_bf16 v[84:87], v[200:203], a[180:183], v[84:87]
    ds_read_b64_tr_b16 v[192:193], v234 offset:25600
    buffer_load_dwordx4 a[252:255], v241, s[16:19], s79 offen offset:1024 sc1
    v_mfma_f32_16x16x32_bf16 v[88:91], v[196:199], a[168:171], v[88:91]
    ds_read_b64_tr_b16 v[194:195], v234 offset:26112
    s_add_u32 s39, s39, 8192
    v_mfma_f32_16x16x32_bf16 v[88:91], v[200:203], a[184:187], v[88:91]
    s_xor_b32 s79, s39, 2048
    v_mfma_f32_16x16x32_bf16 v[92:95], v[196:199], a[172:175], v[92:95]
    buffer_load_dwordx4 v[160:163], v240, s[16:19], s39 offen offset:0 sc1
    v_mfma_f32_16x16x32_bf16 v[92:95], v[200:203], a[188:191], v[92:95]
    ds_read_b64_tr_b16 v[196:197], v234 offset:33792
    s_waitcnt lgkmcnt(3)
    v_mfma_f32_16x16x32_bf16 v[32:35], v[204:207], a[160:163], v[32:35]
    ds_read_b64_tr_b16 v[198:199], v234 offset:34304
    v_mfma_f32_16x16x32_bf16 v[32:35], v[208:211], a[176:179], v[32:35]
    v_mfma_f32_16x16x32_bf16 v[36:39], v[204:207], a[164:167], v[36:39]
    v_mfma_f32_16x16x32_bf16 v[36:39], v[208:211], a[180:183], v[36:39]
    ds_read_b64_tr_b16 v[200:201], v235 offset:24576
    buffer_load_dwordx4 v[164:167], v240, s[16:19], s39 offen offset:1024 sc1
    v_mfma_f32_16x16x32_bf16 v[40:43], v[204:207], a[168:171], v[40:43]
    ds_read_b64_tr_b16 v[202:203], v235 offset:25088
    v_mfma_f32_16x16x32_bf16 v[40:43], v[208:211], a[184:187], v[40:43]
    v_mfma_f32_16x16x32_bf16 v[44:47], v[204:207], a[172:175], v[44:47]
    v_mfma_f32_16x16x32_bf16 v[44:47], v[208:211], a[188:191], v[44:47]
    ds_read_b64_tr_b16 v[204:205], v235 offset:32768
    s_waitcnt lgkmcnt(3)
    v_mfma_f32_16x16x32_bf16 v[96:99], v[192:195], a[160:163], v[96:99]
    ds_read_b64_tr_b16 v[206:207], v235 offset:33280
    buffer_load_dwordx4 v[168:171], v240, s[16:19], s79 offen offset:0 sc1
    v_mfma_f32_16x16x32_bf16 v[96:99], v[196:199], a[176:179], v[96:99]
    v_mfma_f32_16x16x32_bf16 v[100:103], v[192:195], a[164:167], v[100:103]
    v_mfma_f32_16x16x32_bf16 v[100:103], v[196:199], a[180:183], v[100:103]
    ds_read_b64_tr_b16 v[208:209], v235 offset:25600
    v_mfma_f32_16x16x32_bf16 v[104:107], v[192:195], a[168:171], v[104:107]
    ds_read_b64_tr_b16 v[210:211], v235 offset:26112
    v_mfma_f32_16x16x32_bf16 v[104:107], v[196:199], a[184:187], v[104:107]
    buffer_load_dwordx4 v[172:175], v240, s[16:19], s79 offen offset:1024 sc1
    v_mfma_f32_16x16x32_bf16 v[108:111], v[192:195], a[172:175], v[108:111]
    v_mfma_f32_16x16x32_bf16 v[108:111], v[196:199], a[188:191], v[108:111]
    ds_read_b64_tr_b16 v[192:193], v235 offset:33792
    s_waitcnt lgkmcnt(3)
    v_mfma_f32_16x16x32_bf16 v[48:51], v[200:203], a[160:163], v[48:51]
    ds_read_b64_tr_b16 v[194:195], v235 offset:34304
    v_mfma_f32_16x16x32_bf16 v[48:51], v[204:207], a[176:179], v[48:51]
    buffer_load_dwordx4 v[176:179], v241, s[16:19], s39 offen offset:0 sc1
    v_mfma_f32_16x16x32_bf16 v[52:55], v[200:203], a[164:167], v[52:55]
    s_waitcnt vmcnt(17) lgkmcnt(2)
    s_barrier
    v_mfma_f32_16x16x32_bf16 v[52:55], v[204:207], a[180:183], v[52:55]
    ds_read_b64_tr_b16 v[196:197], v232 offset:40960
    v_mfma_f32_16x16x32_bf16 v[56:59], v[200:203], a[168:171], v[56:59]
    ds_read_b64_tr_b16 v[198:199], v232 offset:41472
    v_mfma_f32_16x16x32_bf16 v[56:59], v[204:207], a[184:187], v[56:59]
    s_add_u32 m0, s37, 16384
    v_mfma_f32_16x16x32_bf16 v[60:63], v[200:203], a[172:175], v[60:63]
    buffer_load_dwordx4 v237, s[4:7], s56 offen lds
    v_mfma_f32_16x16x32_bf16 v[60:63], v[204:207], a[188:191], v[60:63]
    ds_read_b64_tr_b16 v[200:201], v232 offset:49152
    s_waitcnt lgkmcnt(3)
    v_mfma_f32_16x16x32_bf16 v[112:115], v[208:211], a[160:163], v[112:115]
    ds_read_b64_tr_b16 v[202:203], v232 offset:49664
    v_mfma_f32_16x16x32_bf16 v[112:115], v[192:195], a[176:179], v[112:115]
    buffer_load_dwordx4 v[180:183], v241, s[16:19], s39 offen offset:1024 sc1
    v_mfma_f32_16x16x32_bf16 v[116:119], v[208:211], a[164:167], v[116:119]
    v_mfma_f32_16x16x32_bf16 v[116:119], v[192:195], a[180:183], v[116:119]
    ds_read_b64_tr_b16 v[204:205], v232 offset:41984
    v_mfma_f32_16x16x32_bf16 v[120:123], v[208:211], a[168:171], v[120:123]
    ds_read_b64_tr_b16 v[206:207], v232 offset:42496
    v_mfma_f32_16x16x32_bf16 v[120:123], v[192:195], a[184:187], v[120:123]
    s_add_u32 m0, s37, 16384
    v_mfma_f32_16x16x32_bf16 v[124:127], v[208:211], a[172:175], v[124:127]
    buffer_load_dwordx4 v237, s[8:11], s56 offen offset:1024 lds
    v_mfma_f32_16x16x32_bf16 v[124:127], v[192:195], a[188:191], v[124:127]
    ds_read_b64_tr_b16 v[208:209], v232 offset:50176
    s_waitcnt lgkmcnt(3)
    v_mfma_f32_16x16x32_bf16 v[0:3], v[196:199], a[192:195], v[0:3]
    ds_read_b64_tr_b16 v[210:211], v232 offset:50688
    v_mfma_f32_16x16x32_bf16 v[0:3], v[200:203], a[208:211], v[0:3]
    buffer_load_dwordx4 v[184:187], v241, s[16:19], s79 offen offset:0 sc1
    v_mfma_f32_16x16x32_bf16 v[4:7], v[196:199], a[196:199], v[4:7]
    v_mfma_f32_16x16x32_bf16 v[4:7], v[200:203], a[212:215], v[4:7]
    ds_read_b64_tr_b16 v[192:193], v233 offset:40960
    v_mfma_f32_16x16x32_bf16 v[8:11], v[196:199], a[200:203], v[8:11]
    ds_read_b64_tr_b16 v[194:195], v233 offset:41472
    v_mfma_f32_16x16x32_bf16 v[8:11], v[200:203], a[216:219], v[8:11]
    s_add_u32 m0, s37, 24576
    v_mfma_f32_16x16x32_bf16 v[12:15], v[196:199], a[204:207], v[12:15]
    buffer_load_dwordx4 v237, s[4:7], s57 offen lds
    v_mfma_f32_16x16x32_bf16 v[12:15], v[200:203], a[220:223], v[12:15]
    ds_read_b64_tr_b16 v[196:197], v233 offset:49152
    s_waitcnt lgkmcnt(3)
    v_mfma_f32_16x16x32_bf16 v[64:67], v[204:207], a[192:195], v[64:67]
    ds_read_b64_tr_b16 v[198:199], v233 offset:49664
    v_mfma_f32_16x16x32_bf16 v[64:67], v[208:211], a[208:211], v[64:67]
    buffer_load_dwordx4 v[188:191], v241, s[16:19], s79 offen offset:1024 sc1
    s_add_u32 s39, s39, 8192
    v_mfma_f32_16x16x32_bf16 v[68:71], v[204:207], a[196:199], v[68:71]
    v_mfma_f32_16x16x32_bf16 v[68:71], v[208:211], a[212:215], v[68:71]
    ds_read_b64_tr_b16 v[200:201], v233 offset:41984
    v_mov_b32 v152, -1
    v_mfma_f32_16x16x32_bf16 v[72:75], v[204:207], a[200:203], v[72:75]
    ds_read_b64_tr_b16 v[202:203], v233 offset:42496
    v_mov_b32 v153, -1
    v_mfma_f32_16x16x32_bf16 v[72:75], v[208:211], a[216:219], v[72:75]
    s_add_u32 m0, s37, 24576
    v_mov_b32 v154, -1
    v_mfma_f32_16x16x32_bf16 v[76:79], v[204:207], a[204:207], v[76:79]
    buffer_load_dwordx4 v237, s[8:11], s57 offen offset:1024 lds
    v_mov_b32 v155, -1
    v_mfma_f32_16x16x32_bf16 v[76:79], v[208:211], a[220:223], v[76:79]
    ds_read_b64_tr_b16 v[204:205], v233 offset:50176
    s_waitcnt lgkmcnt(3)
    v_mfma_f32_16x16x32_bf16 v[16:19], v[192:195], a[192:195], v[16:19]
    ds_read_b64_tr_b16 v[206:207], v233 offset:50688
    s_xor_b32 s79, s100, 294912
    v_mfma_f32_16x16x32_bf16 v[16:19], v[196:199], a[208:211], v[16:19]
    s_mov_b32 m0, s81
    v_mfma_f32_16x16x32_bf16 v[20:23], v[192:195], a[196:199], v[20:23]
    buffer_load_dwordx4 v240, s[16:19], s13 offen offset:0 sc1 lds
    v_mfma_f32_16x16x32_bf16 v[20:23], v[196:199], a[212:215], v[20:23]
    ds_read_b64_tr_b16 v[208:209], v234 offset:40960
    v_mfma_f32_16x16x32_bf16 v[24:27], v[192:195], a[200:203], v[24:27]
    ds_read_b64_tr_b16 v[210:211], v234 offset:41472
    v_mfma_f32_16x16x32_bf16 v[24:27], v[196:199], a[216:219], v[24:27]
    v_mfma_f32_16x16x32_bf16 v[28:31], v[192:195], a[204:207], v[28:31]
    v_mfma_f32_16x16x32_bf16 v[28:31], v[196:199], a[220:223], v[28:31]
    ds_read_b64_tr_b16 v[192:193], v234 offset:49152
    s_waitcnt lgkmcnt(3)
    v_mfma_f32_16x16x32_bf16 v[80:83], v[200:203], a[192:195], v[80:83]
    ds_read_b64_tr_b16 v[194:195], v234 offset:49664
    s_mov_b32 m0, s81
    v_mfma_f32_16x16x32_bf16 v[80:83], v[204:207], a[208:211], v[80:83]
    buffer_load_dwordx4 v240, s[16:19], s13 offen offset:1024 sc1 lds
    v_mfma_f32_16x16x32_bf16 v[84:87], v[200:203], a[196:199], v[84:87]
    v_mfma_f32_16x16x32_bf16 v[84:87], v[204:207], a[212:215], v[84:87]
    ds_read_b64_tr_b16 v[196:197], v234 offset:41984
    v_mfma_f32_16x16x32_bf16 v[88:91], v[200:203], a[200:203], v[88:91]
    ds_read_b64_tr_b16 v[198:199], v234 offset:42496
    v_mfma_f32_16x16x32_bf16 v[88:91], v[204:207], a[216:219], v[88:91]
    buffer_store_dwordx4 v[152:155], v240, s[16:19], s79 offen offset:0 sc1
    v_mfma_f32_16x16x32_bf16 v[92:95], v[200:203], a[204:207], v[92:95]
    v_mfma_f32_16x16x32_bf16 v[92:95], v[204:207], a[220:223], v[92:95]
    ds_read_b64_tr_b16 v[200:201], v234 offset:50176
    s_waitcnt lgkmcnt(3)
    v_mfma_f32_16x16x32_bf16 v[32:35], v[208:211], a[192:195], v[32:35]
    ds_read_b64_tr_b16 v[202:203], v234 offset:50688
    s_mov_b32 m0, s81
    v_mfma_f32_16x16x32_bf16 v[32:35], v[192:195], a[208:211], v[32:35]
    buffer_load_dwordx4 v240, s[16:19], s13 offen offset:2048 sc1 lds
    v_mfma_f32_16x16x32_bf16 v[36:39], v[208:211], a[196:199], v[36:39]
    v_mfma_f32_16x16x32_bf16 v[36:39], v[192:195], a[212:215], v[36:39]
    ds_read_b64_tr_b16 v[204:205], v235 offset:40960
    v_mfma_f32_16x16x32_bf16 v[40:43], v[208:211], a[200:203], v[40:43]
    ds_read_b64_tr_b16 v[206:207], v235 offset:41472
    v_mfma_f32_16x16x32_bf16 v[40:43], v[192:195], a[216:219], v[40:43]
    v_mfma_f32_16x16x32_bf16 v[44:47], v[208:211], a[204:207], v[44:47]
    v_mfma_f32_16x16x32_bf16 v[44:47], v[192:195], a[220:223], v[44:47]
    ds_read_b64_tr_b16 v[208:209], v235 offset:49152
    s_waitcnt lgkmcnt(3)
    v_mfma_f32_16x16x32_bf16 v[96:99], v[196:199], a[192:195], v[96:99]
    ds_read_b64_tr_b16 v[210:211], v235 offset:49664
    s_mov_b32 m0, s81
    v_mfma_f32_16x16x32_bf16 v[96:99], v[200:203], a[208:211], v[96:99]
    buffer_load_dwordx4 v240, s[16:19], s13 offen offset:3072 sc1 lds
    v_mfma_f32_16x16x32_bf16 v[100:103], v[196:199], a[196:199], v[100:103]
    v_mfma_f32_16x16x32_bf16 v[100:103], v[200:203], a[212:215], v[100:103]
    ds_read_b64_tr_b16 v[192:193], v235 offset:41984
    v_mfma_f32_16x16x32_bf16 v[104:107], v[196:199], a[200:203], v[104:107]
    ds_read_b64_tr_b16 v[194:195], v235 offset:42496
    v_mfma_f32_16x16x32_bf16 v[104:107], v[200:203], a[216:219], v[104:107]
    v_mfma_f32_16x16x32_bf16 v[108:111], v[196:199], a[204:207], v[108:111]
    v_mfma_f32_16x16x32_bf16 v[108:111], v[200:203], a[220:223], v[108:111]
    ds_read_b64_tr_b16 v[196:197], v235 offset:50176
    s_waitcnt lgkmcnt(3)
    v_mfma_f32_16x16x32_bf16 v[48:51], v[204:207], a[192:195], v[48:51]
    ds_read_b64_tr_b16 v[198:199], v235 offset:50688
    buffer_store_dwordx4 v[152:155], v240, s[16:19], s79 offen offset:1024 sc1
    v_mfma_f32_16x16x32_bf16 v[48:51], v[208:211], a[208:211], v[48:51]
    s_xor_b32 s79, s100, 221184
    v_mfma_f32_16x16x32_bf16 v[52:55], v[204:207], a[196:199], v[52:55]
    s_waitcnt vmcnt(21) lgkmcnt(2)
    s_barrier
    v_mfma_f32_16x16x32_bf16 v[52:55], v[208:211], a[212:215], v[52:55]
    ds_read_b64_tr_b16 v[200:201], v232 offset:0
    v_mfma_f32_16x16x32_bf16 v[56:59], v[204:207], a[200:203], v[56:59]
    ds_read_b64_tr_b16 v[202:203], v232 offset:512
    v_mfma_f32_16x16x32_bf16 v[56:59], v[208:211], a[216:219], v[56:59]
    s_add_u32 m0, s37, 32768
    v_mfma_f32_16x16x32_bf16 v[60:63], v[204:207], a[204:207], v[60:63]
    buffer_load_dwordx4 v238, s[4:7], s56 offen lds
    v_mfma_f32_16x16x32_bf16 v[60:63], v[208:211], a[220:223], v[60:63]
    ds_read_b64_tr_b16 v[204:205], v232 offset:8192
    s_waitcnt lgkmcnt(3)
    v_mfma_f32_16x16x32_bf16 v[112:115], v[192:195], a[192:195], v[112:115]
    ds_read_b64_tr_b16 v[206:207], v232 offset:8704
    v_mfma_f32_16x16x32_bf16 v[112:115], v[196:199], a[208:211], v[112:115]
    v_mfma_f32_16x16x32_bf16 v[116:119], v[192:195], a[196:199], v[116:119]
    v_mfma_f32_16x16x32_bf16 v[116:119], v[196:199], a[212:215], v[116:119]
    ds_read_b64_tr_b16 v[208:209], v232 offset:1024
    v_mfma_f32_16x16x32_bf16 v[120:123], v[192:195], a[200:203], v[120:123]
    ds_read_b64_tr_b16 v[210:211], v232 offset:1536
    v_mfma_f32_16x16x32_bf16 v[120:123], v[196:199], a[216:219], v[120:123]
    s_add_u32 m0, s37, 32768
    v_mfma_f32_16x16x32_bf16 v[124:127], v[192:195], a[204:207], v[124:127]
    buffer_load_dwordx4 v238, s[8:11], s56 offen offset:1024 lds
    v_mfma_f32_16x16x32_bf16 v[124:127], v[196:199], a[220:223], v[124:127]
    ds_read_b64_tr_b16 v[192:193], v232 offset:9216
    s_waitcnt vmcnt(20) lgkmcnt(3)
    v_mfma_f32_16x16x32_bf16 v[0:3], v[200:203], a[224:227], v[0:3]
    ds_read_b64_tr_b16 v[194:195], v232 offset:9728
    v_mfma_f32_16x16x32_bf16 v[0:3], v[204:207], a[240:243], v[0:3]
    v_mfma_f32_16x16x32_bf16 v[4:7], v[200:203], a[228:231], v[4:7]
    buffer_store_dwordx4 v[152:155], v240, s[16:19], s79 offen offset:0 sc1
    v_mfma_f32_16x16x32_bf16 v[4:7], v[204:207], a[244:247], v[4:7]
    ds_read_b64_tr_b16 v[196:197], v233 offset:0
    v_mfma_f32_16x16x32_bf16 v[8:11], v[200:203], a[232:235], v[8:11]
    ds_read_b64_tr_b16 v[198:199], v233 offset:512
    v_mfma_f32_16x16x32_bf16 v[8:11], v[204:207], a[248:251], v[8:11]
    s_add_u32 m0, s37, 40960
    v_mfma_f32_16x16x32_bf16 v[12:15], v[200:203], a[236:239], v[12:15]
    buffer_load_dwordx4 v238, s[4:7], s57 offen lds
    v_mfma_f32_16x16x32_bf16 v[12:15], v[204:207], a[252:255], v[12:15]
    ds_read_b64_tr_b16 v[200:201], v233 offset:8192
    s_waitcnt lgkmcnt(3)
    v_mfma_f32_16x16x32_bf16 v[64:67], v[208:211], a[224:227], v[64:67]
    ds_read_b64_tr_b16 v[202:203], v233 offset:8704
    v_mfma_f32_16x16x32_bf16 v[64:67], v[192:195], a[240:243], v[64:67]
    v_mfma_f32_16x16x32_bf16 v[68:71], v[208:211], a[228:231], v[68:71]
    v_mfma_f32_16x16x32_bf16 v[68:71], v[192:195], a[244:247], v[68:71]
    ds_read_b64_tr_b16 v[204:205], v233 offset:1024
    v_mfma_f32_16x16x32_bf16 v[72:75], v[208:211], a[232:235], v[72:75]
    ds_read_b64_tr_b16 v[206:207], v233 offset:1536
    v_mfma_f32_16x16x32_bf16 v[72:75], v[192:195], a[248:251], v[72:75]
    s_add_u32 m0, s37, 40960
    v_mfma_f32_16x16x32_bf16 v[76:79], v[208:211], a[236:239], v[76:79]
    buffer_load_dwordx4 v238, s[8:11], s57 offen offset:1024 lds
    v_mfma_f32_16x16x32_bf16 v[76:79], v[192:195], a[252:255], v[76:79]
    ds_read_b64_tr_b16 v[208:209], v233 offset:9216
    s_waitcnt lgkmcnt(3)
    v_mfma_f32_16x16x32_bf16 v[16:19], v[196:199], a[224:227], v[16:19]
    ds_read_b64_tr_b16 v[210:211], v233 offset:9728
    v_mfma_f32_16x16x32_bf16 v[16:19], v[200:203], a[240:243], v[16:19]
    v_mfma_f32_16x16x32_bf16 v[20:23], v[196:199], a[228:231], v[20:23]
    v_mfma_f32_16x16x32_bf16 v[20:23], v[200:203], a[244:247], v[20:23]
    ds_read_b64_tr_b16 v[192:193], v234 offset:0
    v_mfma_f32_16x16x32_bf16 v[24:27], v[196:199], a[232:235], v[24:27]
    ds_read_b64_tr_b16 v[194:195], v234 offset:512
    buffer_store_dwordx4 v[152:155], v240, s[16:19], s79 offen offset:1024 sc1
    v_mfma_f32_16x16x32_bf16 v[24:27], v[200:203], a[248:251], v[24:27]
    s_xor_b32 s79, s100, 147456
    v_mfma_f32_16x16x32_bf16 v[28:31], v[196:199], a[236:239], v[28:31]
    v_mfma_f32_16x16x32_bf16 v[28:31], v[200:203], a[252:255], v[28:31]
    ds_read_b64_tr_b16 v[196:197], v234 offset:8192
    s_waitcnt lgkmcnt(3)
    v_mfma_f32_16x16x32_bf16 v[80:83], v[204:207], a[224:227], v[80:83]
    ds_read_b64_tr_b16 v[198:199], v234 offset:8704
    v_mfma_f32_16x16x32_bf16 v[80:83], v[208:211], a[240:243], v[80:83]
    v_mfma_f32_16x16x32_bf16 v[84:87], v[204:207], a[228:231], v[84:87]
    v_mfma_f32_16x16x32_bf16 v[84:87], v[208:211], a[244:247], v[84:87]
    ds_read_b64_tr_b16 v[200:201], v234 offset:1024
    v_mfma_f32_16x16x32_bf16 v[88:91], v[204:207], a[232:235], v[88:91]
    ds_read_b64_tr_b16 v[202:203], v234 offset:1536
    v_mfma_f32_16x16x32_bf16 v[88:91], v[208:211], a[248:251], v[88:91]
    v_mfma_f32_16x16x32_bf16 v[92:95], v[204:207], a[236:239], v[92:95]
    v_mfma_f32_16x16x32_bf16 v[92:95], v[208:211], a[252:255], v[92:95]
    ds_read_b64_tr_b16 v[204:205], v234 offset:9216
    s_waitcnt lgkmcnt(3)
    v_mfma_f32_16x16x32_bf16 v[32:35], v[192:195], a[224:227], v[32:35]
    ds_read_b64_tr_b16 v[206:207], v234 offset:9728
    v_mfma_f32_16x16x32_bf16 v[32:35], v[196:199], a[240:243], v[32:35]
    v_mfma_f32_16x16x32_bf16 v[36:39], v[192:195], a[228:231], v[36:39]
    v_mfma_f32_16x16x32_bf16 v[36:39], v[196:199], a[244:247], v[36:39]
    ds_read_b64_tr_b16 v[208:209], v235 offset:0
    v_mfma_f32_16x16x32_bf16 v[40:43], v[192:195], a[232:235], v[40:43]
    ds_read_b64_tr_b16 v[210:211], v235 offset:512
    v_mfma_f32_16x16x32_bf16 v[40:43], v[196:199], a[248:251], v[40:43]
    v_mfma_f32_16x16x32_bf16 v[44:47], v[192:195], a[236:239], v[44:47]
    buffer_store_dwordx4 v[152:155], v240, s[16:19], s79 offen offset:0 sc1
    v_mfma_f32_16x16x32_bf16 v[44:47], v[196:199], a[252:255], v[44:47]
    ds_read_b64_tr_b16 v[192:193], v235 offset:8192
    s_waitcnt lgkmcnt(3)
    v_mfma_f32_16x16x32_bf16 v[96:99], v[200:203], a[224:227], v[96:99]
    ds_read_b64_tr_b16 v[194:195], v235 offset:8704
    v_mfma_f32_16x16x32_bf16 v[96:99], v[204:207], a[240:243], v[96:99]
    v_mfma_f32_16x16x32_bf16 v[100:103], v[200:203], a[228:231], v[100:103]
    v_mfma_f32_16x16x32_bf16 v[100:103], v[204:207], a[244:247], v[100:103]
    ds_read_b64_tr_b16 v[196:197], v235 offset:1024
    v_mfma_f32_16x16x32_bf16 v[104:107], v[200:203], a[232:235], v[104:107]
    ds_read_b64_tr_b16 v[198:199], v235 offset:1536
    v_mfma_f32_16x16x32_bf16 v[104:107], v[204:207], a[248:251], v[104:107]
    v_mfma_f32_16x16x32_bf16 v[108:111], v[200:203], a[236:239], v[108:111]
    v_mfma_f32_16x16x32_bf16 v[108:111], v[204:207], a[252:255], v[108:111]
    ds_read_b64_tr_b16 v[200:201], v235 offset:9216
    s_waitcnt lgkmcnt(3)
    v_mfma_f32_16x16x32_bf16 v[48:51], v[208:211], a[224:227], v[48:51]
    ds_read_b64_tr_b16 v[202:203], v235 offset:9728
    s_waitcnt vmcnt(8)
    v_mfma_f32_16x16x32_bf16 v[48:51], v[192:195], a[240:243], v[48:51]
    ds_read_b64_tr_b16 v[128:129], v144 offset:0
    v_mfma_f32_16x16x32_bf16 v[52:55], v[208:211], a[228:231], v[52:55]
    s_waitcnt lgkmcnt(3)
    s_barrier
    v_mfma_f32_16x16x32_bf16 v[52:55], v[192:195], a[244:247], v[52:55]
    ds_read_b64_tr_b16 v[204:205], v232 offset:16384
    ds_read_b64_tr_b16 v[130:131], v144 offset:64
    v_mfma_f32_16x16x32_bf16 v[56:59], v[208:211], a[232:235], v[56:59]
    ds_read_b64_tr_b16 v[206:207], v232 offset:16896
    ds_read_b64_tr_b16 v[132:133], v144 offset:256
    v_mfma_f32_16x16x32_bf16 v[56:59], v[192:195], a[248:251], v[56:59]
    s_add_u32 m0, s37, 49152
    ds_read_b64_tr_b16 v[134:135], v144 offset:320
    v_mfma_f32_16x16x32_bf16 v[60:63], v[208:211], a[236:239], v[60:63]
    buffer_load_dwordx4 v238, s[4:7], s40 offen lds
    ds_read_b64_tr_b16 v[136:137], v144 offset:512
    v_mfma_f32_16x16x32_bf16 v[60:63], v[192:195], a[252:255], v[60:63]
    ds_read_b64_tr_b16 v[208:209], v232 offset:24576
    s_waitcnt lgkmcnt(8)
    v_mfma_f32_16x16x32_bf16 v[112:115], v[196:199], a[224:227], v[112:115]
    ds_read_b64_tr_b16 v[210:211], v232 offset:25088
    ds_read_b64_tr_b16 v[138:139], v144 offset:576
    v_mfma_f32_16x16x32_bf16 v[112:115], v[200:203], a[240:243], v[112:115]
    ds_read_b64_tr_b16 v[140:141], v144 offset:768
    v_mfma_f32_16x16x32_bf16 v[116:119], v[196:199], a[228:231], v[116:119]
    ds_read_b64_tr_b16 v[142:143], v144 offset:832
    buffer_store_dwordx4 v[152:155], v240, s[16:19], s79 offen offset:1024 sc1
    v_mfma_f32_16x16x32_bf16 v[116:119], v[200:203], a[244:247], v[116:119]
    ds_read_b64_tr_b16 v[192:193], v232 offset:17408
    s_xor_b32 s79, s100, 73728
    v_mfma_f32_16x16x32_bf16 v[120:123], v[196:199], a[232:235], v[120:123]
    ds_read_b64_tr_b16 v[194:195], v232 offset:17920
    v_mfma_f32_16x16x32_bf16 v[120:123], v[200:203], a[248:251], v[120:123]
    s_add_u32 m0, s37, 49152
    v_mfma_f32_16x16x32_bf16 v[124:127], v[196:199], a[236:239], v[124:127]
    buffer_load_dwordx4 v238, s[8:11], s40 offen offset:1024 lds
    v_mfma_f32_16x16x32_bf16 v[124:127], v[200:203], a[252:255], v[124:127]
    ds_read_b64_tr_b16 v[196:197], v232 offset:25600
    s_waitcnt lgkmcnt(6)
    v_mfma_f32_16x16x32_bf16 v[0:3], v[204:207], v[160:163], v[0:3]
    ds_read_b64_tr_b16 v[198:199], v232 offset:26112
    v_mfma_f32_16x16x32_bf16 v[0:3], v[208:211], v[176:179], v[0:3]
    v_mfma_f32_16x16x32_bf16 v[4:7], v[204:207], v[164:167], v[4:7]
    s_waitcnt lgkmcnt(4)
    buffer_store_dwordx4 v[128:131], v145, s[16:19], s14 offen sc1
    v_mfma_f32_16x16x32_bf16 v[4:7], v[208:211], v[180:183], v[4:7]
    ds_read_b64_tr_b16 v[200:201], v233 offset:16384
    s_add_u32 s14, s14, 33792
    v_mfma_f32_16x16x32_bf16 v[8:11], v[204:207], v[168:171], v[8:11]
    ds_read_b64_tr_b16 v[202:203], v233 offset:16896
    v_mfma_f32_16x16x32_bf16 v[8:11], v[208:211], v[184:187], v[8:11]
    s_add_u32 m0, s37, 0
    v_mfma_f32_16x16x32_bf16 v[12:15], v[204:207], v[172:175], v[12:15]
    buffer_load_dwordx4 v238, s[4:7], s41 offen lds
    v_mfma_f32_16x16x32_bf16 v[12:15], v[208:211], v[188:191], v[12:15]
    ds_read_b64_tr_b16 v[204:205], v233 offset:24576
    s_waitcnt lgkmcnt(3)
    v_mfma_f32_16x16x32_bf16 v[64:67], v[192:195], v[160:163], v[64:67]
    ds_read_b64_tr_b16 v[206:207], v233 offset:25088
    v_mfma_f32_16x16x32_bf16 v[64:67], v[196:199], v[176:179], v[64:67]
    v_mfma_f32_16x16x32_bf16 v[68:71], v[192:195], v[164:167], v[68:71]
    v_mfma_f32_16x16x32_bf16 v[68:71], v[196:199], v[180:183], v[68:71]
    ds_read_b64_tr_b16 v[208:209], v233 offset:17408
    v_mfma_f32_16x16x32_bf16 v[72:75], v[192:195], v[168:171], v[72:75]
    ds_read_b64_tr_b16 v[210:211], v233 offset:17920
    v_mfma_f32_16x16x32_bf16 v[72:75], v[196:199], v[184:187], v[72:75]
    s_add_u32 m0, s37, 0
    v_mfma_f32_16x16x32_bf16 v[76:79], v[192:195], v[172:175], v[76:79]
    buffer_load_dwordx4 v238, s[8:11], s41 offen offset:1024 lds
    v_mfma_f32_16x16x32_bf16 v[76:79], v[196:199], v[188:191], v[76:79]
    ds_read_b64_tr_b16 v[192:193], v233 offset:25600
    s_waitcnt lgkmcnt(3)
    v_mfma_f32_16x16x32_bf16 v[16:19], v[200:203], v[160:163], v[16:19]
    ds_read_b64_tr_b16 v[194:195], v233 offset:26112
    v_mfma_f32_16x16x32_bf16 v[16:19], v[204:207], v[176:179], v[16:19]
    v_mfma_f32_16x16x32_bf16 v[20:23], v[200:203], v[164:167], v[20:23]
    buffer_store_dwordx4 v[132:135], v145, s[16:19], s14 offen sc1
    s_add_u32 s14, s14, 33792
    v_mfma_f32_16x16x32_bf16 v[20:23], v[204:207], v[180:183], v[20:23]
    ds_read_b64_tr_b16 v[196:197], v234 offset:16384
    v_mfma_f32_16x16x32_bf16 v[24:27], v[200:203], v[168:171], v[24:27]
    ds_read_b64_tr_b16 v[198:199], v234 offset:16896
    v_mfma_f32_16x16x32_bf16 v[24:27], v[204:207], v[184:187], v[24:27]
    v_mfma_f32_16x16x32_bf16 v[28:31], v[200:203], v[172:175], v[28:31]
    buffer_store_dwordx4 v[152:155], v240, s[16:19], s79 offen offset:0 sc1
    v_mfma_f32_16x16x32_bf16 v[28:31], v[204:207], v[188:191], v[28:31]
    ds_read_b64_tr_b16 v[200:201], v234 offset:24576
    s_waitcnt lgkmcnt(3)
    v_mfma_f32_16x16x32_bf16 v[80:83], v[208:211], v[160:163], v[80:83]
    ds_read_b64_tr_b16 v[202:203], v234 offset:25088
    v_mfma_f32_16x16x32_bf16 v[80:83], v[192:195], v[176:179], v[80:83]
    v_mfma_f32_16x16x32_bf16 v[84:87], v[208:211], v[164:167], v[84:87]
    v_mfma_f32_16x16x32_bf16 v[84:87], v[192:195], v[180:183], v[84:87]
    ds_read_b64_tr_b16 v[204:205], v234 offset:17408
    v_mfma_f32_16x16x32_bf16 v[88:91], v[208:211], v[168:171], v[88:91]
    ds_read_b64_tr_b16 v[206:207], v234 offset:17920
    buffer_store_dwordx4 v[136:139], v145, s[16:19], s14 offen sc1
    v_mfma_f32_16x16x32_bf16 v[88:91], v[192:195], v[184:187], v[88:91]
    s_add_u32 s14, s14, 33792
    v_mfma_f32_16x16x32_bf16 v[92:95], v[208:211], v[172:175], v[92:95]
    v_mfma_f32_16x16x32_bf16 v[92:95], v[192:195], v[188:191], v[92:95]
    ds_read_b64_tr_b16 v[208:209], v234 offset:25600
    s_waitcnt lgkmcnt(3)
    v_mfma_f32_16x16x32_bf16 v[32:35], v[196:199], v[160:163], v[32:35]
    ds_read_b64_tr_b16 v[210:211], v234 offset:26112
    v_mfma_f32_16x16x32_bf16 v[32:35], v[200:203], v[176:179], v[32:35]
    v_mfma_f32_16x16x32_bf16 v[36:39], v[196:199], v[164:167], v[36:39]
    v_mfma_f32_16x16x32_bf16 v[36:39], v[200:203], v[180:183], v[36:39]
    ds_read_b64_tr_b16 v[192:193], v235 offset:16384
    v_mfma_f32_16x16x32_bf16 v[40:43], v[196:199], v[168:171], v[40:43]
    ds_read_b64_tr_b16 v[194:195], v235 offset:16896
    v_mfma_f32_16x16x32_bf16 v[40:43], v[200:203], v[184:187], v[40:43]
    v_mfma_f32_16x16x32_bf16 v[44:47], v[196:199], v[172:175], v[44:47]
    buffer_store_dwordx4 v[140:143], v145, s[16:19], s14 offen sc1
    v_mfma_f32_16x16x32_bf16 v[44:47], v[200:203], v[188:191], v[44:47]
    ds_read_b64_tr_b16 v[196:197], v235 offset:24576
    s_waitcnt lgkmcnt(3)
    v_mfma_f32_16x16x32_bf16 v[96:99], v[204:207], v[160:163], v[96:99]
    ds_read_b64_tr_b16 v[198:199], v235 offset:25088
    v_mfma_f32_16x16x32_bf16 v[96:99], v[208:211], v[176:179], v[96:99]
    v_mfma_f32_16x16x32_bf16 v[100:103], v[204:207], v[164:167], v[100:103]
    buffer_store_dwordx4 v[152:155], v240, s[16:19], s79 offen offset:1024 sc1
    v_mfma_f32_16x16x32_bf16 v[100:103], v[208:211], v[180:183], v[100:103]
    ds_read_b64_tr_b16 v[200:201], v235 offset:17408
    v_mfma_f32_16x16x32_bf16 v[104:107], v[204:207], v[168:171], v[104:107]
    ds_read_b64_tr_b16 v[202:203], v235 offset:17920
    v_mfma_f32_16x16x32_bf16 v[104:107], v[208:211], v[184:187], v[104:107]
    v_mfma_f32_16x16x32_bf16 v[108:111], v[204:207], v[172:175], v[108:111]
    v_mfma_f32_16x16x32_bf16 v[108:111], v[208:211], v[188:191], v[108:111]
    ds_read_b64_tr_b16 v[204:205], v235 offset:25600
    s_waitcnt lgkmcnt(3)
    v_mfma_f32_16x16x32_bf16 v[48:51], v[192:195], v[160:163], v[48:51]
    ds_read_b64_tr_b16 v[206:207], v235 offset:26112
    v_mfma_f32_16x16x32_bf16 v[48:51], v[196:199], v[176:179], v[48:51]
    v_mfma_f32_16x16x32_bf16 v[52:55], v[192:195], v[164:167], v[52:55]
    v_mfma_f32_16x16x32_bf16 v[52:55], v[196:199], v[180:183], v[52:55]
    ds_read_b64_tr_b16 v[208:209], v236 offset:0
    v_mfma_f32_16x16x32_bf16 v[56:59], v[192:195], v[168:171], v[56:59]
    ds_read_b64_tr_b16 v[210:211], v236 offset:256
    v_mfma_f32_16x16x32_bf16 v[56:59], v[196:199], v[184:187], v[56:59]
    v_mfma_f32_16x16x32_bf16 v[60:63], v[192:195], v[172:175], v[60:63]
    v_mfma_f32_16x16x32_bf16 v[60:63], v[196:199], v[188:191], v[60:63]
    ds_read_b64_tr_b16 v[192:193], v236 offset:2048
    s_waitcnt lgkmcnt(3)
    v_mfma_f32_16x16x32_bf16 v[112:115], v[200:203], v[160:163], v[112:115]
    ds_read_b64_tr_b16 v[194:195], v236 offset:2304
    v_mfma_f32_16x16x32_bf16 v[112:115], v[204:207], v[176:179], v[112:115]
    v_mfma_f32_16x16x32_bf16 v[116:119], v[200:203], v[164:167], v[116:119]
    v_mfma_f32_16x16x32_bf16 v[116:119], v[204:207], v[180:183], v[116:119]
    ds_read_b64_tr_b16 v[196:197], v236 offset:1024
    v_mfma_f32_16x16x32_bf16 v[120:123], v[200:203], v[168:171], v[120:123]
    ds_read_b64_tr_b16 v[198:199], v236 offset:1280
    v_mfma_f32_16x16x32_bf16 v[120:123], v[204:207], v[184:187], v[120:123]
    v_mfma_f32_16x16x32_bf16 v[124:127], v[200:203], v[172:175], v[124:127]
    v_mfma_f32_16x16x32_bf16 v[124:127], v[204:207], v[188:191], v[124:127]
    ds_read_b64_tr_b16 v[200:201], v236 offset:3072
    s_waitcnt lgkmcnt(3)
    v_mfma_f32_16x16x32_bf16 v[128:131], v[208:211], a[0:3], 0
    ds_read_b64_tr_b16 v[202:203], v236 offset:3328
    v_mfma_f32_16x16x32_bf16 v[128:131], v[192:195], a[16:19], v[128:131]
    v_mfma_f32_16x16x32_bf16 v[132:135], v[208:211], a[4:7], 0
    v_mfma_f32_16x16x32_bf16 v[132:135], v[192:195], a[20:23], v[132:135]
    ds_read_b64_tr_b16 v[204:205], v236 offset:4096
    v_mfma_f32_16x16x32_bf16 v[136:139], v[208:211], a[8:11], 0
    ds_read_b64_tr_b16 v[206:207], v236 offset:4352
    v_mul_f32 v0, v0, v64
    v_mfma_f32_16x16x32_bf16 v[136:139], v[192:195], a[24:27], v[136:139]
    v_mul_f32 v1, v1, v65
    v_mul_f32 v2, v2, v66
    v_mfma_f32_16x16x32_bf16 v[140:143], v[208:211], a[12:15], 0
    v_mul_f32 v3, v3, v67
    v_cvt_pk_bf16_f32 v216, v0, v1
    v_mfma_f32_16x16x32_bf16 v[140:143], v[192:195], a[28:31], v[140:143]
    ds_read_b64_tr_b16 v[208:209], v236 offset:6144
    s_waitcnt lgkmcnt(3)
    v_mfma_f32_16x16x32_bf16 v[144:147], v[196:199], a[0:3], 0
    ds_read_b64_tr_b16 v[210:211], v236 offset:6400
    v_cvt_pk_bf16_f32 v217, v2, v3
    v_mfma_f32_16x16x32_bf16 v[144:147], v[200:203], a[16:19], v[144:147]
    v_mul_f32 v16, v16, v80
    v_mul_f32 v17, v17, v81
    v_mfma_f32_16x16x32_bf16 v[148:151], v[196:199], a[4:7], 0
    v_mul_f32 v18, v18, v82
    v_mul_f32 v19, v19, v83
    v_mfma_f32_16x16x32_bf16 v[148:151], v[200:203], a[20:23], v[148:151]
    ds_read_b64_tr_b16 v[192:193], v236 offset:5120
    v_cvt_pk_bf16_f32 v218, v16, v17
    v_mfma_f32_16x16x32_bf16 v[152:155], v[196:199], a[8:11], 0
    ds_read_b64_tr_b16 v[194:195], v236 offset:5376
    v_cvt_pk_bf16_f32 v219, v18, v19
    v_mfma_f32_16x16x32_bf16 v[152:155], v[200:203], a[24:27], v[152:155]
    buffer_store_dwordx4 v[216:219], v240, s[16:19], s58 offen offset:0 sc1
    v_mul_f32 v4, v4, v68
    v_mfma_f32_16x16x32_bf16 v[156:159], v[196:199], a[12:15], 0
    v_mul_f32 v5, v5, v69
    v_mul_f32 v6, v6, v70
    v_mfma_f32_16x16x32_bf16 v[156:159], v[200:203], a[28:31], v[156:159]
    ds_read_b64_tr_b16 v[196:197], v236 offset:7168
    s_waitcnt lgkmcnt(3)
    v_mfma_f32_16x16x32_bf16 v[128:131], v[204:207], a[32:35], v[128:131]
    ds_read_b64_tr_b16 v[198:199], v236 offset:7424
    v_mul_f32 v7, v7, v71
    v_mfma_f32_16x16x32_bf16 v[128:131], v[208:211], a[48:51], v[128:131]
    v_cvt_pk_bf16_f32 v220, v4, v5
    v_cvt_pk_bf16_f32 v221, v6, v7
    v_mfma_f32_16x16x32_bf16 v[132:135], v[204:207], a[36:39], v[132:135]
    v_mul_f32 v20, v20, v84
    v_mul_f32 v21, v21, v85
    v_mfma_f32_16x16x32_bf16 v[132:135], v[208:211], a[52:55], v[132:135]
    ds_read_b64_tr_b16 v[200:201], v236 offset:8192
    v_mul_f32 v22, v22, v86
    v_mfma_f32_16x16x32_bf16 v[136:139], v[204:207], a[40:43], v[136:139]
    ds_read_b64_tr_b16 v[202:203], v236 offset:8448
    v_mul_f32 v23, v23, v87
    v_mfma_f32_16x16x32_bf16 v[136:139], v[208:211], a[56:59], v[136:139]
    v_cvt_pk_bf16_f32 v222, v20, v21
    v_cvt_pk_bf16_f32 v223, v22, v23
    v_mfma_f32_16x16x32_bf16 v[140:143], v[204:207], a[44:47], v[140:143]
    v_mfma_f32_16x16x32_bf16 v[140:143], v[208:211], a[60:63], v[140:143]
    ds_read_b64_tr_b16 v[204:205], v236 offset:10240
    s_waitcnt lgkmcnt(3)
    v_mfma_f32_16x16x32_bf16 v[144:147], v[192:195], a[32:35], v[144:147]
    ds_read_b64_tr_b16 v[206:207], v236 offset:10496
    v_mfma_f32_16x16x32_bf16 v[144:147], v[196:199], a[48:51], v[144:147]
    v_mfma_f32_16x16x32_bf16 v[148:151], v[192:195], a[36:39], v[148:151]
    v_mfma_f32_16x16x32_bf16 v[148:151], v[196:199], a[52:55], v[148:151]
    ds_read_b64_tr_b16 v[208:209], v236 offset:9216
    v_mfma_f32_16x16x32_bf16 v[152:155], v[192:195], a[40:43], v[152:155]
    ds_read_b64_tr_b16 v[210:211], v236 offset:9472
    v_mfma_f32_16x16x32_bf16 v[152:155], v[196:199], a[56:59], v[152:155]
    buffer_store_dwordx4 v[220:223], v240, s[16:19], s58 offen offset:1024 sc1
    v_mul_f32 v8, v8, v72
    v_mfma_f32_16x16x32_bf16 v[156:159], v[192:195], a[44:47], v[156:159]
    v_mul_f32 v9, v9, v73
    v_mul_f32 v10, v10, v74
    v_mfma_f32_16x16x32_bf16 v[156:159], v[196:199], a[60:63], v[156:159]
    ds_read_b64_tr_b16 v[192:193], v236 offset:11264
    s_waitcnt lgkmcnt(3)
    v_mfma_f32_16x16x32_bf16 v[128:131], v[200:203], a[64:67], v[128:131]
    ds_read_b64_tr_b16 v[194:195], v236 offset:11520
    v_mul_f32 v11, v11, v75
    v_mfma_f32_16x16x32_bf16 v[128:131], v[204:207], a[80:83], v[128:131]
    v_cvt_pk_bf16_f32 v224, v8, v9
    v_cvt_pk_bf16_f32 v225, v10, v11
    v_mfma_f32_16x16x32_bf16 v[132:135], v[200:203], a[68:71], v[132:135]
    v_mul_f32 v24, v24, v88
    v_mul_f32 v25, v25, v89
    v_mfma_f32_16x16x32_bf16 v[132:135], v[204:207], a[84:87], v[132:135]
    ds_read_b64_tr_b16 v[196:197], v236 offset:12288
    v_mul_f32 v26, v26, v90
    v_mfma_f32_16x16x32_bf16 v[136:139], v[200:203], a[72:75], v[136:139]
    ds_read_b64_tr_b16 v[198:199], v236 offset:12544
    v_mul_f32 v27, v27, v91
    v_mfma_f32_16x16x32_bf16 v[136:139], v[204:207], a[88:91], v[136:139]
    v_cvt_pk_bf16_f32 v226, v24, v25
    v_cvt_pk_bf16_f32 v227, v26, v27
    v_mfma_f32_16x16x32_bf16 v[140:143], v[200:203], a[76:79], v[140:143]
    v_mfma_f32_16x16x32_bf16 v[140:143], v[204:207], a[92:95], v[140:143]
    ds_read_b64_tr_b16 v[200:201], v236 offset:14336
    s_waitcnt lgkmcnt(3)
    v_mfma_f32_16x16x32_bf16 v[144:147], v[208:211], a[64:67], v[144:147]
    ds_read_b64_tr_b16 v[202:203], v236 offset:14592
    v_mfma_f32_16x16x32_bf16 v[144:147], v[192:195], a[80:83], v[144:147]
    v_mfma_f32_16x16x32_bf16 v[148:151], v[208:211], a[68:71], v[148:151]
    v_mfma_f32_16x16x32_bf16 v[148:151], v[192:195], a[84:87], v[148:151]
    ds_read_b64_tr_b16 v[204:205], v236 offset:13312
    v_mfma_f32_16x16x32_bf16 v[152:155], v[208:211], a[72:75], v[152:155]
    ds_read_b64_tr_b16 v[206:207], v236 offset:13568
    v_mfma_f32_16x16x32_bf16 v[152:155], v[192:195], a[88:91], v[152:155]
    buffer_store_dwordx4 v[224:227], v240, s[16:19], s58 offen offset:2048 sc1
    v_mul_f32 v12, v12, v76
    v_mfma_f32_16x16x32_bf16 v[156:159], v[208:211], a[76:79], v[156:159]
    v_mul_f32 v13, v13, v77
    v_mul_f32 v14, v14, v78
    v_mfma_f32_16x16x32_bf16 v[156:159], v[192:195], a[92:95], v[156:159]
    ds_read_b64_tr_b16 v[208:209], v236 offset:15360
    s_waitcnt lgkmcnt(3)
    v_mfma_f32_16x16x32_bf16 v[128:131], v[196:199], a[96:99], v[128:131]
    ds_read_b64_tr_b16 v[210:211], v236 offset:15616
    v_mul_f32 v15, v15, v79
    v_mfma_f32_16x16x32_bf16 v[128:131], v[200:203], a[112:115], v[128:131]
    v_cvt_pk_bf16_f32 v228, v12, v13
    v_cvt_pk_bf16_f32 v229, v14, v15
    v_mfma_f32_16x16x32_bf16 v[132:135], v[196:199], a[100:103], v[132:135]
    v_mul_f32 v28, v28, v92
    v_mul_f32 v29, v29, v93
    v_mfma_f32_16x16x32_bf16 v[132:135], v[200:203], a[116:119], v[132:135]
    ds_read_b64_tr_b16 v[192:193], v236 offset:16384
    v_mul_f32 v30, v30, v94
    v_mfma_f32_16x16x32_bf16 v[136:139], v[196:199], a[104:107], v[136:139]
    ds_read_b64_tr_b16 v[194:195], v236 offset:16640
    v_mul_f32 v31, v31, v95
    v_mfma_f32_16x16x32_bf16 v[136:139], v[200:203], a[120:123], v[136:139]
    v_cvt_pk_bf16_f32 v230, v28, v29
    v_cvt_pk_bf16_f32 v231, v30, v31
    v_mfma_f32_16x16x32_bf16 v[140:143], v[196:199], a[108:111], v[140:143]
    v_mfma_f32_16x16x32_bf16 v[140:143], v[200:203], a[124:127], v[140:143]
    ds_read_b64_tr_b16 v[196:197], v236 offset:18432
    s_waitcnt lgkmcnt(3)
    v_mfma_f32_16x16x32_bf16 v[144:147], v[204:207], a[96:99], v[144:147]
    ds_read_b64_tr_b16 v[198:199], v236 offset:18688
    v_mfma_f32_16x16x32_bf16 v[144:147], v[208:211], a[112:115], v[144:147]
    v_mfma_f32_16x16x32_bf16 v[148:151], v[204:207], a[100:103], v[148:151]
    v_mfma_f32_16x16x32_bf16 v[148:151], v[208:211], a[116:119], v[148:151]
    ds_read_b64_tr_b16 v[200:201], v236 offset:17408
    v_mfma_f32_16x16x32_bf16 v[152:155], v[204:207], a[104:107], v[152:155]
    ds_read_b64_tr_b16 v[202:203], v236 offset:17664
    s_waitcnt vmcnt(4)
    v_mfma_f32_16x16x32_bf16 v[152:155], v[208:211], a[120:123], v[152:155]
    buffer_store_dwordx4 v[228:231], v240, s[16:19], s58 offen offset:3072 sc1
    v_mul_f32 v32, v32, v96
    v_mfma_f32_16x16x32_bf16 v[156:159], v[204:207], a[108:111], v[156:159]
    v_mul_f32 v33, v33, v97
    v_mul_f32 v34, v34, v98
    v_mfma_f32_16x16x32_bf16 v[156:159], v[208:211], a[124:127], v[156:159]
    ds_read_b64_tr_b16 v[204:205], v236 offset:19456
    s_waitcnt lgkmcnt(3)
    v_mfma_f32_16x16x32_bf16 v[128:131], v[192:195], a[128:131], v[128:131]
    ds_read_b64_tr_b16 v[206:207], v236 offset:19712
    v_mul_f32 v35, v35, v99
    v_mfma_f32_16x16x32_bf16 v[128:131], v[196:199], a[144:147], v[128:131]
    v_cvt_pk_bf16_f32 v216, v32, v33
    v_cvt_pk_bf16_f32 v217, v34, v35
    v_mfma_f32_16x16x32_bf16 v[132:135], v[192:195], a[132:135], v[132:135]
    v_mul_f32 v48, v48, v112
    v_mul_f32 v49, v49, v113
    v_mfma_f32_16x16x32_bf16 v[132:135], v[196:199], a[148:151], v[132:135]
    ds_read_b64_tr_b16 v[208:209], v236 offset:20480
    v_mul_f32 v50, v50, v114
    v_mfma_f32_16x16x32_bf16 v[136:139], v[192:195], a[136:139], v[136:139]
    ds_read_b64_tr_b16 v[210:211], v236 offset:20736
    v_mul_f32 v51, v51, v115
    v_mfma_f32_16x16x32_bf16 v[136:139], v[196:199], a[152:155], v[136:139]
    v_cvt_pk_bf16_f32 v218, v48, v49
    v_cvt_pk_bf16_f32 v219, v50, v51
    v_mfma_f32_16x16x32_bf16 v[140:143], v[192:195], a[140:143], v[140:143]
    buffer_store_dwordx4 v[248:251], v252, s[16:19], s15 offen sc1
    v_mfma_f32_16x16x32_bf16 v[140:143], v[196:199], a[156:159], v[140:143]
    ds_read_b64_tr_b16 v[192:193], v236 offset:22528
    s_waitcnt lgkmcnt(3)
    v_mfma_f32_16x16x32_bf16 v[144:147], v[200:203], a[128:131], v[144:147]
    ds_read_b64_tr_b16 v[194:195], v236 offset:22784
    v_lshrrev_b32 v244, 1, v243
    v_mfma_f32_16x16x32_bf16 v[144:147], v[204:207], a[144:147], v[144:147]
    v_and_b32 v245, 7, v244
    v_bfe_u32 v246, v244, 3, 1
    v_mfma_f32_16x16x32_bf16 v[148:151], v[200:203], a[132:135], v[148:151]
    v_lshl_add_u32 v245, v246, 4, v245
    v_bfe_u32 v246, v244, 4, 1
    v_mfma_f32_16x16x32_bf16 v[148:151], v[204:207], a[148:151], v[148:151]
    ds_read_b64_tr_b16 v[196:197], v236 offset:21504
    v_lshl_add_u32 v245, v246, 3, v245
    v_mfma_f32_16x16x32_bf16 v[152:155], v[200:203], a[136:139], v[152:155]
    ds_read_b64_tr_b16 v[198:199], v236 offset:21760
    s_cmp_lt_u32 s32, 2
    s_cselect_b64 vcc, -1, 0
    v_mfma_f32_16x16x32_bf16 v[152:155], v[204:207], a[152:155], v[152:155]
    buffer_store_dwordx4 v[216:219], v241, s[16:19], s58 offen offset:0 sc1
    v_mul_f32 v36, v36, v100
    v_mfma_f32_16x16x32_bf16 v[156:159], v[200:203], a[140:143], v[156:159]
    v_mul_f32 v37, v37, v101
    v_mul_f32 v38, v38, v102
    v_mfma_f32_16x16x32_bf16 v[156:159], v[204:207], a[156:159], v[156:159]
    ds_read_b64_tr_b16 v[200:201], v236 offset:23552
    s_waitcnt lgkmcnt(3)
    v_mfma_f32_16x16x32_bf16 v[128:131], v[208:211], a[160:163], v[128:131]
    ds_read_b64_tr_b16 v[202:203], v236 offset:23808
    v_mul_f32 v39, v39, v103
    v_mfma_f32_16x16x32_bf16 v[128:131], v[192:195], a[176:179], v[128:131]
    v_cvt_pk_bf16_f32 v220, v36, v37
    v_cvt_pk_bf16_f32 v221, v38, v39
    v_mfma_f32_16x16x32_bf16 v[132:135], v[208:211], a[164:167], v[132:135]
    v_mul_f32 v52, v52, v116
    v_mul_f32 v53, v53, v117
    v_mfma_f32_16x16x32_bf16 v[132:135], v[192:195], a[180:183], v[132:135]
    ds_read_b64_tr_b16 v[204:205], v236 offset:24576
    v_mul_f32 v54, v54, v118
    v_mfma_f32_16x16x32_bf16 v[136:139], v[208:211], a[168:171], v[136:139]
    ds_read_b64_tr_b16 v[206:207], v236 offset:24832
    v_mul_f32 v55, v55, v119
    v_mfma_f32_16x16x32_bf16 v[136:139], v[192:195], a[184:187], v[136:139]
    v_cvt_pk_bf16_f32 v222, v52, v53
    v_cvt_pk_bf16_f32 v223, v54, v55
    v_mfma_f32_16x16x32_bf16 v[140:143], v[208:211], a[172:175], v[140:143]
    v_cndmask_b32 v245, v244, v245, vcc
    s_and_b32 s78, s32, 1
    v_mfma_f32_16x16x32_bf16 v[140:143], v[192:195], a[188:191], v[140:143]
    ds_read_b64_tr_b16 v[208:209], v236 offset:26624
    s_waitcnt lgkmcnt(3)
    v_mfma_f32_16x16x32_bf16 v[144:147], v[196:199], a[160:163], v[144:147]
    ds_read_b64_tr_b16 v[210:211], v236 offset:26880
    s_mul_i32 s78, s78, 36864
    v_mfma_f32_16x16x32_bf16 v[144:147], v[200:203], a[176:179], v[144:147]
    s_lshl_b32 s79, s35, 5
    s_add_u32 s78, s78, s79
    v_mfma_f32_16x16x32_bf16 v[148:151], v[196:199], a[164:167], v[148:151]
    s_add_u32 s78, s78, 1024
    v_and_b32 v246, 1, v243
    v_mfma_f32_16x16x32_bf16 v[148:151], v[200:203], a[180:183], v[148:151]
    ds_read_b64_tr_b16 v[192:193], v236 offset:25600
    v_lshl_add_u32 v246, v246, 4, s78
    v_mfma_f32_16x16x32_bf16 v[152:155], v[196:199], a[168:171], v[152:155]
    ds_read_b64_tr_b16 v[194:195], v236 offset:25856
    v_mul_u32_u24 v244, 1152, v244
    v_mfma_f32_16x16x32_bf16 v[152:155], v[200:203], a[184:187], v[152:155]
    buffer_store_dwordx4 v[220:223], v241, s[16:19], s58 offen offset:1024 sc1
    v_mul_f32 v40, v40, v104
    v_mfma_f32_16x16x32_bf16 v[156:159], v[196:199], a[172:175], v[156:159]
    v_mul_f32 v41, v41, v105
    v_mul_f32 v42, v42, v106
    v_mfma_f32_16x16x32_bf16 v[156:159], v[200:203], a[188:191], v[156:159]
    ds_read_b64_tr_b16 v[196:197], v236 offset:27648
    s_waitcnt lgkmcnt(3)
    v_mfma_f32_16x16x32_bf16 v[128:131], v[204:207], a[192:195], v[128:131]
    ds_read_b64_tr_b16 v[198:199], v236 offset:27904
    v_mul_f32 v43, v43, v107
    v_mfma_f32_16x16x32_bf16 v[128:131], v[208:211], a[208:211], v[128:131]
    v_cvt_pk_bf16_f32 v224, v40, v41
    v_cvt_pk_bf16_f32 v225, v42, v43
    v_mfma_f32_16x16x32_bf16 v[132:135], v[204:207], a[196:199], v[132:135]
    v_mul_f32 v56, v56, v120
    v_mul_f32 v57, v57, v121
    v_mfma_f32_16x16x32_bf16 v[132:135], v[208:211], a[212:215], v[132:135]
    ds_read_b64_tr_b16 v[200:201], v236 offset:28672
    v_mul_f32 v58, v58, v122
    v_mfma_f32_16x16x32_bf16 v[136:139], v[204:207], a[200:203], v[136:139]
    ds_read_b64_tr_b16 v[202:203], v236 offset:28928
    v_mul_f32 v59, v59, v123
    v_mfma_f32_16x16x32_bf16 v[136:139], v[208:211], a[216:219], v[136:139]
    v_cvt_pk_bf16_f32 v226, v56, v57
    v_cvt_pk_bf16_f32 v227, v58, v59
    v_mfma_f32_16x16x32_bf16 v[140:143], v[204:207], a[204:207], v[140:143]
    v_mul_u32_u24 v245, 1152, v245
    v_add_u32 v237, v244, v246
    v_mfma_f32_16x16x32_bf16 v[140:143], v[208:211], a[220:223], v[140:143]
    ds_read_b64_tr_b16 v[204:205], v236 offset:30720
    s_waitcnt lgkmcnt(3)
    v_mfma_f32_16x16x32_bf16 v[144:147], v[192:195], a[192:195], v[144:147]
    ds_read_b64_tr_b16 v[206:207], v236 offset:30976
    v_add_u32 v239, v245, v246
    v_mfma_f32_16x16x32_bf16 v[144:147], v[196:199], a[208:211], v[144:147]
    s_lshr_b32 s14, s2, 4
    s_lshr_b32 s15, s2, 5
    v_mfma_f32_16x16x32_bf16 v[148:151], v[192:195], a[196:199], v[148:151]
    s_add_u32 s15, s15, 16
    s_cmp_lt_u32 s2, 64
    s_cselect_b32 s15, s15, s14
    v_mfma_f32_16x16x32_bf16 v[148:151], v[196:199], a[212:215], v[148:151]
    ds_read_b64_tr_b16 v[208:209], v236 offset:29696
    s_sub_u32 s15, s15, s14
    v_mfma_f32_16x16x32_bf16 v[152:155], v[192:195], a[200:203], v[152:155]
    ds_read_b64_tr_b16 v[210:211], v236 offset:29952
    s_lshl_b32 s15, s15, 12
    v_mfma_f32_16x16x32_bf16 v[152:155], v[196:199], a[216:219], v[152:155]
    buffer_store_dwordx4 v[224:227], v241, s[16:19], s58 offen offset:2048 sc1
    v_mul_f32 v44, v44, v108
    v_mfma_f32_16x16x32_bf16 v[156:159], v[192:195], a[204:207], v[156:159]
    v_mul_f32 v45, v45, v109
    v_mul_f32 v46, v46, v110
    v_mfma_f32_16x16x32_bf16 v[156:159], v[196:199], a[220:223], v[156:159]
    ds_read_b64_tr_b16 v[192:193], v236 offset:31744
    s_waitcnt lgkmcnt(3)
    v_mfma_f32_16x16x32_bf16 v[128:131], v[200:203], a[224:227], v[128:131]
    ds_read_b64_tr_b16 v[194:195], v236 offset:32000
    v_mul_f32 v47, v47, v111
    v_mfma_f32_16x16x32_bf16 v[128:131], v[204:207], a[240:243], v[128:131]
    v_cvt_pk_bf16_f32 v228, v44, v45
    v_cvt_pk_bf16_f32 v229, v46, v47
    v_mfma_f32_16x16x32_bf16 v[132:135], v[200:203], a[228:231], v[132:135]
    v_mul_f32 v60, v60, v124
    v_mul_f32 v61, v61, v125
    v_mfma_f32_16x16x32_bf16 v[132:135], v[204:207], a[244:247], v[132:135]
    ds_read_b64_tr_b16 v[196:197], v236 offset:32768
    v_mul_f32 v62, v62, v126
    v_mfma_f32_16x16x32_bf16 v[136:139], v[200:203], a[232:235], v[136:139]
    ds_read_b64_tr_b16 v[198:199], v236 offset:33024
    v_mul_f32 v63, v63, v127
    v_mfma_f32_16x16x32_bf16 v[136:139], v[204:207], a[248:251], v[136:139]
    v_cvt_pk_bf16_f32 v230, v60, v61
    v_cvt_pk_bf16_f32 v231, v62, v63
    v_mfma_f32_16x16x32_bf16 v[140:143], v[200:203], a[236:239], v[140:143]
    s_lshl_b32 s14, s14, 12
    s_add_u32 s14, s14, 9502720
    v_mfma_f32_16x16x32_bf16 v[140:143], v[204:207], a[252:255], v[140:143]
    ds_read_b64_tr_b16 v[200:201], v236 offset:34816
    s_waitcnt lgkmcnt(3)
    v_mfma_f32_16x16x32_bf16 v[144:147], v[208:211], a[224:227], v[144:147]
    ds_read_b64_tr_b16 v[202:203], v236 offset:35072
    v_lshrrev_b32 v244, 5, v243
    v_mfma_f32_16x16x32_bf16 v[144:147], v[192:195], a[240:243], v[144:147]
    v_mul_lo_u32 v244, v244, s15
    v_and_b32 v245, 31, v243
    v_mfma_f32_16x16x32_bf16 v[148:151], v[208:211], a[228:231], v[148:151]
    v_lshl_add_u32 v253, v245, 7, v244
    v_mfma_f32_16x16x32_bf16 v[148:151], v[192:195], a[244:247], v[148:151]
    ds_read_b64_tr_b16 v[204:205], v236 offset:33792
    v_mfma_f32_16x16x32_bf16 v[152:155], v[208:211], a[232:235], v[152:155]
    ds_read_b64_tr_b16 v[206:207], v236 offset:34048
    v_mfma_f32_16x16x32_bf16 v[152:155], v[192:195], a[248:251], v[152:155]
    buffer_store_dwordx4 v[228:231], v241, s[16:19], s58 offen offset:3072 sc1
    v_mfma_f32_16x16x32_bf16 v[156:159], v[208:211], a[236:239], v[156:159]
    v_mfma_f32_16x16x32_bf16 v[156:159], v[192:195], a[252:255], v[156:159]
    ds_read_b64_tr_b16 v[208:209], v236 offset:35840
    s_waitcnt lgkmcnt(3)
    v_mfma_f32_16x16x32_bf16 v[128:131], v[196:199], v[160:163], v[128:131]
    ds_read_b64_tr_b16 v[210:211], v236 offset:36096
    v_mfma_f32_16x16x32_bf16 v[128:131], v[200:203], v[176:179], v[128:131]
    v_mfma_f32_16x16x32_bf16 v[132:135], v[196:199], v[164:167], v[132:135]
    s_waitcnt lgkmcnt(2)
    s_barrier
    v_mfma_f32_16x16x32_bf16 v[132:135], v[200:203], v[180:183], v[132:135]
    ds_read_b64_tr_b16 v[192:193], v232 offset:32768
    v_mfma_f32_16x16x32_bf16 v[136:139], v[196:199], v[168:171], v[136:139]
    ds_read_b64_tr_b16 v[194:195], v232 offset:33280
    v_mfma_f32_16x16x32_bf16 v[136:139], v[200:203], v[184:187], v[136:139]
    s_add_u32 m0, s37, 8192
    v_mfma_f32_16x16x32_bf16 v[140:143], v[196:199], v[172:175], v[140:143]
    buffer_load_dwordx4 v238, s[4:7], s42 offen lds
    v_mfma_f32_16x16x32_bf16 v[140:143], v[200:203], v[188:191], v[140:143]
    ds_read_b64_tr_b16 v[196:197], v232 offset:40960
    s_waitcnt lgkmcnt(3)
    v_mfma_f32_16x16x32_bf16 v[144:147], v[204:207], v[160:163], v[144:147]
    ds_read_b64_tr_b16 v[198:199], v232 offset:41472
    v_mfma_f32_16x16x32_bf16 v[144:147], v[208:211], v[176:179], v[144:147]
    v_mfma_f32_16x16x32_bf16 v[148:151], v[204:207], v[164:167], v[148:151]
    v_mfma_f32_16x16x32_bf16 v[148:151], v[208:211], v[180:183], v[148:151]
    ds_read_b64_tr_b16 v[200:201], v232 offset:33792
    v_mfma_f32_16x16x32_bf16 v[152:155], v[204:207], v[168:171], v[152:155]
    ds_read_b64_tr_b16 v[202:203], v232 offset:34304
    v_mfma_f32_16x16x32_bf16 v[152:155], v[208:211], v[184:187], v[152:155]
    s_add_u32 m0, s37, 8192
    v_mfma_f32_16x16x32_bf16 v[156:159], v[204:207], v[172:175], v[156:159]
    buffer_load_dwordx4 v238, s[8:11], s42 offen offset:1024 lds
    v_mfma_f32_16x16x32_bf16 v[156:159], v[208:211], v[188:191], v[156:159]
    ds_read_b64_tr_b16 v[204:205], v232 offset:41984
    s_waitcnt lgkmcnt(3)
    v_mfma_f32_16x16x32_bf16 v[0:3], v[192:195], v[160:163], 0
    ds_read_b64_tr_b16 v[206:207], v232 offset:42496
    v_mfma_f32_16x16x32_bf16 v[0:3], v[196:199], v[176:179], v[0:3]
    v_mfma_f32_16x16x32_bf16 v[4:7], v[192:195], v[164:167], 0
    v_mfma_f32_16x16x32_bf16 v[4:7], v[196:199], v[180:183], v[4:7]
    ds_read_b64_tr_b16 v[208:209], v233 offset:32768
    v_mfma_f32_16x16x32_bf16 v[8:11], v[192:195], v[168:171], 0
    ds_read_b64_tr_b16 v[210:211], v233 offset:33280
    v_mfma_f32_16x16x32_bf16 v[8:11], v[196:199], v[184:187], v[8:11]
    s_add_u32 m0, s37, 16384
    v_mfma_f32_16x16x32_bf16 v[12:15], v[192:195], v[172:175], 0
    buffer_load_dwordx4 v238, s[4:7], s43 offen lds
    v_mfma_f32_16x16x32_bf16 v[12:15], v[196:199], v[188:191], v[12:15]
    ds_read_b64_tr_b16 v[192:193], v233 offset:40960
    s_waitcnt lgkmcnt(3)
    v_mfma_f32_16x16x32_bf16 v[64:67], v[200:203], v[160:163], 0
    ds_read_b64_tr_b16 v[194:195], v233 offset:41472
    v_mul_f32 v128, v128, v144
    v_mfma_f32_16x16x32_bf16 v[64:67], v[204:207], v[176:179], v[64:67]
    v_mul_f32 v129, v129, v145
    v_mul_f32 v130, v130, v146
    v_mfma_f32_16x16x32_bf16 v[68:71], v[200:203], v[164:167], 0
    v_mul_f32 v131, v131, v147
    v_cvt_pk_bf16_f32 v216, v128, v129
    v_mfma_f32_16x16x32_bf16 v[68:71], v[204:207], v[180:183], v[68:71]
    ds_read_b64_tr_b16 v[196:197], v233 offset:33792
    v_cvt_pk_bf16_f32 v217, v130, v131
    v_mfma_f32_16x16x32_bf16 v[72:75], v[200:203], v[168:171], 0
    ds_read_b64_tr_b16 v[198:199], v233 offset:34304
    v_mul_f32 v132, v132, v148
    v_mfma_f32_16x16x32_bf16 v[72:75], v[204:207], v[184:187], v[72:75]
    s_add_u32 m0, s37, 16384
    v_mul_f32 v133, v133, v149
    v_mfma_f32_16x16x32_bf16 v[76:79], v[200:203], v[172:175], 0
    buffer_load_dwordx4 v238, s[8:11], s43 offen offset:1024 lds
    v_mul_f32 v134, v134, v150
    v_mfma_f32_16x16x32_bf16 v[76:79], v[204:207], v[188:191], v[76:79]
    ds_read_b64_tr_b16 v[200:201], v233 offset:41984
    s_waitcnt lgkmcnt(3)
    v_mfma_f32_16x16x32_bf16 v[16:19], v[208:211], v[160:163], 0
    ds_read_b64_tr_b16 v[202:203], v233 offset:42496
    v_mul_f32 v135, v135, v151
    v_mfma_f32_16x16x32_bf16 v[16:19], v[192:195], v[176:179], v[16:19]
    v_cvt_pk_bf16_f32 v218, v132, v133
    v_cvt_pk_bf16_f32 v219, v134, v135
    v_mfma_f32_16x16x32_bf16 v[20:23], v[208:211], v[164:167], 0
    s_nop 1
    v_permlane32_swap_b32 v216, v218
    v_mfma_f32_16x16x32_bf16 v[20:23], v[192:195], v[180:183], v[20:23]
    ds_read_b64_tr_b16 v[204:205], v234 offset:32768
    v_permlane32_swap_b32 v217, v219
    v_mfma_f32_16x16x32_bf16 v[24:27], v[208:211], v[168:171], 0
    ds_read_b64_tr_b16 v[206:207], v234 offset:33280
    s_nop 0
    v_mfma_f32_16x16x32_bf16 v[24:27], v[192:195], v[184:187], v[24:27]
    buffer_store_dwordx4 v[216:219], v242, s[16:19], s62 offen offset:0 sc1
    v_mul_f32 v136, v136, v152
    v_mfma_f32_16x16x32_bf16 v[28:31], v[208:211], v[172:175], 0
    v_mul_f32 v137, v137, v153
    v_mul_f32 v138, v138, v154
    v_mfma_f32_16x16x32_bf16 v[28:31], v[192:195], v[188:191], v[28:31]
    ds_read_b64_tr_b16 v[208:209], v234 offset:40960
    s_waitcnt lgkmcnt(3)
    v_mfma_f32_16x16x32_bf16 v[80:83], v[196:199], v[160:163], 0
    ds_read_b64_tr_b16 v[210:211], v234 offset:41472
    v_mul_f32 v139, v139, v155
    v_mfma_f32_16x16x32_bf16 v[80:83], v[200:203], v[176:179], v[80:83]
    v_cvt_pk_bf16_f32 v220, v136, v137
    v_cvt_pk_bf16_f32 v221, v138, v139
    v_mfma_f32_16x16x32_bf16 v[84:87], v[196:199], v[164:167], 0
    v_mul_f32 v140, v140, v156
    v_mul_f32 v141, v141, v157
    v_mfma_f32_16x16x32_bf16 v[84:87], v[200:203], v[180:183], v[84:87]
    ds_read_b64_tr_b16 v[192:193], v234 offset:33792
    v_mul_f32 v142, v142, v158
    v_mfma_f32_16x16x32_bf16 v[88:91], v[196:199], v[168:171], 0
    ds_read_b64_tr_b16 v[194:195], v234 offset:34304
    v_mul_f32 v143, v143, v159
    v_mfma_f32_16x16x32_bf16 v[88:91], v[200:203], v[184:187], v[88:91]
    v_cvt_pk_bf16_f32 v222, v140, v141
    v_cvt_pk_bf16_f32 v223, v142, v143
    v_mfma_f32_16x16x32_bf16 v[92:95], v[196:199], v[172:175], 0
    s_nop 1
    v_permlane32_swap_b32 v220, v222
    v_mfma_f32_16x16x32_bf16 v[92:95], v[200:203], v[188:191], v[92:95]
    ds_read_b64_tr_b16 v[196:197], v234 offset:41984
    s_waitcnt lgkmcnt(3)
    v_mfma_f32_16x16x32_bf16 v[32:35], v[204:207], v[160:163], 0
    ds_read_b64_tr_b16 v[198:199], v234 offset:42496
    v_permlane32_swap_b32 v221, v223
    v_mfma_f32_16x16x32_bf16 v[32:35], v[208:211], v[176:179], v[32:35]
    s_nop 0
    buffer_store_dwordx4 v[220:223], v242, s[16:19], s62 offen offset:2048 sc1
    v_mfma_f32_16x16x32_bf16 v[36:39], v[204:207], v[164:167], 0
    v_mfma_f32_16x16x32_bf16 v[36:39], v[208:211], v[180:183], v[36:39]
    ds_read_b64_tr_b16 v[200:201], v235 offset:32768
    v_mfma_f32_16x16x32_bf16 v[40:43], v[204:207], v[168:171], 0
    ds_read_b64_tr_b16 v[202:203], v235 offset:33280
    v_mfma_f32_16x16x32_bf16 v[40:43], v[208:211], v[184:187], v[40:43]
    v_mfma_f32_16x16x32_bf16 v[44:47], v[204:207], v[172:175], 0
    v_mfma_f32_16x16x32_bf16 v[44:47], v[208:211], v[188:191], v[44:47]
    ds_read_b64_tr_b16 v[204:205], v235 offset:40960
    s_waitcnt lgkmcnt(3)
    v_mfma_f32_16x16x32_bf16 v[96:99], v[192:195], v[160:163], 0
    ds_read_b64_tr_b16 v[206:207], v235 offset:41472
    v_mfma_f32_16x16x32_bf16 v[96:99], v[196:199], v[176:179], v[96:99]
    v_mfma_f32_16x16x32_bf16 v[100:103], v[192:195], v[164:167], 0
    v_mfma_f32_16x16x32_bf16 v[100:103], v[196:199], v[180:183], v[100:103]
    ds_read_b64_tr_b16 v[208:209], v235 offset:33792
    v_mfma_f32_16x16x32_bf16 v[104:107], v[192:195], v[168:171], 0
    ds_read_b64_tr_b16 v[210:211], v235 offset:34304
    v_mfma_f32_16x16x32_bf16 v[104:107], v[196:199], v[184:187], v[104:107]
    v_mfma_f32_16x16x32_bf16 v[108:111], v[192:195], v[172:175], 0
    v_mfma_f32_16x16x32_bf16 v[108:111], v[196:199], v[188:191], v[108:111]
    ds_read_b64_tr_b16 v[192:193], v235 offset:41984
    s_waitcnt lgkmcnt(3)
    v_mfma_f32_16x16x32_bf16 v[48:51], v[200:203], v[160:163], 0
    ds_read_b64_tr_b16 v[194:195], v235 offset:42496
    v_mfma_f32_16x16x32_bf16 v[48:51], v[204:207], v[176:179], v[48:51]
    v_mfma_f32_16x16x32_bf16 v[52:55], v[200:203], v[164:167], 0
    s_waitcnt lgkmcnt(2)
    s_barrier
    v_mfma_f32_16x16x32_bf16 v[52:55], v[204:207], v[180:183], v[52:55]
    ds_read_b64_tr_b16 v[196:197], v232 offset:49152
    v_mfma_f32_16x16x32_bf16 v[56:59], v[200:203], v[168:171], 0
    ds_read_b64_tr_b16 v[198:199], v232 offset:49664
    s_cmp_lt_u32 s32, 2
    s_cselect_b32 s78, s67, s68
    v_mfma_f32_16x16x32_bf16 v[56:59], v[204:207], v[184:187], v[56:59]
    s_add_u32 m0, s37, 24576
    v_mfma_f32_16x16x32_bf16 v[60:63], v[200:203], v[172:175], 0
    buffer_load_dwordx4 v238, s[4:7], s44 offen lds
    v_mfma_f32_16x16x32_bf16 v[60:63], v[204:207], v[188:191], v[60:63]
    ds_read_b64_tr_b16 v[200:201], v232 offset:0
    s_waitcnt lgkmcnt(3)
    v_mfma_f32_16x16x32_bf16 v[112:115], v[208:211], v[160:163], 0
    ds_read_b64_tr_b16 v[202:203], v232 offset:512
    v_mfma_f32_16x16x32_bf16 v[112:115], v[192:195], v[176:179], v[112:115]
    s_add_u32 m0, s38, 73728
    v_mfma_f32_16x16x32_bf16 v[116:119], v[208:211], v[164:167], 0
    buffer_load_dwordx4 v237, s[20:23], s78 offen lds
    s_cmp_lt_u32 s32, 2
    s_cselect_b32 s78, s69, s70
    v_mfma_f32_16x16x32_bf16 v[116:119], v[192:195], v[180:183], v[116:119]
    ds_read_b64_tr_b16 v[204:205], v232 offset:50176
    v_mfma_f32_16x16x32_bf16 v[120:123], v[208:211], v[168:171], 0
    ds_read_b64_tr_b16 v[206:207], v232 offset:50688
    v_mfma_f32_16x16x32_bf16 v[120:123], v[192:195], v[184:187], v[120:123]
    s_add_u32 m0, s37, 24576
    v_mfma_f32_16x16x32_bf16 v[124:127], v[208:211], v[172:175], 0
    buffer_load_dwordx4 v238, s[8:11], s44 offen offset:1024 lds
    v_mfma_f32_16x16x32_bf16 v[124:127], v[192:195], v[188:191], v[124:127]
    ds_read_b64_tr_b16 v[208:209], v232 offset:1024
    s_waitcnt lgkmcnt(3)
    v_mfma_f32_16x16x32_bf16 v[0:3], v[196:199], a[0:3], v[0:3]
    ds_read_b64_tr_b16 v[210:211], v232 offset:1536
    v_mfma_f32_16x16x32_bf16 v[0:3], v[200:203], a[16:19], v[0:3]
    v_mfma_f32_16x16x32_bf16 v[4:7], v[196:199], a[4:7], v[4:7]
    buffer_load_dwordx2 v[250:251], v253, s[16:19], s14 offen sc1
    v_mfma_f32_16x16x32_bf16 v[4:7], v[200:203], a[20:23], v[4:7]
    ds_read_b64_tr_b16 v[192:193], v233 offset:49152
    s_mul_i32 s15, s2, 8448
    v_mfma_f32_16x16x32_bf16 v[8:11], v[196:199], a[8:11], v[8:11]
    ds_read_b64_tr_b16 v[194:195], v233 offset:49664
    s_lshl_b32 s81, s32, 1
    v_mfma_f32_16x16x32_bf16 v[8:11], v[200:203], a[24:27], v[8:11]
    s_add_u32 m0, s37, 32768
    s_add_u32 s81, s81, 3145856
    v_mfma_f32_16x16x32_bf16 v[12:15], v[196:199], a[12:15], v[12:15]
    buffer_load_dwordx4 v238, s[4:7], s45 offen lds
    s_mul_i32 s82, s2, 4224
    v_mfma_f32_16x16x32_bf16 v[12:15], v[200:203], a[28:31], v[12:15]
    ds_read_b64_tr_b16 v[196:197], v233 offset:0
    s_waitcnt lgkmcnt(3)
    v_mfma_f32_16x16x32_bf16 v[64:67], v[204:207], a[0:3], v[64:67]
    ds_read_b64_tr_b16 v[198:199], v233 offset:512
    s_add_u32 s82, s82, 2162688
    v_mfma_f32_16x16x32_bf16 v[64:67], v[208:211], a[16:19], v[64:67]
    s_add_u32 m0, s38, 77824
    s_cmp_lt_u32 s2, 64
    s_cselect_b32 s82, s82, 1073741824
    v_mfma_f32_16x16x32_bf16 v[68:71], v[204:207], a[4:7], v[68:71]
    buffer_load_dwordx4 v237, s[20:23], s78 offen lds
    s_cmp_lt_u32 s32, 2
    s_cselect_b32 s78, s71, s72
    v_mfma_f32_16x16x32_bf16 v[68:71], v[208:211], a[20:23], v[68:71]
    ds_read_b64_tr_b16 v[200:201], v233 offset:50176
    s_add_u32 s82, s82, s81
    v_mfma_f32_16x16x32_bf16 v[72:75], v[204:207], a[8:11], v[72:75]
    ds_read_b64_tr_b16 v[202:203], v233 offset:50688
    s_add_u32 s15, s15, s81
    v_mfma_f32_16x16x32_bf16 v[72:75], v[208:211], a[24:27], v[72:75]
    s_add_u32 m0, s37, 32768
    s_add_u32 s80, s15, 4224
    v_mfma_f32_16x16x32_bf16 v[76:79], v[204:207], a[12:15], v[76:79]
    buffer_load_dwordx4 v238, s[8:11], s45 offen offset:1024 lds
    s_mul_i32 s81, s32, 4160
    v_mfma_f32_16x16x32_bf16 v[76:79], v[208:211], a[28:31], v[76:79]
    ds_read_b64_tr_b16 v[204:205], v233 offset:1024
    s_waitcnt lgkmcnt(3)
    v_mfma_f32_16x16x32_bf16 v[16:19], v[192:195], a[0:3], v[16:19]
    ds_read_b64_tr_b16 v[206:207], v233 offset:1536
    s_mul_i32 s39, s83, 4224
    v_mfma_f32_16x16x32_bf16 v[16:19], v[196:199], a[16:19], v[16:19]
    s_add_u32 s39, s39, 3145728
    v_and_b32 v244, 7, v243
    v_mfma_f32_16x16x32_bf16 v[20:23], v[192:195], a[4:7], v[20:23]
    v_mov_b32 v245, 0x57
    v_lshrrev_b32 v244, v244, v245
    v_mfma_f32_16x16x32_bf16 v[20:23], v[196:199], a[20:23], v[20:23]
    ds_read_b64_tr_b16 v[208:209], v234 offset:49152
    v_lshlrev_b32 v245, 31, v244
    v_mfma_f32_16x16x32_bf16 v[24:27], v[192:195], a[8:11], v[24:27]
    ds_read_b64_tr_b16 v[210:211], v234 offset:49664
    v_mfma_f32_16x16x32_bf16 v[24:27], v[196:199], a[24:27], v[24:27]
    v_mfma_f32_16x16x32_bf16 v[28:31], v[192:195], a[12:15], v[28:31]
    v_mfma_f32_16x16x32_bf16 v[28:31], v[196:199], a[28:31], v[28:31]
    ds_read_b64_tr_b16 v[192:193], v234 offset:0
    s_waitcnt lgkmcnt(3)
    v_mfma_f32_16x16x32_bf16 v[80:83], v[200:203], a[0:3], v[80:83]
    ds_read_b64_tr_b16 v[194:195], v234 offset:512
    v_mfma_f32_16x16x32_bf16 v[80:83], v[204:207], a[16:19], v[80:83]
    s_add_u32 m0, s38, 81920
    v_mfma_f32_16x16x32_bf16 v[84:87], v[200:203], a[4:7], v[84:87]
    buffer_load_dwordx4 v239, s[20:23], s78 offen lds
    s_cmp_lt_u32 s32, 2
    s_cselect_b32 s78, s73, s74
    v_mfma_f32_16x16x32_bf16 v[84:87], v[204:207], a[20:23], v[84:87]
    ds_read_b64_tr_b16 v[196:197], v234 offset:50176
    v_mfma_f32_16x16x32_bf16 v[88:91], v[200:203], a[8:11], v[88:91]
    ds_read_b64_tr_b16 v[198:199], v234 offset:50688
    v_mfma_f32_16x16x32_bf16 v[88:91], v[204:207], a[24:27], v[88:91]
    v_mfma_f32_16x16x32_bf16 v[92:95], v[200:203], a[12:15], v[92:95]
    v_mfma_f32_16x16x32_bf16 v[92:95], v[204:207], a[28:31], v[92:95]
    ds_read_b64_tr_b16 v[200:201], v234 offset:1024
    s_waitcnt lgkmcnt(3)
    v_mfma_f32_16x16x32_bf16 v[32:35], v[208:211], a[0:3], v[32:35]
    ds_read_b64_tr_b16 v[202:203], v234 offset:1536
    v_mfma_f32_16x16x32_bf16 v[32:35], v[192:195], a[16:19], v[32:35]
    v_mfma_f32_16x16x32_bf16 v[36:39], v[208:211], a[4:7], v[36:39]
    v_mfma_f32_16x16x32_bf16 v[36:39], v[192:195], a[20:23], v[36:39]
    ds_read_b64_tr_b16 v[204:205], v235 offset:49152
    v_mfma_f32_16x16x32_bf16 v[40:43], v[208:211], a[8:11], v[40:43]
    ds_read_b64_tr_b16 v[206:207], v235 offset:49664
    v_mfma_f32_16x16x32_bf16 v[40:43], v[192:195], a[24:27], v[40:43]
    v_mfma_f32_16x16x32_bf16 v[44:47], v[208:211], a[12:15], v[44:47]
    v_mfma_f32_16x16x32_bf16 v[44:47], v[192:195], a[28:31], v[44:47]
    ds_read_b64_tr_b16 v[208:209], v235 offset:0
    s_waitcnt lgkmcnt(3)
    v_mfma_f32_16x16x32_bf16 v[96:99], v[196:199], a[0:3], v[96:99]
    ds_read_b64_tr_b16 v[210:211], v235 offset:512
    v_mfma_f32_16x16x32_bf16 v[96:99], v[200:203], a[16:19], v[96:99]
    s_add_u32 m0, s38, 86016
    v_mfma_f32_16x16x32_bf16 v[100:103], v[196:199], a[4:7], v[100:103]
    buffer_load_dwordx4 v237, s[20:23], s78 offen lds
    s_cmp_lt_u32 s32, 2
    s_cselect_b32 s78, s75, s74
    v_mfma_f32_16x16x32_bf16 v[100:103], v[200:203], a[20:23], v[100:103]
    ds_read_b64_tr_b16 v[192:193], v235 offset:50176
    s_cmp_lt_u32 s32, 2
    s_cselect_b32 s79, 4096, 0
    v_mfma_f32_16x16x32_bf16 v[104:107], v[196:199], a[8:11], v[104:107]
    ds_read_b64_tr_b16 v[194:195], v235 offset:50688
    s_add_u32 s79, s79, s38
    v_mfma_f32_16x16x32_bf16 v[104:107], v[200:203], a[24:27], v[104:107]
    v_mfma_f32_16x16x32_bf16 v[108:111], v[196:199], a[12:15], v[108:111]
    v_mfma_f32_16x16x32_bf16 v[108:111], v[200:203], a[28:31], v[108:111]
    ds_read_b64_tr_b16 v[196:197], v235 offset:1024
    s_waitcnt lgkmcnt(3)
    v_mfma_f32_16x16x32_bf16 v[48:51], v[204:207], a[0:3], v[48:51]
    ds_read_b64_tr_b16 v[198:199], v235 offset:1536
    v_mfma_f32_16x16x32_bf16 v[48:51], v[208:211], a[16:19], v[48:51]
    v_mfma_f32_16x16x32_bf16 v[52:55], v[204:207], a[4:7], v[52:55]
    s_waitcnt vmcnt(11) lgkmcnt(2)
    s_barrier
    v_mfma_f32_16x16x32_bf16 v[52:55], v[208:211], a[20:23], v[52:55]
    ds_read_b64_tr_b16 v[200:201], v232 offset:8192
    v_mfma_f32_16x16x32_bf16 v[56:59], v[204:207], a[8:11], v[56:59]
    ds_read_b64_tr_b16 v[202:203], v232 offset:8704
    v_mfma_f32_16x16x32_bf16 v[56:59], v[208:211], a[24:27], v[56:59]
    s_add_u32 m0, s37, 40960
    v_mfma_f32_16x16x32_bf16 v[60:63], v[204:207], a[12:15], v[60:63]
    buffer_load_dwordx4 v238, s[4:7], s46 offen lds
    v_mfma_f32_16x16x32_bf16 v[60:63], v[208:211], a[28:31], v[60:63]
    ds_read_b64_tr_b16 v[204:205], v232 offset:16384
    s_waitcnt lgkmcnt(3)
    v_mfma_f32_16x16x32_bf16 v[112:115], v[192:195], a[0:3], v[112:115]
    ds_read_b64_tr_b16 v[206:207], v232 offset:16896
    v_mfma_f32_16x16x32_bf16 v[112:115], v[196:199], a[16:19], v[112:115]
    s_add_u32 m0, s79, 86016
    v_mfma_f32_16x16x32_bf16 v[116:119], v[192:195], a[4:7], v[116:119]
    buffer_load_dwordx4 v237, s[20:23], s78 offen lds
    v_mfma_f32_16x16x32_bf16 v[116:119], v[196:199], a[20:23], v[116:119]
    ds_read_b64_tr_b16 v[208:209], v232 offset:9216
    v_mfma_f32_16x16x32_bf16 v[120:123], v[192:195], a[8:11], v[120:123]
    ds_read_b64_tr_b16 v[210:211], v232 offset:9728
    v_mfma_f32_16x16x32_bf16 v[120:123], v[196:199], a[24:27], v[120:123]
    s_add_u32 m0, s37, 40960
    v_mfma_f32_16x16x32_bf16 v[124:127], v[192:195], a[12:15], v[124:127]
    buffer_load_dwordx4 v238, s[8:11], s46 offen offset:1024 lds
    v_mfma_f32_16x16x32_bf16 v[124:127], v[196:199], a[28:31], v[124:127]
    ds_read_b64_tr_b16 v[192:193], v232 offset:17408
    s_waitcnt lgkmcnt(3)
    v_mfma_f32_16x16x32_bf16 v[0:3], v[200:203], a[32:35], v[0:3]
    ds_read_b64_tr_b16 v[194:195], v232 offset:17920
    s_lshl_b32 s12, s2, 2
    v_mfma_f32_16x16x32_bf16 v[0:3], v[204:207], a[48:51], v[0:3]
    s_add_u32 s12, s12, s32
    s_lshl_b32 s12, s12, 7
    v_mfma_f32_16x16x32_bf16 v[4:7], v[200:203], a[36:39], v[4:7]
    s_add_u32 s13, s12, 9764864
    s_add_u32 s12, s12, 9633792
    v_mfma_f32_16x16x32_bf16 v[4:7], v[204:207], a[52:55], v[4:7]
    ds_read_b64_tr_b16 v[196:197], v233 offset:8192
    s_waitcnt vmcnt(12)
    v_mfma_f32_16x16x32_bf16 v[8:11], v[200:203], a[40:43], v[8:11]
    ds_read_b64_tr_b16 v[198:199], v233 offset:8704
    v_mfma_f32_16x16x32_bf16 v[8:11], v[204:207], a[56:59], v[8:11]
    s_add_u32 m0, s37, 49152
    v_mfma_f32_16x16x32_bf16 v[12:15], v[200:203], a[44:47], v[12:15]
    buffer_load_dwordx4 v238, s[4:7], s47 offen lds
    v_mfma_f32_16x16x32_bf16 v[12:15], v[204:207], a[60:63], v[12:15]
    ds_read_b64_tr_b16 v[200:201], v233 offset:16384
    s_waitcnt lgkmcnt(3)
    v_mfma_f32_16x16x32_bf16 v[64:67], v[208:211], a[32:35], v[64:67]
    ds_read_b64_tr_b16 v[202:203], v233 offset:16896
    v_mfma_f32_16x16x32_bf16 v[64:67], v[192:195], a[48:51], v[64:67]
    v_mfma_f32_16x16x32_bf16 v[68:71], v[208:211], a[36:39], v[68:71]
    buffer_store_dwordx4 v[248:251], v252, s[16:19], s12 offen sc1
    v_mfma_f32_16x16x32_bf16 v[68:71], v[192:195], a[52:55], v[68:71]
    ds_read_b64_tr_b16 v[204:205], v233 offset:9216
    v_mfma_f32_16x16x32_bf16 v[72:75], v[208:211], a[40:43], v[72:75]
    ds_read_b64_tr_b16 v[206:207], v233 offset:9728
    s_waitcnt vmcnt(10)
    v_mfma_f32_16x16x32_bf16 v[72:75], v[192:195], a[56:59], v[72:75]
    s_add_u32 m0, s37, 49152
    v_cmp_ne_u64 vcc, v[250:251], v[248:249]
    v_mfma_f32_16x16x32_bf16 v[76:79], v[208:211], a[44:47], v[76:79]
    buffer_load_dwordx4 v238, s[8:11], s47 offen offset:1024 lds
    s_cbranch_vccnz L_slow_12
L_back_13:
    v_mfma_f32_16x16x32_bf16 v[76:79], v[192:195], a[60:63], v[76:79]
    ds_read_b64_tr_b16 v[208:209], v233 offset:17408
    s_waitcnt lgkmcnt(3)
    v_mfma_f32_16x16x32_bf16 v[16:19], v[196:199], a[32:35], v[16:19]
    ds_read_b64_tr_b16 v[210:211], v233 offset:17920
    v_mfma_f32_16x16x32_bf16 v[16:19], v[200:203], a[48:51], v[16:19]
    v_mfma_f32_16x16x32_bf16 v[20:23], v[196:199], a[36:39], v[20:23]
    buffer_load_dwordx2 v[214:215], v245, s[16:19], s39 offen offset:128 sc1
    v_mfma_f32_16x16x32_bf16 v[20:23], v[200:203], a[52:55], v[20:23]
    ds_read_b64_tr_b16 v[192:193], v234 offset:8192
    v_lshrrev_b32 v244, 2, v243
    v_mfma_f32_16x16x32_bf16 v[24:27], v[196:199], a[40:43], v[24:27]
    ds_read_b64_tr_b16 v[194:195], v234 offset:8704
    v_and_b32 v245, 3, v243
    v_mfma_f32_16x16x32_bf16 v[24:27], v[200:203], a[56:59], v[24:27]
    s_add_u32 m0, s81, 98592
    v_lshlrev_b32 v245, 3, v245
    v_mfma_f32_16x16x32_bf16 v[28:31], v[196:199], a[44:47], v[28:31]
    buffer_load_dwordx4 v240, s[16:19], s15 offen offset:0 sc1 lds
    v_lshl_add_u32 v244, v244, 7, v245
    v_mfma_f32_16x16x32_bf16 v[28:31], v[200:203], a[60:63], v[28:31]
    ds_read_b64_tr_b16 v[196:197], v234 offset:16384
    s_waitcnt lgkmcnt(3)
    v_mfma_f32_16x16x32_bf16 v[80:83], v[204:207], a[32:35], v[80:83]
    ds_read_b64_tr_b16 v[198:199], v234 offset:16896
    v_bfe_u32 v245, v243, 3, 2
    v_mfma_f32_16x16x32_bf16 v[80:83], v[208:211], a[48:51], v[80:83]
    v_lshl_add_u32 v244, v245, 5, v244
    s_andn2_b32 s76, 3, s33
    v_mfma_f32_16x16x32_bf16 v[84:87], v[204:207], a[36:39], v[84:87]
    s_lshl_b32 s76, s76, 5
    v_xor_b32 v216, s76, v244
    v_mfma_f32_16x16x32_bf16 v[84:87], v[208:211], a[52:55], v[84:87]
    ds_read_b64_tr_b16 v[200:201], v234 offset:9216
    s_add_u32 m0, s81, 120352
    v_mfma_f32_16x16x32_bf16 v[88:91], v[204:207], a[40:43], v[88:91]
    ds_read_b64_tr_b16 v[202:203], v234 offset:9728
    buffer_load_dwordx4 v240, s[16:19], s82 offen offset:0 sc1 lds
    v_mfma_f32_16x16x32_bf16 v[88:91], v[208:211], a[56:59], v[88:91]
    v_xor_b32 v218, 32, v216
    v_xor_b32 v220, 64, v216
    v_mfma_f32_16x16x32_bf16 v[92:95], v[204:207], a[44:47], v[92:95]
    v_add_u32 v217, 65536, v216
    v_add_u32 v219, 65536, v218
    v_mfma_f32_16x16x32_bf16 v[92:95], v[208:211], a[60:63], v[92:95]
    ds_read_b64_tr_b16 v[204:205], v234 offset:17408
    s_waitcnt lgkmcnt(3)
    v_mfma_f32_16x16x32_bf16 v[32:35], v[192:195], a[32:35], v[32:35]
    ds_read_b64_tr_b16 v[206:207], v234 offset:17920
    v_add_u32 v221, 65536, v220
    v_mfma_f32_16x16x32_bf16 v[32:35], v[196:199], a[48:51], v[32:35]
    s_add_u32 m0, s81, 142112
    v_lshlrev_b32 v244, 3, v243
    v_mfma_f32_16x16x32_bf16 v[36:39], v[192:195], a[36:39], v[36:39]
    buffer_load_dwordx4 v240, s[16:19], s80 offen offset:0 sc1 lds
    v_add_u32 v222, 73728, v244
    v_mfma_f32_16x16x32_bf16 v[36:39], v[196:199], a[52:55], v[36:39]
    ds_read_b64_tr_b16 v[208:209], v235 offset:8192
    s_mul_i32 s76, s32, 21760
    v_mfma_f32_16x16x32_bf16 v[40:43], v[192:195], a[40:43], v[40:43]
    ds_read_b64_tr_b16 v[210:211], v235 offset:8704
    s_add_u32 s76, s76, 76800
    v_mfma_f32_16x16x32_bf16 v[40:43], v[196:199], a[56:59], v[40:43]
    v_bfe_u32 v244, v243, 1, 2
    v_mul_u32_u24 v244, 4160, v244
    v_mfma_f32_16x16x32_bf16 v[44:47], v[192:195], a[44:47], v[44:47]
    v_and_b32 v245, 1, v243
    v_lshl_add_u32 v244, v245, 4, v244
    v_mfma_f32_16x16x32_bf16 v[44:47], v[196:199], a[60:63], v[44:47]
    ds_read_b64_tr_b16 v[192:193], v235 offset:16384
    s_waitcnt lgkmcnt(3)
    v_mfma_f32_16x16x32_bf16 v[96:99], v[200:203], a[32:35], v[96:99]
    ds_read_b64_tr_b16 v[194:195], v235 offset:16896
    s_add_u32 m0, s81, 98592
    v_mfma_f32_16x16x32_bf16 v[96:99], v[204:207], a[48:51], v[96:99]
    buffer_load_dwordx4 v240, s[16:19], s15 offen offset:1024 sc1 lds
    s_cmp_eq_u32 s32, 0
    s_cselect_b32 s77, 57344, s76
    v_mfma_f32_16x16x32_bf16 v[100:103], v[200:203], a[36:39], v[100:103]
    v_add_u32 v229, s77, v244
    v_and_b32 v245, 15, v243
    v_mfma_f32_16x16x32_bf16 v[100:103], v[204:207], a[52:55], v[100:103]
    ds_read_b64_tr_b16 v[196:197], v235 offset:9216
    v_lshrrev_b32 v246, 4, v243
    v_mfma_f32_16x16x32_bf16 v[104:107], v[200:203], a[40:43], v[104:107]
    ds_read_b64_tr_b16 v[198:199], v235 offset:9728
    v_mul_u32_u24 v223, 1152, v245
    v_mfma_f32_16x16x32_bf16 v[104:107], v[204:207], a[56:59], v[104:107]
    v_lshl_add_u32 v223, v246, 3, v223
    v_lshlrev_b32 v228, 5, v245
    v_mfma_f32_16x16x32_bf16 v[108:111], v[200:203], a[44:47], v[108:111]
    v_lshlrev_b32 v227, 4, v246
    v_sub_u32 v227, v227, v228
    v_mfma_f32_16x16x32_bf16 v[108:111], v[204:207], a[60:63], v[108:111]
    ds_read_b64_tr_b16 v[200:201], v235 offset:17408
    s_waitcnt lgkmcnt(3)
    v_mfma_f32_16x16x32_bf16 v[48:51], v[208:211], a[32:35], v[48:51]
    ds_read_b64_tr_b16 v[202:203], v235 offset:17920
    s_add_u32 m0, s81, 120352
    v_mfma_f32_16x16x32_bf16 v[48:51], v[192:195], a[48:51], v[48:51]
    buffer_load_dwordx4 v240, s[16:19], s82 offen offset:1024 sc1 lds
    v_lshrrev_b32 v244, 1, v246
    v_mfma_f32_16x16x32_bf16 v[52:55], v[208:211], a[36:39], v[52:55]
    s_waitcnt vmcnt(14) lgkmcnt(2)
    s_barrier
    v_mfma_f32_16x16x32_bf16 v[52:55], v[192:195], a[52:55], v[52:55]
    ds_read_b64_tr_b16 v[204:205], v232 offset:24576
    v_lshl_add_u32 v228, v244, 4, v228
    v_mfma_f32_16x16x32_bf16 v[56:59], v[208:211], a[40:43], v[56:59]
    ds_read_b64_tr_b16 v[206:207], v232 offset:25088
    v_and_b32 v244, 1, v246
    v_mfma_f32_16x16x32_bf16 v[56:59], v[192:195], a[56:59], v[56:59]
    s_add_u32 m0, s37, 0
    v_lshl_add_u32 v228, v244, 9, v228
    v_mfma_f32_16x16x32_bf16 v[60:63], v[208:211], a[44:47], v[60:63]
    buffer_load_dwordx4 v238, s[4:7], s48 offen lds
    s_add_u32 s77, s76, 17120
    v_mfma_f32_16x16x32_bf16 v[60:63], v[192:195], a[60:63], v[60:63]
    ds_read_b64_tr_b16 v[208:209], v232 offset:32768
    s_waitcnt lgkmcnt(3)
    v_mfma_f32_16x16x32_bf16 v[112:115], v[196:199], a[32:35], v[112:115]
    ds_read_b64_tr_b16 v[210:211], v232 offset:33280
    v_add_u32 v227, s77, v227
    v_mfma_f32_16x16x32_bf16 v[112:115], v[200:203], a[48:51], v[112:115]
    s_add_u32 m0, s81, 142112
    v_add_u32 v245, 1, v245
    v_mfma_f32_16x16x32_bf16 v[116:119], v[196:199], a[36:39], v[116:119]
    buffer_load_dwordx4 v240, s[16:19], s80 offen offset:1024 sc1 lds
    v_and_b32 v226, 3, v245
    v_mfma_f32_16x16x32_bf16 v[116:119], v[200:203], a[52:55], v[116:119]
    ds_read_b64_tr_b16 v[192:193], v232 offset:25600
    v_mul_u32_u24 v226, 4160, v226
    v_mfma_f32_16x16x32_bf16 v[120:123], v[196:199], a[40:43], v[120:123]
    ds_read_b64_tr_b16 v[194:195], v232 offset:26112
    v_lshrrev_b32 v245, 2, v245
    v_mfma_f32_16x16x32_bf16 v[120:123], v[200:203], a[56:59], v[120:123]
    s_add_u32 m0, s37, 0
    v_lshl_add_u32 v226, v245, 3, v226
    v_mfma_f32_16x16x32_bf16 v[124:127], v[196:199], a[44:47], v[124:127]
    buffer_load_dwordx4 v238, s[8:11], s48 offen offset:1024 lds
    v_lshl_add_u32 v226, v246, 4, v226
    v_mfma_f32_16x16x32_bf16 v[124:127], v[200:203], a[60:63], v[124:127]
    ds_read_b64_tr_b16 v[196:197], v232 offset:33792
    s_waitcnt lgkmcnt(3)
    v_mfma_f32_16x16x32_bf16 v[0:3], v[204:207], a[64:67], v[0:3]
    ds_read_b64_tr_b16 v[198:199], v232 offset:34304
    v_add_u32 v226, s76, v226
    v_mfma_f32_16x16x32_bf16 v[0:3], v[208:211], a[80:83], v[0:3]
    s_add_u32 m0, s81, 98592
    v_and_b32 v245, 3, v243
    v_mfma_f32_16x16x32_bf16 v[4:7], v[204:207], a[68:71], v[4:7]
    buffer_load_dwordx4 v240, s[16:19], s15 offen offset:2048 sc1 lds
    v_lshl_add_u32 v244, v244, 4, v245
    v_mfma_f32_16x16x32_bf16 v[4:7], v[208:211], a[84:87], v[4:7]
    ds_read_b64_tr_b16 v[200:201], v233 offset:24576
    v_mul_u32_u24 v224, 1152, v244
    v_mfma_f32_16x16x32_bf16 v[8:11], v[204:207], a[72:75], v[8:11]
    ds_read_b64_tr_b16 v[202:203], v233 offset:25088
    v_bfe_u32 v244, v243, 2, 2
    v_mfma_f32_16x16x32_bf16 v[8:11], v[208:211], a[88:91], v[8:11]
    s_add_u32 m0, s37, 8192
    v_lshl_add_u32 v224, v244, 3, v224
    v_mfma_f32_16x16x32_bf16 v[12:15], v[204:207], a[76:79], v[12:15]
    buffer_load_dwordx4 v238, s[4:7], s49 offen lds
    v_lshrrev_b32 v247, 5, v243
    v_mfma_f32_16x16x32_bf16 v[12:15], v[208:211], a[92:95], v[12:15]
    ds_read_b64_tr_b16 v[204:205], v233 offset:32768
    s_waitcnt lgkmcnt(3)
    v_mfma_f32_16x16x32_bf16 v[64:67], v[192:195], a[64:67], v[64:67]
    ds_read_b64_tr_b16 v[206:207], v233 offset:33280
    v_lshl_add_u32 v224, v247, 30, v224
    v_mfma_f32_16x16x32_bf16 v[64:67], v[196:199], a[80:83], v[64:67]
    s_add_u32 m0, s81, 120352
    v_lshlrev_b32 v245, 4, v245
    v_mfma_f32_16x16x32_bf16 v[68:71], v[192:195], a[68:71], v[68:71]
    buffer_load_dwordx4 v240, s[16:19], s82 offen offset:2048 sc1 lds
    v_lshl_add_u32 v245, v244, 8, v245
    v_mfma_f32_16x16x32_bf16 v[68:71], v[196:199], a[84:87], v[68:71]
    ds_read_b64_tr_b16 v[208:209], v233 offset:25600
    v_lshl_add_u32 v225, v246, 10, v245
    v_mfma_f32_16x16x32_bf16 v[72:75], v[192:195], a[72:75], v[72:75]
    ds_read_b64_tr_b16 v[210:211], v233 offset:26112
    s_and_b32 s14, s2, 0x3f
    v_mfma_f32_16x16x32_bf16 v[72:75], v[196:199], a[88:91], v[72:75]
    s_add_u32 m0, s37, 8192
    v_and_b32 v245, 3, v243
    v_mfma_f32_16x16x32_bf16 v[76:79], v[192:195], a[76:79], v[76:79]
    buffer_load_dwordx4 v238, s[8:11], s49 offen offset:1024 lds
    v_lshl_add_u32 v245, v245, 6, s14
    v_mfma_f32_16x16x32_bf16 v[76:79], v[196:199], a[92:95], v[76:79]
    ds_read_b64_tr_b16 v[192:193], v233 offset:33792
    s_waitcnt lgkmcnt(3)
    v_mfma_f32_16x16x32_bf16 v[16:19], v[200:203], a[64:67], v[16:19]
    ds_read_b64_tr_b16 v[194:195], v233 offset:34304
    v_lshl_add_u32 v245, v245, 2, s32
    v_mfma_f32_16x16x32_bf16 v[16:19], v[204:207], a[80:83], v[16:19]
    s_add_u32 m0, s81, 142112
    v_lshlrev_b32 v253, 7, v245
    v_mfma_f32_16x16x32_bf16 v[20:23], v[200:203], a[68:71], v[20:23]
    buffer_load_dwordx4 v240, s[16:19], s80 offen offset:2048 sc1 lds
    s_mov_b32 s14, 9633792
    v_mfma_f32_16x16x32_bf16 v[20:23], v[204:207], a[84:87], v[20:23]
    ds_read_b64_tr_b16 v[196:197], v234 offset:24576
    v_mfma_f32_16x16x32_bf16 v[24:27], v[200:203], a[72:75], v[24:27]
    ds_read_b64_tr_b16 v[198:199], v234 offset:25088
    v_mfma_f32_16x16x32_bf16 v[24:27], v[204:207], a[88:91], v[24:27]
    v_mfma_f32_16x16x32_bf16 v[28:31], v[200:203], a[76:79], v[28:31]
    v_mfma_f32_16x16x32_bf16 v[28:31], v[204:207], a[92:95], v[28:31]
    ds_read_b64_tr_b16 v[200:201], v234 offset:32768
    s_waitcnt lgkmcnt(3)
    v_mfma_f32_16x16x32_bf16 v[80:83], v[208:211], a[64:67], v[80:83]
    ds_read_b64_tr_b16 v[202:203], v234 offset:33280
    s_add_u32 m0, s81, 98592
    v_mfma_f32_16x16x32_bf16 v[80:83], v[192:195], a[80:83], v[80:83]
    buffer_load_dwordx4 v240, s[16:19], s15 offen offset:3072 sc1 lds
    v_mfma_f32_16x16x32_bf16 v[84:87], v[208:211], a[68:71], v[84:87]
    v_mfma_f32_16x16x32_bf16 v[84:87], v[192:195], a[84:87], v[84:87]
    ds_read_b64_tr_b16 v[204:205], v234 offset:25600
    v_mfma_f32_16x16x32_bf16 v[88:91], v[208:211], a[72:75], v[88:91]
    ds_read_b64_tr_b16 v[206:207], v234 offset:26112
    v_mfma_f32_16x16x32_bf16 v[88:91], v[192:195], a[88:91], v[88:91]
    v_mfma_f32_16x16x32_bf16 v[92:95], v[208:211], a[76:79], v[92:95]
    v_mfma_f32_16x16x32_bf16 v[92:95], v[192:195], a[92:95], v[92:95]
    ds_read_b64_tr_b16 v[208:209], v234 offset:33792
    s_waitcnt lgkmcnt(3)
    v_mfma_f32_16x16x32_bf16 v[32:35], v[196:199], a[64:67], v[32:35]
    ds_read_b64_tr_b16 v[210:211], v234 offset:34304
    s_add_u32 m0, s81, 120352
    v_mfma_f32_16x16x32_bf16 v[32:35], v[200:203], a[80:83], v[32:35]
    buffer_load_dwordx4 v240, s[16:19], s82 offen offset:3072 sc1 lds
    v_mfma_f32_16x16x32_bf16 v[36:39], v[196:199], a[68:71], v[36:39]
    v_mfma_f32_16x16x32_bf16 v[36:39], v[200:203], a[84:87], v[36:39]
    ds_read_b64_tr_b16 v[192:193], v235 offset:24576
    v_mfma_f32_16x16x32_bf16 v[40:43], v[196:199], a[72:75], v[40:43]
    ds_read_b64_tr_b16 v[194:195], v235 offset:25088
    v_mfma_f32_16x16x32_bf16 v[40:43], v[200:203], a[88:91], v[40:43]
    v_mfma_f32_16x16x32_bf16 v[44:47], v[196:199], a[76:79], v[44:47]
    v_mfma_f32_16x16x32_bf16 v[44:47], v[200:203], a[92:95], v[44:47]
    ds_read_b64_tr_b16 v[196:197], v235 offset:32768
    s_waitcnt lgkmcnt(3)
    v_mfma_f32_16x16x32_bf16 v[96:99], v[204:207], a[64:67], v[96:99]
    ds_read_b64_tr_b16 v[198:199], v235 offset:33280
    s_add_u32 m0, s81, 142112
    v_mfma_f32_16x16x32_bf16 v[96:99], v[208:211], a[80:83], v[96:99]
    buffer_load_dwordx4 v240, s[16:19], s80 offen offset:3072 sc1 lds
    v_mfma_f32_16x16x32_bf16 v[100:103], v[204:207], a[68:71], v[100:103]
    v_mfma_f32_16x16x32_bf16 v[100:103], v[208:211], a[84:87], v[100:103]
    ds_read_b64_tr_b16 v[200:201], v235 offset:25600
    v_mfma_f32_16x16x32_bf16 v[104:107], v[204:207], a[72:75], v[104:107]
    ds_read_b64_tr_b16 v[202:203], v235 offset:26112
    v_mfma_f32_16x16x32_bf16 v[104:107], v[208:211], a[88:91], v[104:107]
    buffer_load_dwordx4 a[0:3], v240, s[16:19], s58 offen offset:0 sc1
    v_mfma_f32_16x16x32_bf16 v[108:111], v[204:207], a[76:79], v[108:111]
    v_mfma_f32_16x16x32_bf16 v[108:111], v[208:211], a[92:95], v[108:111]
    ds_read_b64_tr_b16 v[204:205], v235 offset:33792
    s_waitcnt lgkmcnt(3)
    v_mfma_f32_16x16x32_bf16 v[48:51], v[192:195], a[64:67], v[48:51]
    ds_read_b64_tr_b16 v[206:207], v235 offset:34304
    v_mfma_f32_16x16x32_bf16 v[48:51], v[196:199], a[80:83], v[48:51]
    buffer_load_dwordx4 a[4:7], v240, s[16:19], s58 offen offset:1024 sc1
    v_mfma_f32_16x16x32_bf16 v[52:55], v[192:195], a[68:71], v[52:55]
    s_waitcnt vmcnt(19) lgkmcnt(2)
    s_barrier
    v_mfma_f32_16x16x32_bf16 v[52:55], v[196:199], a[84:87], v[52:55]
    ds_read_b64_tr_b16 v[208:209], v232 offset:40960
    v_mfma_f32_16x16x32_bf16 v[56:59], v[192:195], a[72:75], v[56:59]
    ds_read_b64_tr_b16 v[210:211], v232 offset:41472
    v_mfma_f32_16x16x32_bf16 v[56:59], v[196:199], a[88:91], v[56:59]
    s_add_u32 m0, s37, 16384
    v_mfma_f32_16x16x32_bf16 v[60:63], v[192:195], a[76:79], v[60:63]
    buffer_load_dwordx4 v238, s[4:7], s50 offen lds
    v_mfma_f32_16x16x32_bf16 v[60:63], v[196:199], a[92:95], v[60:63]
    ds_read_b64_tr_b16 v[192:193], v232 offset:49152
    s_waitcnt lgkmcnt(3)
    v_mfma_f32_16x16x32_bf16 v[112:115], v[200:203], a[64:67], v[112:115]
    ds_read_b64_tr_b16 v[194:195], v232 offset:49664
    v_mfma_f32_16x16x32_bf16 v[112:115], v[204:207], a[80:83], v[112:115]
    v_mfma_f32_16x16x32_bf16 v[116:119], v[200:203], a[68:71], v[116:119]
    buffer_load_dwordx4 a[8:11], v240, s[16:19], s58 offen offset:2048 sc1
    v_mfma_f32_16x16x32_bf16 v[116:119], v[204:207], a[84:87], v[116:119]
    ds_read_b64_tr_b16 v[196:197], v232 offset:41984
    v_mfma_f32_16x16x32_bf16 v[120:123], v[200:203], a[72:75], v[120:123]
    ds_read_b64_tr_b16 v[198:199], v232 offset:42496
    v_mfma_f32_16x16x32_bf16 v[120:123], v[204:207], a[88:91], v[120:123]
    s_add_u32 m0, s37, 16384
    v_mfma_f32_16x16x32_bf16 v[124:127], v[200:203], a[76:79], v[124:127]
    buffer_load_dwordx4 v238, s[8:11], s50 offen offset:1024 lds
    v_mfma_f32_16x16x32_bf16 v[124:127], v[204:207], a[92:95], v[124:127]
    ds_read_b64_tr_b16 v[200:201], v232 offset:50176
    s_waitcnt lgkmcnt(3)
    v_mfma_f32_16x16x32_bf16 v[0:3], v[208:211], a[96:99], v[0:3]
    ds_read_b64_tr_b16 v[202:203], v232 offset:50688
    v_mfma_f32_16x16x32_bf16 v[0:3], v[192:195], a[112:115], v[0:3]
    v_mfma_f32_16x16x32_bf16 v[4:7], v[208:211], a[100:103], v[4:7]
    buffer_load_dwordx4 a[12:15], v240, s[16:19], s58 offen offset:3072 sc1
    v_mfma_f32_16x16x32_bf16 v[4:7], v[192:195], a[116:119], v[4:7]
    ds_read_b64_tr_b16 v[204:205], v233 offset:40960
    v_mfma_f32_16x16x32_bf16 v[8:11], v[208:211], a[104:107], v[8:11]
    ds_read_b64_tr_b16 v[206:207], v233 offset:41472
    v_mfma_f32_16x16x32_bf16 v[8:11], v[192:195], a[120:123], v[8:11]
    s_add_u32 m0, s37, 24576
    v_mfma_f32_16x16x32_bf16 v[12:15], v[208:211], a[108:111], v[12:15]
    buffer_load_dwordx4 v238, s[4:7], s51 offen lds
    v_mfma_f32_16x16x32_bf16 v[12:15], v[192:195], a[124:127], v[12:15]
    ds_read_b64_tr_b16 v[208:209], v233 offset:49152
    s_waitcnt lgkmcnt(3)
    v_mfma_f32_16x16x32_bf16 v[64:67], v[196:199], a[96:99], v[64:67]
    ds_read_b64_tr_b16 v[210:211], v233 offset:49664
    v_mfma_f32_16x16x32_bf16 v[64:67], v[200:203], a[112:115], v[64:67]
    v_mfma_f32_16x16x32_bf16 v[68:71], v[196:199], a[100:103], v[68:71]
    buffer_load_dwordx4 a[16:19], v241, s[16:19], s58 offen offset:0 sc1
    v_mfma_f32_16x16x32_bf16 v[68:71], v[200:203], a[116:119], v[68:71]
    ds_read_b64_tr_b16 v[192:193], v233 offset:41984
    v_mfma_f32_16x16x32_bf16 v[72:75], v[196:199], a[104:107], v[72:75]
    ds_read_b64_tr_b16 v[194:195], v233 offset:42496
    v_mfma_f32_16x16x32_bf16 v[72:75], v[200:203], a[120:123], v[72:75]
    s_add_u32 m0, s37, 24576
    v_mfma_f32_16x16x32_bf16 v[76:79], v[196:199], a[108:111], v[76:79]
    buffer_load_dwordx4 v238, s[8:11], s51 offen offset:1024 lds
    v_mfma_f32_16x16x32_bf16 v[76:79], v[200:203], a[124:127], v[76:79]
    ds_read_b64_tr_b16 v[196:197], v233 offset:50176
    s_waitcnt lgkmcnt(3)
    v_mfma_f32_16x16x32_bf16 v[16:19], v[204:207], a[96:99], v[16:19]
    ds_read_b64_tr_b16 v[198:199], v233 offset:50688
    v_mfma_f32_16x16x32_bf16 v[16:19], v[208:211], a[112:115], v[16:19]
    v_mfma_f32_16x16x32_bf16 v[20:23], v[204:207], a[100:103], v[20:23]
    buffer_load_dwordx4 a[20:23], v241, s[16:19], s58 offen offset:1024 sc1
    v_mfma_f32_16x16x32_bf16 v[20:23], v[208:211], a[116:119], v[20:23]
    ds_read_b64_tr_b16 v[200:201], v234 offset:40960
    v_mfma_f32_16x16x32_bf16 v[24:27], v[204:207], a[104:107], v[24:27]
    ds_read_b64_tr_b16 v[202:203], v234 offset:41472
    v_mfma_f32_16x16x32_bf16 v[24:27], v[208:211], a[120:123], v[24:27]
    v_mfma_f32_16x16x32_bf16 v[28:31], v[204:207], a[108:111], v[28:31]
    buffer_load_dwordx4 a[24:27], v241, s[16:19], s58 offen offset:2048 sc1
    v_mfma_f32_16x16x32_bf16 v[28:31], v[208:211], a[124:127], v[28:31]
    ds_read_b64_tr_b16 v[204:205], v234 offset:49152
    s_waitcnt lgkmcnt(3)
    v_mfma_f32_16x16x32_bf16 v[80:83], v[192:195], a[96:99], v[80:83]
    ds_read_b64_tr_b16 v[206:207], v234 offset:49664
    v_mfma_f32_16x16x32_bf16 v[80:83], v[196:199], a[112:115], v[80:83]
    v_mfma_f32_16x16x32_bf16 v[84:87], v[192:195], a[100:103], v[84:87]
    buffer_load_dwordx4 a[28:31], v241, s[16:19], s58 offen offset:3072 sc1
    v_mfma_f32_16x16x32_bf16 v[84:87], v[196:199], a[116:119], v[84:87]
    ds_read_b64_tr_b16 v[208:209], v234 offset:41984
    v_mfma_f32_16x16x32_bf16 v[88:91], v[192:195], a[104:107], v[88:91]
    ds_read_b64_tr_b16 v[210:211], v234 offset:42496
    v_mfma_f32_16x16x32_bf16 v[88:91], v[196:199], a[120:123], v[88:91]
    v_mfma_f32_16x16x32_bf16 v[92:95], v[192:195], a[108:111], v[92:95]
    v_mfma_f32_16x16x32_bf16 v[92:95], v[196:199], a[124:127], v[92:95]
    ds_read_b64_tr_b16 v[192:193], v234 offset:50176
    s_waitcnt lgkmcnt(3)
    v_mfma_f32_16x16x32_bf16 v[32:35], v[200:203], a[96:99], v[32:35]
    ds_read_b64_tr_b16 v[194:195], v234 offset:50688
    v_mfma_f32_16x16x32_bf16 v[32:35], v[204:207], a[112:115], v[32:35]
    v_mfma_f32_16x16x32_bf16 v[36:39], v[200:203], a[100:103], v[36:39]
    buffer_load_dwordx2 v[250:251], v253, s[16:19], s14 offen sc1
    v_mfma_f32_16x16x32_bf16 v[36:39], v[204:207], a[116:119], v[36:39]
    ds_read_b64_tr_b16 v[196:197], v235 offset:40960
    s_lshr_b32 s79, s2, 3
    v_mfma_f32_16x16x32_bf16 v[40:43], v[200:203], a[104:107], v[40:43]
    ds_read_b64_tr_b16 v[198:199], v235 offset:41472
    s_lshl2_add_u32 s79, s79, s32
    v_mfma_f32_16x16x32_bf16 v[40:43], v[204:207], a[120:123], v[40:43]
    s_lshl_b32 s82, s33, 7
    s_add_u32 s79, s79, s82
    v_mfma_f32_16x16x32_bf16 v[44:47], v[200:203], a[108:111], v[44:47]
    s_mul_i32 s79, s79, 5184
    s_and_b32 s79, s79, -128
    v_mfma_f32_16x16x32_bf16 v[44:47], v[204:207], a[124:127], v[44:47]
    ds_read_b64_tr_b16 v[200:201], v235 offset:49152
    s_waitcnt lgkmcnt(3)
    v_mfma_f32_16x16x32_bf16 v[96:99], v[208:211], a[96:99], v[96:99]
    ds_read_b64_tr_b16 v[202:203], v235 offset:49664
    v_min_u32 v245, 40, v243
    v_mfma_f32_16x16x32_bf16 v[96:99], v[192:195], a[112:115], v[96:99]
    v_lshlrev_b32 v245, 7, v245
    v_mfma_f32_16x16x32_bf16 v[100:103], v[208:211], a[100:103], v[100:103]
    buffer_load_dword v246, v245, s[20:23], s79 offen
    v_mfma_f32_16x16x32_bf16 v[100:103], v[192:195], a[116:119], v[100:103]
    ds_read_b64_tr_b16 v[204:205], v235 offset:41984
    v_mfma_f32_16x16x32_bf16 v[104:107], v[208:211], a[104:107], v[104:107]
    ds_read_b64_tr_b16 v[206:207], v235 offset:42496
    v_mfma_f32_16x16x32_bf16 v[104:107], v[192:195], a[120:123], v[104:107]
    v_mfma_f32_16x16x32_bf16 v[108:111], v[208:211], a[108:111], v[108:111]
    v_mfma_f32_16x16x32_bf16 v[108:111], v[192:195], a[124:127], v[108:111]
    ds_read_b64_tr_b16 v[208:209], v235 offset:50176
    s_waitcnt lgkmcnt(3)
    v_mfma_f32_16x16x32_bf16 v[48:51], v[196:199], a[96:99], v[48:51]
    ds_read_b64_tr_b16 v[210:211], v235 offset:50688
    v_mfma_f32_16x16x32_bf16 v[48:51], v[200:203], a[112:115], v[48:51]
    v_mfma_f32_16x16x32_bf16 v[52:55], v[196:199], a[100:103], v[52:55]
    s_waitcnt vmcnt(18) lgkmcnt(2)
    s_barrier
    v_mfma_f32_16x16x32_bf16 v[52:55], v[200:203], a[116:119], v[52:55]
    ds_read_b64_tr_b16 v[192:193], v232 offset:0
    v_mfma_f32_16x16x32_bf16 v[56:59], v[196:199], a[104:107], v[56:59]
    ds_read_b64_tr_b16 v[194:195], v232 offset:512
    s_lshl_b32 s76, s35, 7
    v_mfma_f32_16x16x32_bf16 v[56:59], v[200:203], a[120:123], v[56:59]
    s_add_u32 m0, s37, 32768
    s_lshl_b32 s43, s33, 4
    v_mfma_f32_16x16x32_bf16 v[60:63], v[196:199], a[108:111], v[60:63]
    buffer_load_dwordx4 v238, s[4:7], s52 offen lds
    s_lshl4_add_u32 s77, s35, 512
    v_mfma_f32_16x16x32_bf16 v[60:63], v[200:203], a[124:127], v[60:63]
    ds_read_b64_tr_b16 v[196:197], v232 offset:8192
    s_waitcnt lgkmcnt(3)
    v_mfma_f32_16x16x32_bf16 v[112:115], v[204:207], a[96:99], v[112:115]
    ds_read_b64_tr_b16 v[198:199], v232 offset:8704
    s_add_u32 s76, s76, s43
    v_mfma_f32_16x16x32_bf16 v[112:115], v[208:211], a[112:115], v[112:115]
    s_lshl_b32 s78, s34, 3
    s_add_u32 s78, s78, s33
    v_mfma_f32_16x16x32_bf16 v[116:119], v[204:207], a[100:103], v[116:119]
    s_lshl_b32 s40, s76, 12
    s_lshl_b32 s43, s36, 7
    v_mfma_f32_16x16x32_bf16 v[116:119], v[208:211], a[116:119], v[116:119]
    ds_read_b64_tr_b16 v[200:201], v232 offset:1024
    s_add_u32 s40, s40, s43
    v_mfma_f32_16x16x32_bf16 v[120:123], v[204:207], a[104:107], v[120:123]
    ds_read_b64_tr_b16 v[202:203], v232 offset:1536
    s_add_u32 s40, s40, 6291456
    v_mfma_f32_16x16x32_bf16 v[120:123], v[208:211], a[120:123], v[120:123]
    s_add_u32 m0, s37, 32768
    s_and_b32 s45, s33, 1
    v_mfma_f32_16x16x32_bf16 v[124:127], v[204:207], a[108:111], v[124:127]
    buffer_load_dwordx4 v238, s[8:11], s52 offen offset:1024 lds
    s_lshl_b32 s43, s45, 6
    v_mfma_f32_16x16x32_bf16 v[124:127], v[208:211], a[124:127], v[124:127]
    ds_read_b64_tr_b16 v[204:205], v232 offset:9216
    s_waitcnt lgkmcnt(3)
    v_mfma_f32_16x16x32_bf16 v[0:3], v[192:195], a[128:131], v[0:3]
    ds_read_b64_tr_b16 v[206:207], v232 offset:9728
    s_add_u32 s40, s40, s43
    v_mfma_f32_16x16x32_bf16 v[0:3], v[196:199], a[144:147], v[0:3]
    s_xor_b32 s41, s40, 65536
    s_sub_u32 s41, s41, 1024
    v_mfma_f32_16x16x32_bf16 v[4:7], v[192:195], a[132:135], v[4:7]
    s_lshl_b32 s42, s77, 12
    s_lshl_b32 s43, s78, 6
    v_mfma_f32_16x16x32_bf16 v[4:7], v[196:199], a[148:151], v[4:7]
    ds_read_b64_tr_b16 v[208:209], v233 offset:0
    s_add_u32 s42, s42, s43
    v_mfma_f32_16x16x32_bf16 v[8:11], v[192:195], a[136:139], v[8:11]
    ds_read_b64_tr_b16 v[210:211], v233 offset:512
    s_add_u32 s42, s42, 6289408
    v_mfma_f32_16x16x32_bf16 v[8:11], v[196:199], a[152:155], v[8:11]
    s_add_u32 m0, s37, 40960
    s_lshl1_add_u32 s44, s36, s45
    v_mfma_f32_16x16x32_bf16 v[12:15], v[192:195], a[140:143], v[12:15]
    buffer_load_dwordx4 v238, s[4:7], s53 offen lds
    s_mul_i32 s44, s44, 36864
    v_mfma_f32_16x16x32_bf16 v[12:15], v[196:199], a[156:159], v[12:15]
    ds_read_b64_tr_b16 v[192:193], v233 offset:8192
    s_waitcnt lgkmcnt(3)
    v_mfma_f32_16x16x32_bf16 v[64:67], v[200:203], a[128:131], v[64:67]
    ds_read_b64_tr_b16 v[194:195], v233 offset:8704
    s_lshl_b32 s43, s76, 1
    v_mfma_f32_16x16x32_bf16 v[64:67], v[204:207], a[144:147], v[64:67]
    s_add_u32 s44, s44, s43
    s_add_u32 s45, s44, 18432
    v_mfma_f32_16x16x32_bf16 v[68:71], v[200:203], a[132:135], v[68:71]
    s_xor_b32 s46, s44, 32
    s_xor_b32 s47, s45, 32
    v_mfma_f32_16x16x32_bf16 v[68:71], v[204:207], a[148:151], v[68:71]
    ds_read_b64_tr_b16 v[196:197], v233 offset:1024
    s_lshl_b32 s48, s78, 3
    v_mfma_f32_16x16x32_bf16 v[72:75], v[200:203], a[136:139], v[72:75]
    ds_read_b64_tr_b16 v[198:199], v233 offset:1536
    s_add_u32 s48, s48, s32
    v_mfma_f32_16x16x32_bf16 v[72:75], v[204:207], a[152:155], v[72:75]
    s_add_u32 m0, s37, 40960
    s_mul_i32 s48, s48, 4608
    v_mfma_f32_16x16x32_bf16 v[76:79], v[200:203], a[140:143], v[76:79]
    buffer_load_dwordx4 v238, s[8:11], s53 offen offset:1024 lds
    s_lshl_b32 s43, s77, 1
    v_mfma_f32_16x16x32_bf16 v[76:79], v[204:207], a[156:159], v[76:79]
    ds_read_b64_tr_b16 v[200:201], v233 offset:9216
    s_waitcnt lgkmcnt(3)
    v_mfma_f32_16x16x32_bf16 v[16:19], v[208:211], a[128:131], v[16:19]
    ds_read_b64_tr_b16 v[202:203], v233 offset:9728
    s_add_u32 s48, s48, s43
    v_mfma_f32_16x16x32_bf16 v[16:19], v[192:195], a[144:147], v[16:19]
    s_and_b32 s49, s100, 0xffff0000
    s_lshl_b32 s43, s32, 6
    v_mfma_f32_16x16x32_bf16 v[20:23], v[208:211], a[132:135], v[20:23]
    s_add_u32 s49, s49, s43
    s_cmp_lt_u32 s83, 576
    s_cselect_b32 s51, 0, 1073741824
    v_mfma_f32_16x16x32_bf16 v[20:23], v[192:195], a[148:151], v[20:23]
    ds_read_b64_tr_b16 v[204:205], v234 offset:0
    s_lshl_b32 s43, s83, 12
    v_mfma_f32_16x16x32_bf16 v[24:27], v[208:211], a[136:139], v[24:27]
    ds_read_b64_tr_b16 v[206:207], v234 offset:512
    s_add_u32 s43, s43, s51
    v_mfma_f32_16x16x32_bf16 v[24:27], v[192:195], a[152:155], v[24:27]
    s_add_u32 s43, s43, 6291456
    s_lshl_b32 s50, s83, 7
    v_mfma_f32_16x16x32_bf16 v[28:31], v[208:211], a[140:143], v[28:31]
    s_add_u32 s50, s50, s51
    s_add_u32 s50, s50, 9895936
    v_mfma_f32_16x16x32_bf16 v[28:31], v[192:195], a[156:159], v[28:31]
    ds_read_b64_tr_b16 v[208:209], v234 offset:8192
    s_waitcnt lgkmcnt(3)
    v_mfma_f32_16x16x32_bf16 v[80:83], v[196:199], a[128:131], v[80:83]
    ds_read_b64_tr_b16 v[210:211], v234 offset:8704
    s_mov_b32 s51, 0xffff0000
    v_mfma_f32_16x16x32_bf16 v[80:83], v[200:203], a[144:147], v[80:83]
    s_and_b32 s80, s33, 4
    s_lshl_b32 s80, s80, 6
    v_mfma_f32_16x16x32_bf16 v[84:87], v[196:199], a[132:135], v[84:87]
    s_sub_u32 s80, 128, s80
    v_add_u32 v237, s80, v254
    v_mfma_f32_16x16x32_bf16 v[84:87], v[200:203], a[148:151], v[84:87]
    ds_read_b64_tr_b16 v[192:193], v234 offset:1024
    v_add_u32 v239, s80, v255
    v_mfma_f32_16x16x32_bf16 v[88:91], v[196:199], a[136:139], v[88:91]
    ds_read_b64_tr_b16 v[194:195], v234 offset:1536
    s_lshl_b32 s80, s32, 1
    v_mfma_f32_16x16x32_bf16 v[88:91], v[200:203], a[152:155], v[88:91]
    s_lshr_b32 s80, 0xd8, s80
    s_and_b32 s80, s80, 3
    v_mfma_f32_16x16x32_bf16 v[92:95], v[196:199], a[140:143], v[92:95]
    s_lshl_b32 s80, s80, 10
    v_mfma_f32_16x16x32_bf16 v[92:95], v[200:203], a[156:159], v[92:95]
    ds_read_b64_tr_b16 v[196:197], v234 offset:9216
    s_waitcnt lgkmcnt(3)
    v_mfma_f32_16x16x32_bf16 v[32:35], v[204:207], a[128:131], v[32:35]
    ds_read_b64_tr_b16 v[198:199], v234 offset:9728
    v_mfma_f32_16x16x32_bf16 v[32:35], v[208:211], a[144:147], v[32:35]
    v_mfma_f32_16x16x32_bf16 v[36:39], v[204:207], a[132:135], v[36:39]
    v_mfma_f32_16x16x32_bf16 v[36:39], v[208:211], a[148:151], v[36:39]
    ds_read_b64_tr_b16 v[200:201], v235 offset:0
    v_mfma_f32_16x16x32_bf16 v[40:43], v[204:207], a[136:139], v[40:43]
    ds_read_b64_tr_b16 v[202:203], v235 offset:512
    v_mfma_f32_16x16x32_bf16 v[40:43], v[208:211], a[152:155], v[40:43]
    v_mfma_f32_16x16x32_bf16 v[44:47], v[204:207], a[140:143], v[44:47]
    v_mfma_f32_16x16x32_bf16 v[44:47], v[208:211], a[156:159], v[44:47]
    ds_read_b64_tr_b16 v[204:205], v235 offset:8192
    s_waitcnt lgkmcnt(3)
    v_mfma_f32_16x16x32_bf16 v[96:99], v[192:195], a[128:131], v[96:99]
    ds_read_b64_tr_b16 v[206:207], v235 offset:8704
    s_waitcnt vmcnt(5)
    v_mfma_f32_16x16x32_bf16 v[96:99], v[196:199], a[144:147], v[96:99]
    v_cmp_ne_u64 vcc, v[250:251], v[248:249]
    s_cbranch_vccnz L_slow_14
L_back_15:
    v_mfma_f32_16x16x32_bf16 v[100:103], v[192:195], a[132:135], v[100:103]
    v_and_b32 v212, 6, v243
    v_mul_i32_i24 v212, -8, v212
    v_mfma_f32_16x16x32_bf16 v[100:103], v[196:199], a[148:151], v[100:103]
    ds_read_b64_tr_b16 v[208:209], v235 offset:1024
    v_lshlrev_b64 v[214:215], v212, v[214:215]
    v_mfma_f32_16x16x32_bf16 v[104:107], v[192:195], a[136:139], v[104:107]
    ds_read_b64_tr_b16 v[210:211], v235 offset:1536
    v_mov_b32 v212, 0
    v_mfma_f32_16x16x32_bf16 v[104:107], v[196:199], a[152:155], v[104:107]
    v_mov_b32 v213, 0
    ds_write_b128 v229, v[212:215]
    v_mfma_f32_16x16x32_bf16 v[108:111], v[192:195], a[140:143], v[108:111]
    v_mfma_f32_16x16x32_bf16 v[108:111], v[196:199], a[156:159], v[108:111]
    ds_read_b64_tr_b16 v[192:193], v235 offset:9216
    s_waitcnt lgkmcnt(4)
    v_mfma_f32_16x16x32_bf16 v[48:51], v[200:203], a[128:131], v[48:51]
    ds_read_b64_tr_b16 v[194:195], v235 offset:9728
    v_mfma_f32_16x16x32_bf16 v[48:51], v[204:207], a[144:147], v[48:51]
    v_mfma_f32_16x16x32_bf16 v[52:55], v[200:203], a[132:135], v[52:55]
    s_waitcnt lgkmcnt(3)
    s_barrier
    v_mfma_f32_16x16x32_bf16 v[52:55], v[204:207], a[148:151], v[52:55]
    ds_read_b64_tr_b16 v[196:197], v232 offset:16384
    v_mfma_f32_16x16x32_bf16 v[56:59], v[200:203], a[136:139], v[56:59]
    ds_read_b64_tr_b16 v[198:199], v232 offset:16896
    v_mfma_f32_16x16x32_bf16 v[56:59], v[204:207], a[152:155], v[56:59]
    s_add_u32 m0, s37, 49152
    v_mfma_f32_16x16x32_bf16 v[60:63], v[200:203], a[140:143], v[60:63]
    buffer_load_dwordx4 v238, s[4:7], s54 offen lds
    v_mfma_f32_16x16x32_bf16 v[60:63], v[204:207], a[156:159], v[60:63]
    ds_read_b64_tr_b16 v[200:201], v232 offset:24576
    s_waitcnt lgkmcnt(3)
    v_mfma_f32_16x16x32_bf16 v[112:115], v[208:211], a[128:131], v[112:115]
    ds_read_b64_tr_b16 v[202:203], v232 offset:25088
    v_mfma_f32_16x16x32_bf16 v[112:115], v[192:195], a[144:147], v[112:115]
    v_mfma_f32_16x16x32_bf16 v[116:119], v[208:211], a[132:135], v[116:119]
    buffer_load_dwordx4 a[32:35], v240, s[16:19], s59 offen offset:0 sc1
    v_mfma_f32_16x16x32_bf16 v[116:119], v[192:195], a[148:151], v[116:119]
    ds_read_b64_tr_b16 v[204:205], v232 offset:17408
    v_mfma_f32_16x16x32_bf16 v[120:123], v[208:211], a[136:139], v[120:123]
    ds_read_b64_tr_b16 v[206:207], v232 offset:17920
    v_mfma_f32_16x16x32_bf16 v[120:123], v[192:195], a[152:155], v[120:123]
    s_add_u32 m0, s37, 49152
    v_mfma_f32_16x16x32_bf16 v[124:127], v[208:211], a[140:143], v[124:127]
    buffer_load_dwordx4 v238, s[8:11], s54 offen offset:1024 lds
    v_mfma_f32_16x16x32_bf16 v[124:127], v[192:195], a[156:159], v[124:127]
    ds_read_b64_tr_b16 v[208:209], v232 offset:25600
    s_waitcnt lgkmcnt(3)
    v_mfma_f32_16x16x32_bf16 v[0:3], v[196:199], a[160:163], v[0:3]
    ds_read_b64_tr_b16 v[210:211], v232 offset:26112
    v_mfma_f32_16x16x32_bf16 v[0:3], v[200:203], a[176:179], v[0:3]
    v_mfma_f32_16x16x32_bf16 v[4:7], v[196:199], a[164:167], v[4:7]
    buffer_load_dwordx4 a[36:39], v240, s[16:19], s59 offen offset:1024 sc1
    v_mfma_f32_16x16x32_bf16 v[4:7], v[200:203], a[180:183], v[4:7]
    ds_read_b64_tr_b16 v[192:193], v233 offset:16384
    v_mfma_f32_16x16x32_bf16 v[8:11], v[196:199], a[168:171], v[8:11]
    ds_read_b64_tr_b16 v[194:195], v233 offset:16896
    v_mfma_f32_16x16x32_bf16 v[8:11], v[200:203], a[184:187], v[8:11]
    s_add_u32 m0, s37, 0
    v_mfma_f32_16x16x32_bf16 v[12:15], v[196:199], a[172:175], v[12:15]
    buffer_load_dwordx4 v238, s[4:7], s55 offen lds
    v_mfma_f32_16x16x32_bf16 v[12:15], v[200:203], a[188:191], v[12:15]
    ds_read_b64_tr_b16 v[196:197], v233 offset:24576
    s_waitcnt lgkmcnt(3)
    v_mfma_f32_16x16x32_bf16 v[64:67], v[204:207], a[160:163], v[64:67]
    ds_read_b64_tr_b16 v[198:199], v233 offset:25088
    v_mfma_f32_16x16x32_bf16 v[64:67], v[208:211], a[176:179], v[64:67]
    v_mfma_f32_16x16x32_bf16 v[68:71], v[204:207], a[164:167], v[68:71]
    buffer_load_dwordx4 a[40:43], v240, s[16:19], s59 offen offset:2048 sc1
    v_mfma_f32_16x16x32_bf16 v[68:71], v[208:211], a[180:183], v[68:71]
    ds_read_b64_tr_b16 v[200:201], v233 offset:17408
    v_mfma_f32_16x16x32_bf16 v[72:75], v[204:207], a[168:171], v[72:75]
    ds_read_b64_tr_b16 v[202:203], v233 offset:17920
    v_mfma_f32_16x16x32_bf16 v[72:75], v[208:211], a[184:187], v[72:75]
    s_add_u32 m0, s37, 0
    v_mfma_f32_16x16x32_bf16 v[76:79], v[204:207], a[172:175], v[76:79]
    buffer_load_dwordx4 v238, s[8:11], s55 offen offset:1024 lds
    v_mfma_f32_16x16x32_bf16 v[76:79], v[208:211], a[188:191], v[76:79]
    ds_read_b64_tr_b16 v[204:205], v233 offset:25600
    s_waitcnt lgkmcnt(3)
    v_mfma_f32_16x16x32_bf16 v[16:19], v[192:195], a[160:163], v[16:19]
    ds_read_b64_tr_b16 v[206:207], v233 offset:26112
    v_mfma_f32_16x16x32_bf16 v[16:19], v[196:199], a[176:179], v[16:19]
    v_mfma_f32_16x16x32_bf16 v[20:23], v[192:195], a[164:167], v[20:23]
    buffer_load_dwordx4 a[44:47], v240, s[16:19], s59 offen offset:3072 sc1
    v_mfma_f32_16x16x32_bf16 v[20:23], v[196:199], a[180:183], v[20:23]
    ds_read_b64_tr_b16 v[208:209], v234 offset:16384
    v_mfma_f32_16x16x32_bf16 v[24:27], v[192:195], a[168:171], v[24:27]
    ds_read_b64_tr_b16 v[210:211], v234 offset:16896
    v_mfma_f32_16x16x32_bf16 v[24:27], v[196:199], a[184:187], v[24:27]
    v_mfma_f32_16x16x32_bf16 v[28:31], v[192:195], a[172:175], v[28:31]
    buffer_load_dwordx4 a[48:51], v241, s[16:19], s59 offen offset:0 sc1
    v_mfma_f32_16x16x32_bf16 v[28:31], v[196:199], a[188:191], v[28:31]
    ds_read_b64_tr_b16 v[192:193], v234 offset:24576
    s_waitcnt lgkmcnt(3)
    v_mfma_f32_16x16x32_bf16 v[80:83], v[200:203], a[160:163], v[80:83]
    ds_read_b64_tr_b16 v[194:195], v234 offset:25088
    v_mfma_f32_16x16x32_bf16 v[80:83], v[204:207], a[176:179], v[80:83]
    v_mfma_f32_16x16x32_bf16 v[84:87], v[200:203], a[164:167], v[84:87]
    buffer_load_dwordx4 a[52:55], v241, s[16:19], s59 offen offset:1024 sc1
    v_mfma_f32_16x16x32_bf16 v[84:87], v[204:207], a[180:183], v[84:87]
    ds_read_b64_tr_b16 v[196:197], v234 offset:17408
    v_mfma_f32_16x16x32_bf16 v[88:91], v[200:203], a[168:171], v[88:91]
    ds_read_b64_tr_b16 v[198:199], v234 offset:17920
    v_mfma_f32_16x16x32_bf16 v[88:91], v[204:207], a[184:187], v[88:91]
    v_mfma_f32_16x16x32_bf16 v[92:95], v[200:203], a[172:175], v[92:95]
    buffer_load_dwordx4 a[56:59], v241, s[16:19], s59 offen offset:2048 sc1
    v_mfma_f32_16x16x32_bf16 v[92:95], v[204:207], a[188:191], v[92:95]
    ds_read_b64_tr_b16 v[200:201], v234 offset:25600
    s_waitcnt lgkmcnt(3)
    v_mfma_f32_16x16x32_bf16 v[32:35], v[208:211], a[160:163], v[32:35]
    ds_read_b64_tr_b16 v[202:203], v234 offset:26112
    v_mfma_f32_16x16x32_bf16 v[32:35], v[192:195], a[176:179], v[32:35]
    v_mfma_f32_16x16x32_bf16 v[36:39], v[208:211], a[164:167], v[36:39]
    buffer_load_dwordx4 a[60:63], v241, s[16:19], s59 offen offset:3072 sc1
    v_mfma_f32_16x16x32_bf16 v[36:39], v[192:195], a[180:183], v[36:39]
    ds_read_b64_tr_b16 v[204:205], v235 offset:16384
    v_mfma_f32_16x16x32_bf16 v[40:43], v[208:211], a[168:171], v[40:43]
    ds_read_b64_tr_b16 v[206:207], v235 offset:16896
    v_mfma_f32_16x16x32_bf16 v[40:43], v[192:195], a[184:187], v[40:43]
    v_mfma_f32_16x16x32_bf16 v[44:47], v[208:211], a[172:175], v[44:47]
    buffer_load_dwordx4 a[64:67], v240, s[16:19], s60 offen offset:0 sc1
    v_mfma_f32_16x16x32_bf16 v[44:47], v[192:195], a[188:191], v[44:47]
    ds_read_b64_tr_b16 v[208:209], v235 offset:24576
    s_waitcnt lgkmcnt(3)
    v_mfma_f32_16x16x32_bf16 v[96:99], v[196:199], a[160:163], v[96:99]
    ds_read_b64_tr_b16 v[210:211], v235 offset:25088
    v_mfma_f32_16x16x32_bf16 v[96:99], v[200:203], a[176:179], v[96:99]
    v_mfma_f32_16x16x32_bf16 v[100:103], v[196:199], a[164:167], v[100:103]
    buffer_load_dwordx4 a[68:71], v240, s[16:19], s60 offen offset:1024 sc1
    v_mfma_f32_16x16x32_bf16 v[100:103], v[200:203], a[180:183], v[100:103]
    ds_read_b64_tr_b16 v[192:193], v235 offset:17408
    v_mfma_f32_16x16x32_bf16 v[104:107], v[196:199], a[168:171], v[104:107]
    ds_read_b64_tr_b16 v[194:195], v235 offset:17920
    v_mfma_f32_16x16x32_bf16 v[104:107], v[200:203], a[184:187], v[104:107]
    v_mfma_f32_16x16x32_bf16 v[108:111], v[196:199], a[172:175], v[108:111]
    buffer_load_dwordx4 a[72:75], v240, s[16:19], s60 offen offset:2048 sc1
    v_mfma_f32_16x16x32_bf16 v[108:111], v[200:203], a[188:191], v[108:111]
    ds_read_b64_tr_b16 v[196:197], v235 offset:25600
    s_waitcnt lgkmcnt(3)
    v_mfma_f32_16x16x32_bf16 v[48:51], v[204:207], a[160:163], v[48:51]
    ds_read_b64_tr_b16 v[198:199], v235 offset:26112
    v_mfma_f32_16x16x32_bf16 v[48:51], v[208:211], a[176:179], v[48:51]
    v_mfma_f32_16x16x32_bf16 v[52:55], v[204:207], a[164:167], v[52:55]
    s_waitcnt vmcnt(15) lgkmcnt(2)
    s_barrier
    v_mfma_f32_16x16x32_bf16 v[52:55], v[208:211], a[180:183], v[52:55]
    ds_read_b64_tr_b16 v[200:201], v232 offset:32768
    buffer_load_dwordx4 a[76:79], v240, s[16:19], s60 offen offset:3072 sc1
    v_mfma_f32_16x16x32_bf16 v[56:59], v[204:207], a[168:171], v[56:59]
    ds_read_b64_tr_b16 v[202:203], v232 offset:33280
    v_mfma_f32_16x16x32_bf16 v[56:59], v[208:211], a[184:187], v[56:59]
    v_mfma_f32_16x16x32_bf16 v[60:63], v[204:207], a[172:175], v[60:63]
    v_mfma_f32_16x16x32_bf16 v[60:63], v[208:211], a[188:191], v[60:63]
    ds_read_b64_tr_b16 v[204:205], v232 offset:40960
    s_waitcnt lgkmcnt(3)
    v_mfma_f32_16x16x32_bf16 v[112:115], v[192:195], a[160:163], v[112:115]
    ds_read_b64_tr_b16 v[206:207], v232 offset:41472
    buffer_load_dwordx4 a[80:83], v241, s[16:19], s60 offen offset:0 sc1
    v_mfma_f32_16x16x32_bf16 v[112:115], v[196:199], a[176:179], v[112:115]
    v_mfma_f32_16x16x32_bf16 v[116:119], v[192:195], a[164:167], v[116:119]
    v_mfma_f32_16x16x32_bf16 v[116:119], v[196:199], a[180:183], v[116:119]
    ds_read_b64_tr_b16 v[208:209], v232 offset:33792
    v_mfma_f32_16x16x32_bf16 v[120:123], v[192:195], a[168:171], v[120:123]
    ds_read_b64_tr_b16 v[210:211], v232 offset:34304
    buffer_load_dwordx4 a[84:87], v241, s[16:19], s60 offen offset:1024 sc1
    v_mfma_f32_16x16x32_bf16 v[120:123], v[196:199], a[184:187], v[120:123]
    v_mfma_f32_16x16x32_bf16 v[124:127], v[192:195], a[172:175], v[124:127]
    v_mfma_f32_16x16x32_bf16 v[124:127], v[196:199], a[188:191], v[124:127]
    ds_read_b64_tr_b16 v[192:193], v232 offset:41984
    s_waitcnt lgkmcnt(3)
    v_mfma_f32_16x16x32_bf16 v[0:3], v[200:203], a[192:195], v[0:3]
    ds_read_b64_tr_b16 v[194:195], v232 offset:42496
    buffer_load_dwordx4 a[88:91], v241, s[16:19], s60 offen offset:2048 sc1
    v_mfma_f32_16x16x32_bf16 v[0:3], v[204:207], a[208:211], v[0:3]
    v_mfma_f32_16x16x32_bf16 v[4:7], v[200:203], a[196:199], v[4:7]
    v_mfma_f32_16x16x32_bf16 v[4:7], v[204:207], a[212:215], v[4:7]
    ds_read_b64_tr_b16 v[196:197], v233 offset:32768
    v_mfma_f32_16x16x32_bf16 v[8:11], v[200:203], a[200:203], v[8:11]
    ds_read_b64_tr_b16 v[198:199], v233 offset:33280
    buffer_load_dwordx4 a[92:95], v241, s[16:19], s60 offen offset:3072 sc1
    v_mfma_f32_16x16x32_bf16 v[8:11], v[204:207], a[216:219], v[8:11]
    v_mfma_f32_16x16x32_bf16 v[12:15], v[200:203], a[204:207], v[12:15]
    v_mfma_f32_16x16x32_bf16 v[12:15], v[204:207], a[220:223], v[12:15]
    ds_read_b64_tr_b16 v[200:201], v233 offset:40960
    s_waitcnt lgkmcnt(3)
    v_mfma_f32_16x16x32_bf16 v[64:67], v[208:211], a[192:195], v[64:67]
    ds_read_b64_tr_b16 v[202:203], v233 offset:41472
    buffer_load_dwordx4 a[96:99], v240, s[16:19], s61 offen offset:0 sc1
    v_mfma_f32_16x16x32_bf16 v[64:67], v[192:195], a[208:211], v[64:67]
    v_mfma_f32_16x16x32_bf16 v[68:71], v[208:211], a[196:199], v[68:71]
    v_mfma_f32_16x16x32_bf16 v[68:71], v[192:195], a[212:215], v[68:71]
    ds_read_b64_tr_b16 v[204:205], v233 offset:33792
    v_mfma_f32_16x16x32_bf16 v[72:75], v[208:211], a[200:203], v[72:75]
    ds_read_b64_tr_b16 v[206:207], v233 offset:34304
    buffer_load_dwordx4 a[100:103], v240, s[16:19], s61 offen offset:1024 sc1
    v_mfma_f32_16x16x32_bf16 v[72:75], v[192:195], a[216:219], v[72:75]
    v_mfma_f32_16x16x32_bf16 v[76:79], v[208:211], a[204:207], v[76:79]
    v_mfma_f32_16x16x32_bf16 v[76:79], v[192:195], a[220:223], v[76:79]
    ds_read_b64_tr_b16 v[208:209], v233 offset:41984
    s_waitcnt lgkmcnt(3)
    v_mfma_f32_16x16x32_bf16 v[16:19], v[196:199], a[192:195], v[16:19]
    ds_read_b64_tr_b16 v[210:211], v233 offset:42496
    buffer_load_dwordx4 a[104:107], v240, s[16:19], s61 offen offset:2048 sc1
    v_mfma_f32_16x16x32_bf16 v[16:19], v[200:203], a[208:211], v[16:19]
    v_mfma_f32_16x16x32_bf16 v[20:23], v[196:199], a[196:199], v[20:23]
    v_mfma_f32_16x16x32_bf16 v[20:23], v[200:203], a[212:215], v[20:23]
    ds_read_b64_tr_b16 v[192:193], v234 offset:32768
    v_mfma_f32_16x16x32_bf16 v[24:27], v[196:199], a[200:203], v[24:27]
    ds_read_b64_tr_b16 v[194:195], v234 offset:33280
    buffer_load_dwordx4 a[108:111], v240, s[16:19], s61 offen offset:3072 sc1
    v_mfma_f32_16x16x32_bf16 v[24:27], v[200:203], a[216:219], v[24:27]
    v_mfma_f32_16x16x32_bf16 v[28:31], v[196:199], a[204:207], v[28:31]
    v_mfma_f32_16x16x32_bf16 v[28:31], v[200:203], a[220:223], v[28:31]
    ds_read_b64_tr_b16 v[196:197], v234 offset:40960
    s_waitcnt lgkmcnt(3)
    v_mfma_f32_16x16x32_bf16 v[80:83], v[204:207], a[192:195], v[80:83]
    ds_read_b64_tr_b16 v[198:199], v234 offset:41472
    buffer_load_dwordx4 a[112:115], v241, s[16:19], s61 offen offset:0 sc1
    v_mfma_f32_16x16x32_bf16 v[80:83], v[208:211], a[208:211], v[80:83]
    v_mfma_f32_16x16x32_bf16 v[84:87], v[204:207], a[196:199], v[84:87]
    v_mfma_f32_16x16x32_bf16 v[84:87], v[208:211], a[212:215], v[84:87]
    ds_read_b64_tr_b16 v[200:201], v234 offset:33792
    v_mfma_f32_16x16x32_bf16 v[88:91], v[204:207], a[200:203], v[88:91]
    ds_read_b64_tr_b16 v[202:203], v234 offset:34304
    buffer_load_dwordx4 a[116:119], v241, s[16:19], s61 offen offset:1024 sc1
    v_mfma_f32_16x16x32_bf16 v[88:91], v[208:211], a[216:219], v[88:91]
    v_mfma_f32_16x16x32_bf16 v[92:95], v[204:207], a[204:207], v[92:95]
    v_mfma_f32_16x16x32_bf16 v[92:95], v[208:211], a[220:223], v[92:95]
    ds_read_b64_tr_b16 v[204:205], v234 offset:41984
    s_waitcnt lgkmcnt(3)
    v_mfma_f32_16x16x32_bf16 v[32:35], v[192:195], a[192:195], v[32:35]
    ds_read_b64_tr_b16 v[206:207], v234 offset:42496
    buffer_load_dwordx4 a[120:123], v241, s[16:19], s61 offen offset:2048 sc1
    v_mfma_f32_16x16x32_bf16 v[32:35], v[196:199], a[208:211], v[32:35]
    v_mfma_f32_16x16x32_bf16 v[36:39], v[192:195], a[196:199], v[36:39]
    v_mfma_f32_16x16x32_bf16 v[36:39], v[196:199], a[212:215], v[36:39]
    ds_read_b64_tr_b16 v[208:209], v235 offset:32768
    v_mfma_f32_16x16x32_bf16 v[40:43], v[192:195], a[200:203], v[40:43]
    ds_read_b64_tr_b16 v[210:211], v235 offset:33280
    buffer_load_dwordx4 a[124:127], v241, s[16:19], s61 offen offset:3072 sc1
    v_mfma_f32_16x16x32_bf16 v[40:43], v[196:199], a[216:219], v[40:43]
    v_mfma_f32_16x16x32_bf16 v[44:47], v[192:195], a[204:207], v[44:47]
    v_mfma_f32_16x16x32_bf16 v[44:47], v[196:199], a[220:223], v[44:47]
    ds_read_b64_tr_b16 v[192:193], v235 offset:40960
    s_waitcnt lgkmcnt(3)
    v_mfma_f32_16x16x32_bf16 v[96:99], v[200:203], a[192:195], v[96:99]
    ds_read_b64_tr_b16 v[194:195], v235 offset:41472
    buffer_load_dwordx4 a[128:131], v240, s[16:19], s62 offen offset:0 sc1
    v_mfma_f32_16x16x32_bf16 v[96:99], v[204:207], a[208:211], v[96:99]
    v_mfma_f32_16x16x32_bf16 v[100:103], v[200:203], a[196:199], v[100:103]
    v_mfma_f32_16x16x32_bf16 v[100:103], v[204:207], a[212:215], v[100:103]
    ds_read_b64_tr_b16 v[196:197], v235 offset:33792
    v_mfma_f32_16x16x32_bf16 v[104:107], v[200:203], a[200:203], v[104:107]
    ds_read_b64_tr_b16 v[198:199], v235 offset:34304
    buffer_load_dwordx4 a[132:135], v240, s[16:19], s62 offen offset:1024 sc1
    v_mfma_f32_16x16x32_bf16 v[104:107], v[204:207], a[216:219], v[104:107]
    v_mfma_f32_16x16x32_bf16 v[108:111], v[200:203], a[204:207], v[108:111]
    v_mfma_f32_16x16x32_bf16 v[108:111], v[204:207], a[220:223], v[108:111]
    ds_read_b64_tr_b16 v[200:201], v235 offset:41984
    s_waitcnt lgkmcnt(3)
    v_mfma_f32_16x16x32_bf16 v[48:51], v[208:211], a[192:195], v[48:51]
    ds_read_b64_tr_b16 v[202:203], v235 offset:42496
    buffer_load_dwordx4 a[136:139], v240, s[16:19], s62 offen offset:2048 sc1
    v_mfma_f32_16x16x32_bf16 v[48:51], v[192:195], a[208:211], v[48:51]
    v_mfma_f32_16x16x32_bf16 v[52:55], v[208:211], a[196:199], v[52:55]
    s_waitcnt vmcnt(24) lgkmcnt(2)
    s_barrier
    v_mfma_f32_16x16x32_bf16 v[52:55], v[192:195], a[212:215], v[52:55]
    ds_read_b64_tr_b16 v[204:205], v232 offset:49152
    v_mfma_f32_16x16x32_bf16 v[56:59], v[208:211], a[200:203], v[56:59]
    ds_read_b64_tr_b16 v[206:207], v232 offset:49664
    buffer_load_dwordx4 a[140:143], v240, s[16:19], s62 offen offset:3072 sc1
    v_mfma_f32_16x16x32_bf16 v[56:59], v[192:195], a[216:219], v[56:59]
    ds_read_b64 v[128:129], v226 offset:0
    v_mfma_f32_16x16x32_bf16 v[60:63], v[208:211], a[204:207], v[60:63]
    ds_read_b64 v[130:131], v226 offset:8
    v_mfma_f32_16x16x32_bf16 v[60:63], v[192:195], a[220:223], v[60:63]
    ds_read_b64_tr_b16 v[208:209], v232 offset:0
    s_waitcnt lgkmcnt(5)
    v_mfma_f32_16x16x32_bf16 v[112:115], v[196:199], a[192:195], v[112:115]
    ds_read_b64_tr_b16 v[210:211], v232 offset:512
    ds_read_b64 v[132:133], v226 offset:512
    v_mfma_f32_16x16x32_bf16 v[112:115], v[200:203], a[208:211], v[112:115]
    ds_read_b64 v[134:135], v226 offset:520
    buffer_load_dwordx4 a[144:147], v241, s[16:19], s62 offen offset:0 sc1
    v_mfma_f32_16x16x32_bf16 v[116:119], v[196:199], a[196:199], v[116:119]
    ds_read_b64 v[136:137], v226 offset:1024
    v_mfma_f32_16x16x32_bf16 v[116:119], v[200:203], a[212:215], v[116:119]
    ds_read_b64_tr_b16 v[192:193], v232 offset:50176
    ds_read_b64 v[138:139], v226 offset:1032
    v_mfma_f32_16x16x32_bf16 v[120:123], v[196:199], a[200:203], v[120:123]
    ds_read_b64_tr_b16 v[194:195], v232 offset:50688
    ds_read_b64 v[140:141], v226 offset:1536
    v_mfma_f32_16x16x32_bf16 v[120:123], v[200:203], a[216:219], v[120:123]
    ds_read_b64 v[142:143], v226 offset:1544
    buffer_load_dwordx4 a[148:151], v241, s[16:19], s62 offen offset:1024 sc1
    v_mfma_f32_16x16x32_bf16 v[124:127], v[196:199], a[204:207], v[124:127]
    ds_read_b64 v[144:145], v226 offset:2048
    v_mfma_f32_16x16x32_bf16 v[124:127], v[200:203], a[220:223], v[124:127]
    ds_read_b64_tr_b16 v[196:197], v232 offset:1024
    s_waitcnt lgkmcnt(10)
    v_mfma_f32_16x16x32_bf16 v[0:3], v[204:207], a[224:227], v[0:3]
    ds_read_b64_tr_b16 v[198:199], v232 offset:1536
    ds_read_b64 v[146:147], v226 offset:2056
    v_mfma_f32_16x16x32_bf16 v[0:3], v[208:211], a[240:243], v[0:3]
    ds_read_b64 v[148:149], v226 offset:2560
    buffer_load_dwordx4 a[152:155], v241, s[16:19], s62 offen offset:2048 sc1
    v_mfma_f32_16x16x32_bf16 v[4:7], v[204:207], a[228:231], v[4:7]
    ds_read_b64 v[150:151], v226 offset:2568
    v_mfma_f32_16x16x32_bf16 v[4:7], v[208:211], a[244:247], v[4:7]
    ds_read_b64_tr_b16 v[200:201], v233 offset:49152
    ds_read_b64 v[152:153], v226 offset:3072
    v_mfma_f32_16x16x32_bf16 v[8:11], v[204:207], a[232:235], v[8:11]
    ds_read_b64_tr_b16 v[202:203], v233 offset:49664
    ds_read_b64 v[154:155], v226 offset:3080
    v_mfma_f32_16x16x32_bf16 v[8:11], v[208:211], a[248:251], v[8:11]
    ds_read_b64 v[156:157], v226 offset:3584
    buffer_load_dwordx4 a[156:159], v241, s[16:19], s62 offen offset:3072 sc1
    v_mfma_f32_16x16x32_bf16 v[12:15], v[204:207], a[236:239], v[12:15]
    ds_read_b64 v[158:159], v226 offset:3592
    v_mfma_f32_16x16x32_bf16 v[12:15], v[208:211], a[252:255], v[12:15]
    ds_read_b64_tr_b16 v[204:205], v233 offset:0
    s_waitcnt lgkmcnt(10)
    v_mfma_f32_16x16x32_bf16 v[64:67], v[192:195], a[224:227], v[64:67]
    ds_read_b64_tr_b16 v[206:207], v233 offset:512
    v_mfma_f32_16x16x32_bf16 v[64:67], v[196:199], a[240:243], v[64:67]
    v_mfma_f32_16x16x32_bf16 v[68:71], v[192:195], a[228:231], v[68:71]
    v_mfma_f32_16x16x32_bf16 v[68:71], v[196:199], a[244:247], v[68:71]
    ds_read_b64_tr_b16 v[208:209], v233 offset:50176
    v_mfma_f32_16x16x32_bf16 v[72:75], v[192:195], a[232:235], v[72:75]
    ds_read_b64_tr_b16 v[210:211], v233 offset:50688
    v_mfma_f32_16x16x32_bf16 v[72:75], v[196:199], a[248:251], v[72:75]
    v_mfma_f32_16x16x32_bf16 v[76:79], v[192:195], a[236:239], v[76:79]
    v_mfma_f32_16x16x32_bf16 v[76:79], v[196:199], a[252:255], v[76:79]
    ds_read_b64_tr_b16 v[192:193], v233 offset:1024
    s_waitcnt lgkmcnt(3)
    v_mfma_f32_16x16x32_bf16 v[16:19], v[200:203], a[224:227], v[16:19]
    ds_read_b64_tr_b16 v[194:195], v233 offset:1536
    v_mfma_f32_16x16x32_bf16 v[16:19], v[204:207], a[240:243], v[16:19]
    v_mfma_f32_16x16x32_bf16 v[20:23], v[200:203], a[228:231], v[20:23]
    v_mfma_f32_16x16x32_bf16 v[20:23], v[204:207], a[244:247], v[20:23]
    ds_read_b64_tr_b16 v[196:197], v234 offset:49152
    v_mfma_f32_16x16x32_bf16 v[24:27], v[200:203], a[232:235], v[24:27]
    ds_read_b64_tr_b16 v[198:199], v234 offset:49664
    v_mfma_f32_16x16x32_bf16 v[24:27], v[204:207], a[248:251], v[24:27]
    v_mfma_f32_16x16x32_bf16 v[28:31], v[200:203], a[236:239], v[28:31]
    v_mfma_f32_16x16x32_bf16 v[28:31], v[204:207], a[252:255], v[28:31]
    ds_read_b64_tr_b16 v[200:201], v234 offset:0
    s_waitcnt lgkmcnt(3)
    v_mfma_f32_16x16x32_bf16 v[80:83], v[208:211], a[224:227], v[80:83]
    ds_read_b64_tr_b16 v[202:203], v234 offset:512
    v_mfma_f32_16x16x32_bf16 v[80:83], v[192:195], a[240:243], v[80:83]
    v_mfma_f32_16x16x32_bf16 v[84:87], v[208:211], a[228:231], v[84:87]
    v_mfma_f32_16x16x32_bf16 v[84:87], v[192:195], a[244:247], v[84:87]
    ds_read_b64_tr_b16 v[204:205], v234 offset:50176
    v_mfma_f32_16x16x32_bf16 v[88:91], v[208:211], a[232:235], v[88:91]
    ds_read_b64_tr_b16 v[206:207], v234 offset:50688
    v_mfma_f32_16x16x32_bf16 v[88:91], v[192:195], a[248:251], v[88:91]
    v_mfma_f32_16x16x32_bf16 v[92:95], v[208:211], a[236:239], v[92:95]
    v_mfma_f32_16x16x32_bf16 v[92:95], v[192:195], a[252:255], v[92:95]
    ds_read_b64_tr_b16 v[208:209], v234 offset:1024
    s_waitcnt lgkmcnt(3)
    v_mfma_f32_16x16x32_bf16 v[32:35], v[196:199], a[224:227], v[32:35]
    ds_read_b64_tr_b16 v[210:211], v234 offset:1536
    v_mfma_f32_16x16x32_bf16 v[32:35], v[200:203], a[240:243], v[32:35]
    v_mul_f32 v0, v0, v64
    v_mul_f32 v1, v1, v65
    v_mfma_f32_16x16x32_bf16 v[36:39], v[196:199], a[228:231], v[36:39]
    v_mul_f32 v2, v2, v66
    v_mul_f32 v3, v3, v67
    v_mfma_f32_16x16x32_bf16 v[36:39], v[200:203], a[244:247], v[36:39]
    ds_read_b64_tr_b16 v[192:193], v235 offset:49152
    ds_read_b128 v[64:67], v227 offset:3584
    v_mfma_f32_16x16x32_bf16 v[40:43], v[196:199], a[232:235], v[40:43]
    ds_read_b64_tr_b16 v[194:195], v235 offset:49664
    v_cvt_pk_bf16_f32 v160, v0, v1
    v_mfma_f32_16x16x32_bf16 v[40:43], v[200:203], a[248:251], v[40:43]
    v_cvt_pk_bf16_f32 v161, v2, v3
    v_mul_f32 v16, v16, v80
    v_mfma_f32_16x16x32_bf16 v[44:47], v[196:199], a[236:239], v[44:47]
    v_mul_f32 v17, v17, v81
    v_mul_f32 v18, v18, v82
    v_mfma_f32_16x16x32_bf16 v[44:47], v[200:203], a[252:255], v[44:47]
    ds_read_b64_tr_b16 v[196:197], v235 offset:0
    s_waitcnt lgkmcnt(4)
    v_mfma_f32_16x16x32_bf16 v[96:99], v[204:207], a[224:227], v[96:99]
    ds_read_b64_tr_b16 v[198:199], v235 offset:512
    v_mul_f32 v19, v19, v83
    v_mfma_f32_16x16x32_bf16 v[96:99], v[208:211], a[240:243], v[96:99]
    ds_read_b128 v[80:83], v227 offset:1536
    v_cvt_pk_bf16_f32 v162, v16, v17
    v_mfma_f32_16x16x32_bf16 v[100:103], v[204:207], a[228:231], v[100:103]
    v_cvt_pk_bf16_f32 v163, v18, v19
    buffer_store_dwordx4 v[160:163], v240, s[16:19], s66 offen offset:0 sc1
    v_mfma_f32_16x16x32_bf16 v[100:103], v[208:211], a[244:247], v[100:103]
    ds_read_b64_tr_b16 v[200:201], v235 offset:50176
    v_mul_f32 v4, v4, v68
    v_mfma_f32_16x16x32_bf16 v[104:107], v[204:207], a[232:235], v[104:107]
    ds_read_b64_tr_b16 v[202:203], v235 offset:50688
    v_mul_f32 v5, v5, v69
    v_mfma_f32_16x16x32_bf16 v[104:107], v[208:211], a[248:251], v[104:107]
    v_mul_f32 v6, v6, v70
    v_mul_f32 v7, v7, v71
    v_mfma_f32_16x16x32_bf16 v[108:111], v[204:207], a[236:239], v[108:111]
    ds_read_b128 v[68:71], v227 offset:3072
    v_cvt_pk_bf16_f32 v164, v4, v5
    v_mfma_f32_16x16x32_bf16 v[108:111], v[208:211], a[252:255], v[108:111]
    ds_read_b64_tr_b16 v[204:205], v235 offset:1024
    s_waitcnt lgkmcnt(5)
    v_mfma_f32_16x16x32_bf16 v[48:51], v[192:195], a[224:227], v[48:51]
    ds_read_b64_tr_b16 v[206:207], v235 offset:1536
    v_cvt_pk_bf16_f32 v165, v6, v7
    v_mfma_f32_16x16x32_bf16 v[48:51], v[196:199], a[240:243], v[48:51]
    v_mul_f32 v20, v20, v84
    v_mul_f32 v21, v21, v85
    v_mfma_f32_16x16x32_bf16 v[52:55], v[192:195], a[228:231], v[52:55]
    v_mul_f32 v22, v22, v86
    v_mul_f32 v23, v23, v87
    v_mfma_f32_16x16x32_bf16 v[52:55], v[196:199], a[244:247], v[52:55]
    ds_read_b128 v[84:87], v227 offset:1024
    v_cvt_pk_bf16_f32 v166, v20, v21
    v_mfma_f32_16x16x32_bf16 v[56:59], v[192:195], a[232:235], v[56:59]
    v_cvt_pk_bf16_f32 v167, v22, v23
    buffer_store_dwordx4 v[164:167], v240, s[16:19], s66 offen offset:1024 sc1
    v_mfma_f32_16x16x32_bf16 v[56:59], v[196:199], a[248:251], v[56:59]
    v_mul_f32 v8, v8, v72
    v_mul_f32 v9, v9, v73
    v_mfma_f32_16x16x32_bf16 v[60:63], v[192:195], a[236:239], v[60:63]
    v_mul_f32 v10, v10, v74
    v_mul_f32 v11, v11, v75
    v_mfma_f32_16x16x32_bf16 v[60:63], v[196:199], a[252:255], v[60:63]
    ds_read_b128 v[72:75], v227 offset:2560
    s_waitcnt lgkmcnt(2)
    v_mfma_f32_16x16x32_bf16 v[112:115], v[200:203], a[224:227], v[112:115]
    v_cvt_pk_bf16_f32 v168, v8, v9
    v_cvt_pk_bf16_f32 v169, v10, v11
    v_mfma_f32_16x16x32_bf16 v[112:115], v[204:207], a[240:243], v[112:115]
    v_mul_f32 v24, v24, v88
    v_mul_f32 v25, v25, v89
    v_mfma_f32_16x16x32_bf16 v[116:119], v[200:203], a[228:231], v[116:119]
    v_mul_f32 v26, v26, v90
    v_mul_f32 v27, v27, v91
    v_mfma_f32_16x16x32_bf16 v[116:119], v[204:207], a[244:247], v[116:119]
    ds_read_b128 v[88:91], v227 offset:512
    s_barrier
    v_mfma_f32_16x16x32_bf16 v[120:123], v[200:203], a[232:235], v[120:123]
    v_cvt_pk_bf16_f32 v170, v24, v25
    v_cvt_pk_bf16_f32 v171, v26, v27
    v_mfma_f32_16x16x32_bf16 v[120:123], v[204:207], a[248:251], v[120:123]
    buffer_store_dwordx4 v[168:171], v240, s[16:19], s66 offen offset:2048 sc1
    v_mul_f32 v12, v12, v76
    v_mfma_f32_16x16x32_bf16 v[124:127], v[200:203], a[236:239], v[124:127]
    v_mul_f32 v13, v13, v77
    v_mul_f32 v14, v14, v78
    v_mfma_f32_16x16x32_bf16 v[124:127], v[204:207], a[252:255], v[124:127]
    v_mul_f32 v15, v15, v79
    ds_read_b128 v[76:79], v227 offset:2048
    v_cvt_pk_bf16_f32 v172, v12, v13
    v_cvt_pk_bf16_f32 v173, v14, v15
    v_mul_f32 v28, v28, v92
    v_mul_f32 v29, v29, v93
    v_mul_f32 v30, v30, v94
    v_mul_f32 v31, v31, v95
    ds_read_b128 v[92:95], v227 offset:0
    v_cvt_pk_bf16_f32 v174, v28, v29
    v_cvt_pk_bf16_f32 v175, v30, v31
    buffer_store_dwordx4 v[172:175], v240, s[16:19], s66 offen offset:3072 sc1
    s_cmp_ge_u32 s83, 576
    s_cbranch_scc1 L_idle
    v_mfma_f32_16x16x32_bf16 v[0:3], v[128:131], v[64:67], 0
    v_mul_f32 v32, v32, v96
    v_mul_f32 v33, v33, v97
    v_mfma_f32_16x16x32_bf16 v[4:7], v[128:131], v[68:71], 0
    v_mul_f32 v34, v34, v98
    v_mul_f32 v35, v35, v99
    v_mfma_f32_16x16x32_bf16 v[4:7], v[132:135], v[64:67], v[4:7]
    v_cvt_pk_bf16_f32 v176, v32, v33
    v_cvt_pk_bf16_f32 v177, v34, v35
    s_waitcnt lgkmcnt(3)
    v_mfma_f32_16x16x32_bf16 v[8:11], v[128:131], v[72:75], 0
    v_mul_f32 v48, v48, v112
    v_mul_f32 v49, v49, v113
    v_mfma_f32_16x16x32_bf16 v[8:11], v[132:135], v[68:71], v[8:11]
    v_mul_f32 v50, v50, v114
    v_mul_f32 v51, v51, v115
    v_mfma_f32_16x16x32_bf16 v[8:11], v[136:139], v[64:67], v[8:11]
    v_cvt_pk_bf16_f32 v178, v48, v49
    v_cvt_pk_bf16_f32 v179, v50, v51
    s_waitcnt lgkmcnt(1)
    v_mfma_f32_16x16x32_bf16 v[12:15], v[128:131], v[76:79], 0
    buffer_store_dwordx4 v[176:179], v241, s[16:19], s66 offen offset:0 sc1
    ds_read_b64 v[32:33], v226 offset:64
    v_mfma_f32_16x16x32_bf16 v[12:15], v[132:135], v[72:75], v[12:15]
    ds_read_b64 v[34:35], v226 offset:72
    ds_read_b128 v[96:99], v227 offset:3648
    v_mfma_f32_16x16x32_bf16 v[12:15], v[136:139], v[68:71], v[12:15]
    v_mul_f32 v36, v36, v100
    v_mul_f32 v37, v37, v101
    v_mfma_f32_16x16x32_bf16 v[12:15], v[140:143], v[64:67], v[12:15]
    v_mul_f32 v38, v38, v102
    v_mul_f32 v39, v39, v103
    v_mfma_f32_16x16x32_bf16 v[16:19], v[128:131], v[80:83], 0
    v_cvt_pk_bf16_f32 v180, v36, v37
    v_cvt_pk_bf16_f32 v181, v38, v39
    v_mfma_f32_16x16x32_bf16 v[16:19], v[132:135], v[76:79], v[16:19]
    v_mul_f32 v52, v52, v116
    v_mul_f32 v53, v53, v117
    v_mfma_f32_16x16x32_bf16 v[16:19], v[136:139], v[72:75], v[16:19]
    v_mul_f32 v54, v54, v118
    v_mul_f32 v55, v55, v119
    v_mfma_f32_16x16x32_bf16 v[16:19], v[140:143], v[68:71], v[16:19]
    v_cvt_pk_bf16_f32 v182, v52, v53
    v_cvt_pk_bf16_f32 v183, v54, v55
    v_mfma_f32_16x16x32_bf16 v[16:19], v[144:147], v[64:67], v[16:19]
    buffer_store_dwordx4 v[180:183], v241, s[16:19], s66 offen offset:1024 sc1
    ds_read_b64 v[36:37], v226 offset:576
    v_mfma_f32_16x16x32_bf16 v[20:23], v[128:131], v[84:87], 0
    ds_read_b64 v[38:39], v226 offset:584
    ds_read_b128 v[100:103], v227 offset:3136
    v_mfma_f32_16x16x32_bf16 v[20:23], v[132:135], v[80:83], v[20:23]
    v_mul_f32 v40, v40, v104
    v_mul_f32 v41, v41, v105
    v_mfma_f32_16x16x32_bf16 v[20:23], v[136:139], v[76:79], v[20:23]
    v_mul_f32 v42, v42, v106
    v_mul_f32 v43, v43, v107
    v_mfma_f32_16x16x32_bf16 v[20:23], v[140:143], v[72:75], v[20:23]
    v_cvt_pk_bf16_f32 v184, v40, v41
    v_cvt_pk_bf16_f32 v185, v42, v43
    v_mfma_f32_16x16x32_bf16 v[20:23], v[144:147], v[68:71], v[20:23]
    v_mul_f32 v56, v56, v120
    v_mul_f32 v57, v57, v121
    v_mfma_f32_16x16x32_bf16 v[20:23], v[148:151], v[64:67], v[20:23]
    v_mul_f32 v58, v58, v122
    v_mul_f32 v59, v59, v123
    v_mfma_f32_16x16x32_bf16 v[24:27], v[128:131], v[88:91], 0
    v_cvt_pk_bf16_f32 v186, v56, v57
    v_cvt_pk_bf16_f32 v187, v58, v59
    v_mfma_f32_16x16x32_bf16 v[24:27], v[132:135], v[84:87], v[24:27]
    buffer_store_dwordx4 v[184:187], v241, s[16:19], s66 offen offset:2048 sc1
    ds_read_b64 v[40:41], v226 offset:1088
    v_mfma_f32_16x16x32_bf16 v[24:27], v[136:139], v[80:83], v[24:27]
    ds_read_b64 v[42:43], v226 offset:1096
    ds_read_b128 v[104:107], v227 offset:2624
    v_mfma_f32_16x16x32_bf16 v[24:27], v[140:143], v[76:79], v[24:27]
    v_mul_f32 v44, v44, v108
    v_mul_f32 v45, v45, v109
    v_mfma_f32_16x16x32_bf16 v[24:27], v[144:147], v[72:75], v[24:27]
    v_mul_f32 v46, v46, v110
    v_mul_f32 v47, v47, v111
    v_mfma_f32_16x16x32_bf16 v[24:27], v[148:151], v[68:71], v[24:27]
    v_cvt_pk_bf16_f32 v188, v44, v45
    v_cvt_pk_bf16_f32 v189, v46, v47
    v_mfma_f32_16x16x32_bf16 v[24:27], v[152:155], v[64:67], v[24:27]
    v_mul_f32 v60, v60, v124
    v_mul_f32 v61, v61, v125
    s_waitcnt lgkmcnt(9)
    v_mfma_f32_16x16x32_bf16 v[28:31], v[128:131], v[92:95], 0
    v_mul_f32 v62, v62, v126
    v_mul_f32 v63, v63, v127
    v_mfma_f32_16x16x32_bf16 v[28:31], v[132:135], v[88:91], v[28:31]
    v_cvt_pk_bf16_f32 v190, v60, v61
    v_cvt_pk_bf16_f32 v191, v62, v63
    v_mfma_f32_16x16x32_bf16 v[28:31], v[136:139], v[84:87], v[28:31]
    buffer_store_dwordx4 v[188:191], v241, s[16:19], s66 offen offset:3072 sc1
    ds_read_b64 v[44:45], v226 offset:1600
    v_mfma_f32_16x16x32_bf16 v[28:31], v[140:143], v[80:83], v[28:31]
    ds_read_b64 v[46:47], v226 offset:1608
    ds_read_b128 v[108:111], v227 offset:2112
    v_mfma_f32_16x16x32_bf16 v[28:31], v[144:147], v[76:79], v[28:31]
    ds_read_b64 v[48:49], v226 offset:2112
    ds_read_b64 v[50:51], v226 offset:2120
    v_mfma_f32_16x16x32_bf16 v[28:31], v[148:151], v[72:75], v[28:31]
    ds_read_b128 v[112:115], v227 offset:1600
    ds_read_b64 v[52:53], v226 offset:2624
    v_mfma_f32_16x16x32_bf16 v[28:31], v[152:155], v[68:71], v[28:31]
    ds_read_b64 v[54:55], v226 offset:2632
    ds_read_b128 v[116:119], v227 offset:1088
    v_mfma_f32_16x16x32_bf16 v[28:31], v[156:159], v[64:67], v[28:31]
    ds_read_b64 v[56:57], v226 offset:3136
    ds_read_b64 v[58:59], v226 offset:3144
    s_waitcnt lgkmcnt(15)
    v_mfma_f32_16x16x32_bf16 v[0:3], v[32:35], v[96:99], v[0:3]
    ds_read_b128 v[120:123], v227 offset:576
    ds_read_b64 v[60:61], v226 offset:3648
    s_waitcnt lgkmcnt(15)
    v_mfma_f32_16x16x32_bf16 v[4:7], v[32:35], v[100:103], v[4:7]
    ds_read_b64 v[62:63], v226 offset:3656
    ds_read_b128 v[124:127], v227 offset:64
    v_mfma_f32_16x16x32_bf16 v[4:7], v[36:39], v[96:99], v[4:7]
    s_add_u32 m0, s38, 0
    s_waitcnt lgkmcnt(15)
    v_mfma_f32_16x16x32_bf16 v[8:11], v[32:35], v[104:107], v[8:11]
    buffer_load_dwordx4 v237, s[20:23], s67 offen lds
    v_mfma_f32_16x16x32_bf16 v[8:11], v[36:39], v[100:103], v[8:11]
    s_mov_b32 s14, 9764864
    v_mfma_f32_16x16x32_bf16 v[8:11], v[40:43], v[96:99], v[8:11]
    s_waitcnt lgkmcnt(12)
    v_mfma_f32_16x16x32_bf16 v[12:15], v[32:35], v[108:111], v[12:15]
    v_mfma_f32_16x16x32_bf16 v[12:15], v[36:39], v[104:107], v[12:15]
    v_mfma_f32_16x16x32_bf16 v[12:15], v[40:43], v[100:103], v[12:15]
    ds_read_b64 v[128:129], v226 offset:128
    v_mfma_f32_16x16x32_bf16 v[12:15], v[44:47], v[96:99], v[12:15]
    ds_read_b64 v[130:131], v226 offset:136
    s_waitcnt lgkmcnt(11)
    v_mfma_f32_16x16x32_bf16 v[16:19], v[32:35], v[112:115], v[16:19]
    ds_read_b128 v[64:67], v227 offset:3712
    s_add_u32 m0, s38, 4096
    v_mfma_f32_16x16x32_bf16 v[16:19], v[36:39], v[108:111], v[16:19]
    ds_read_b64 v[132:133], v226 offset:640
    buffer_load_dwordx4 v239, s[20:23], s67 offen lds
    v_mfma_f32_16x16x32_bf16 v[16:19], v[40:43], v[104:107], v[16:19]
    ds_read_b64 v[134:135], v226 offset:648
    v_mfma_f32_16x16x32_bf16 v[16:19], v[44:47], v[100:103], v[16:19]
    ds_read_b128 v[68:71], v227 offset:3200
    v_mfma_f32_16x16x32_bf16 v[16:19], v[48:51], v[96:99], v[16:19]
    ds_read_b64 v[136:137], v226 offset:1152
    s_waitcnt lgkmcnt(13)
    v_mfma_f32_16x16x32_bf16 v[20:23], v[32:35], v[116:119], v[20:23]
    ds_read_b64 v[138:139], v226 offset:1160
    v_mfma_f32_16x16x32_bf16 v[20:23], v[36:39], v[112:115], v[20:23]
    ds_read_b128 v[72:75], v227 offset:2688
    v_mfma_f32_16x16x32_bf16 v[20:23], v[40:43], v[108:111], v[20:23]
    ds_read_b64 v[140:141], v226 offset:1664
    v_mfma_f32_16x16x32_bf16 v[20:23], v[44:47], v[104:107], v[20:23]
    ds_read_b64 v[142:143], v226 offset:1672
    s_add_u32 m0, s38, 8192
    v_mfma_f32_16x16x32_bf16 v[20:23], v[48:51], v[100:103], v[20:23]
    ds_read_b128 v[76:79], v227 offset:2176
    buffer_load_dwordx4 v237, s[20:23], s68 offen lds
    v_mfma_f32_16x16x32_bf16 v[20:23], v[52:55], v[96:99], v[20:23]
    ds_read_b64 v[144:145], v226 offset:2176
    s_waitcnt lgkmcnt(15)
    v_mfma_f32_16x16x32_bf16 v[24:27], v[32:35], v[120:123], v[24:27]
    ds_read_b64 v[146:147], v226 offset:2184
    v_mfma_f32_16x16x32_bf16 v[24:27], v[36:39], v[116:119], v[24:27]
    ds_read_b128 v[80:83], v227 offset:1664
    v_mfma_f32_16x16x32_bf16 v[24:27], v[40:43], v[112:115], v[24:27]
    ds_read_b64 v[148:149], v226 offset:2688
    v_mfma_f32_16x16x32_bf16 v[24:27], v[44:47], v[108:111], v[24:27]
    ds_read_b64 v[150:151], v226 offset:2696
    v_mfma_f32_16x16x32_bf16 v[24:27], v[48:51], v[104:107], v[24:27]
    ds_read_b128 v[84:87], v227 offset:1152
    v_mfma_f32_16x16x32_bf16 v[24:27], v[52:55], v[100:103], v[24:27]
    ds_read_b64 v[152:153], v226 offset:3200
    s_add_u32 m0, s38, 12288
    v_mfma_f32_16x16x32_bf16 v[24:27], v[56:59], v[96:99], v[24:27]
    ds_read_b64 v[154:155], v226 offset:3208
    buffer_load_dwordx4 v239, s[20:23], s68 offen lds
    s_waitcnt lgkmcnt(15)
    v_mfma_f32_16x16x32_bf16 v[28:31], v[32:35], v[124:127], v[28:31]
    ds_read_b128 v[88:91], v227 offset:640
    v_mfma_f32_16x16x32_bf16 v[28:31], v[36:39], v[120:123], v[28:31]
    ds_read_b64 v[156:157], v226 offset:3712
    v_mfma_f32_16x16x32_bf16 v[28:31], v[40:43], v[116:119], v[28:31]
    ds_read_b64 v[158:159], v226 offset:3720
    v_mfma_f32_16x16x32_bf16 v[28:31], v[44:47], v[112:115], v[28:31]
    ds_read_b128 v[92:95], v227 offset:128
    v_mfma_f32_16x16x32_bf16 v[28:31], v[48:51], v[108:111], v[28:31]
    v_mfma_f32_16x16x32_bf16 v[28:31], v[52:55], v[104:107], v[28:31]
    v_mfma_f32_16x16x32_bf16 v[28:31], v[56:59], v[100:103], v[28:31]
    s_add_u32 m0, s38, 16384
    v_mfma_f32_16x16x32_bf16 v[28:31], v[60:63], v[96:99], v[28:31]
    buffer_load_dwordx4 v237, s[20:23], s69 offen lds
    v_mfma_f32_16x16x32_bf16 v[0:3], v[128:131], v[64:67], v[0:3]
    s_waitcnt lgkmcnt(15)
    v_mfma_f32_16x16x32_bf16 v[4:7], v[128:131], v[68:71], v[4:7]
    v_mfma_f32_16x16x32_bf16 v[4:7], v[132:135], v[64:67], v[4:7]
    v_mfma_f32_16x16x32_bf16 v[8:11], v[128:131], v[72:75], v[8:11]
    v_mfma_f32_16x16x32_bf16 v[8:11], v[132:135], v[68:71], v[8:11]
    v_mfma_f32_16x16x32_bf16 v[8:11], v[136:139], v[64:67], v[8:11]
    s_waitcnt lgkmcnt(12)
    v_mfma_f32_16x16x32_bf16 v[12:15], v[128:131], v[76:79], v[12:15]
    s_add_u32 m0, s38, 20480
    v_mfma_f32_16x16x32_bf16 v[12:15], v[132:135], v[72:75], v[12:15]
    buffer_load_dwordx4 v239, s[20:23], s69 offen lds
    v_mfma_f32_16x16x32_bf16 v[12:15], v[136:139], v[68:71], v[12:15]
    ds_read_b64 v[32:33], v226 offset:192
    v_mfma_f32_16x16x32_bf16 v[12:15], v[140:143], v[64:67], v[12:15]
    ds_read_b64 v[34:35], v226 offset:200
    s_waitcnt lgkmcnt(11)
    v_mfma_f32_16x16x32_bf16 v[16:19], v[128:131], v[80:83], v[16:19]
    ds_read_b128 v[96:99], v227 offset:3776
    v_mfma_f32_16x16x32_bf16 v[16:19], v[132:135], v[76:79], v[16:19]
    ds_read_b64 v[36:37], v226 offset:704
    v_mfma_f32_16x16x32_bf16 v[16:19], v[136:139], v[72:75], v[16:19]
    ds_read_b64 v[38:39], v226 offset:712
    v_mfma_f32_16x16x32_bf16 v[16:19], v[140:143], v[68:71], v[16:19]
    ds_read_b128 v[100:103], v227 offset:3264
    v_mfma_f32_16x16x32_bf16 v[16:19], v[144:147], v[64:67], v[16:19]
    ds_read_b64 v[40:41], v226 offset:1216
    s_add_u32 m0, s38, 24576
    s_waitcnt lgkmcnt(13)
    v_mfma_f32_16x16x32_bf16 v[20:23], v[128:131], v[84:87], v[20:23]
    ds_read_b64 v[42:43], v226 offset:1224
    buffer_load_dwordx4 v237, s[20:23], s70 offen lds
    v_mfma_f32_16x16x32_bf16 v[20:23], v[132:135], v[80:83], v[20:23]
    ds_read_b128 v[104:107], v227 offset:2752
    v_mfma_f32_16x16x32_bf16 v[20:23], v[136:139], v[76:79], v[20:23]
    ds_read_b64 v[44:45], v226 offset:1728
    v_mfma_f32_16x16x32_bf16 v[20:23], v[140:143], v[72:75], v[20:23]
    ds_read_b64 v[46:47], v226 offset:1736
    v_mfma_f32_16x16x32_bf16 v[20:23], v[144:147], v[68:71], v[20:23]
    ds_read_b128 v[108:111], v227 offset:2240
    v_mfma_f32_16x16x32_bf16 v[20:23], v[148:151], v[64:67], v[20:23]
    ds_read_b64 v[48:49], v226 offset:2240
    s_waitcnt lgkmcnt(15)
    v_mfma_f32_16x16x32_bf16 v[24:27], v[128:131], v[88:91], v[24:27]
    ds_read_b64 v[50:51], v226 offset:2248
    v_mfma_f32_16x16x32_bf16 v[24:27], v[132:135], v[84:87], v[24:27]
    ds_read_b128 v[112:115], v227 offset:1728
    s_add_u32 m0, s38, 28672
    v_mfma_f32_16x16x32_bf16 v[24:27], v[136:139], v[80:83], v[24:27]
    ds_read_b64 v[52:53], v226 offset:2752
    buffer_load_dwordx4 v239, s[20:23], s70 offen lds
    v_mfma_f32_16x16x32_bf16 v[24:27], v[140:143], v[76:79], v[24:27]
    ds_read_b64 v[54:55], v226 offset:2760
    v_mfma_f32_16x16x32_bf16 v[24:27], v[144:147], v[72:75], v[24:27]
    ds_read_b128 v[116:119], v227 offset:1216
    v_mfma_f32_16x16x32_bf16 v[24:27], v[148:151], v[68:71], v[24:27]
    ds_read_b64 v[56:57], v226 offset:3264
    v_mfma_f32_16x16x32_bf16 v[24:27], v[152:155], v[64:67], v[24:27]
    ds_read_b64 v[58:59], v226 offset:3272
    s_waitcnt lgkmcnt(15)
    v_mfma_f32_16x16x32_bf16 v[28:31], v[128:131], v[92:95], v[28:31]
    ds_read_b128 v[120:123], v227 offset:704
    v_mfma_f32_16x16x32_bf16 v[28:31], v[132:135], v[88:91], v[28:31]
    ds_read_b64 v[60:61], v226 offset:3776
    v_mfma_f32_16x16x32_bf16 v[28:31], v[136:139], v[84:87], v[28:31]
    ds_read_b64 v[62:63], v226 offset:3784
    s_add_u32 m0, s80, 32768
    v_mfma_f32_16x16x32_bf16 v[28:31], v[140:143], v[80:83], v[28:31]
    ds_read_b128 v[124:127], v227 offset:192
    buffer_load_dwordx4 v237, s[20:23], s71 offen lds
    v_mfma_f32_16x16x32_bf16 v[28:31], v[144:147], v[76:79], v[28:31]
    v_mfma_f32_16x16x32_bf16 v[28:31], v[148:151], v[72:75], v[28:31]
    v_mfma_f32_16x16x32_bf16 v[28:31], v[152:155], v[68:71], v[28:31]
    v_mfma_f32_16x16x32_bf16 v[28:31], v[156:159], v[64:67], v[28:31]
    v_mfma_f32_16x16x32_bf16 v[0:3], v[32:35], v[96:99], v[0:3]
    s_waitcnt lgkmcnt(15)
    v_mfma_f32_16x16x32_bf16 v[4:7], v[32:35], v[100:103], v[4:7]
    v_mfma_f32_16x16x32_bf16 v[4:7], v[36:39], v[96:99], v[4:7]
    s_waitcnt vmcnt(9)
    buffer_store_dwordx4 v[248:251], v252, s[16:19], s13 offen sc1
    v_mfma_f32_16x16x32_bf16 v[8:11], v[32:35], v[104:107], v[8:11]
    v_mfma_f32_16x16x32_bf16 v[8:11], v[36:39], v[100:103], v[8:11]
    v_mfma_f32_16x16x32_bf16 v[8:11], v[40:43], v[96:99], v[8:11]
    s_add_u32 m0, s80, 36864
    s_waitcnt lgkmcnt(12)
    v_mfma_f32_16x16x32_bf16 v[12:15], v[32:35], v[108:111], v[12:15]
    buffer_load_dwordx4 v239, s[20:23], s71 offen lds
    v_mfma_f32_16x16x32_bf16 v[12:15], v[36:39], v[104:107], v[12:15]
    v_mfma_f32_16x16x32_bf16 v[12:15], v[40:43], v[100:103], v[12:15]
    ds_read_b64 v[128:129], v226 offset:256
    v_mfma_f32_16x16x32_bf16 v[12:15], v[44:47], v[96:99], v[12:15]
    ds_read_b64 v[130:131], v226 offset:264
    s_waitcnt lgkmcnt(11)
    v_mfma_f32_16x16x32_bf16 v[16:19], v[32:35], v[112:115], v[16:19]
    ds_read_b128 v[64:67], v227 offset:3840
    v_mfma_f32_16x16x32_bf16 v[16:19], v[36:39], v[108:111], v[16:19]
    ds_read_b64 v[132:133], v226 offset:768
    v_mfma_f32_16x16x32_bf16 v[16:19], v[40:43], v[104:107], v[16:19]
    ds_read_b64 v[134:135], v226 offset:776
    v_mfma_f32_16x16x32_bf16 v[16:19], v[44:47], v[100:103], v[16:19]
    ds_read_b128 v[68:71], v227 offset:3328
    s_add_u32 m0, s38, 40960
    v_mfma_f32_16x16x32_bf16 v[16:19], v[48:51], v[96:99], v[16:19]
    ds_read_b64 v[136:137], v226 offset:1280
    buffer_load_dwordx4 v237, s[20:23], s72 offen lds
    s_waitcnt lgkmcnt(13)
    v_mfma_f32_16x16x32_bf16 v[20:23], v[32:35], v[116:119], v[20:23]
    ds_read_b64 v[138:139], v226 offset:1288
    v_mfma_f32_16x16x32_bf16 v[20:23], v[36:39], v[112:115], v[20:23]
    ds_read_b128 v[72:75], v227 offset:2816
    v_mfma_f32_16x16x32_bf16 v[20:23], v[40:43], v[108:111], v[20:23]
    ds_read_b64 v[140:141], v226 offset:1792
    v_mfma_f32_16x16x32_bf16 v[20:23], v[44:47], v[104:107], v[20:23]
    ds_read_b64 v[142:143], v226 offset:1800
    v_mfma_f32_16x16x32_bf16 v[20:23], v[48:51], v[100:103], v[20:23]
    ds_read_b128 v[76:79], v227 offset:2304
    v_mfma_f32_16x16x32_bf16 v[20:23], v[52:55], v[96:99], v[20:23]
    ds_read_b64 v[144:145], v226 offset:2304
    s_waitcnt lgkmcnt(15)
    v_mfma_f32_16x16x32_bf16 v[24:27], v[32:35], v[120:123], v[24:27]
    ds_read_b64 v[146:147], v226 offset:2312
    s_add_u32 m0, s38, 45056
    v_mfma_f32_16x16x32_bf16 v[24:27], v[36:39], v[116:119], v[24:27]
    ds_read_b128 v[80:83], v227 offset:1792
    buffer_load_dwordx4 v239, s[20:23], s72 offen lds
    v_mfma_f32_16x16x32_bf16 v[24:27], v[40:43], v[112:115], v[24:27]
    ds_read_b64 v[148:149], v226 offset:2816
    v_mfma_f32_16x16x32_bf16 v[24:27], v[44:47], v[108:111], v[24:27]
    ds_read_b64 v[150:151], v226 offset:2824
    v_mfma_f32_16x16x32_bf16 v[24:27], v[48:51], v[104:107], v[24:27]
    ds_read_b128 v[84:87], v227 offset:1280
    v_mfma_f32_16x16x32_bf16 v[24:27], v[52:55], v[100:103], v[24:27]
    ds_read_b64 v[152:153], v226 offset:3328
    v_mfma_f32_16x16x32_bf16 v[24:27], v[56:59], v[96:99], v[24:27]
    ds_read_b64 v[154:155], v226 offset:3336
    s_waitcnt lgkmcnt(15)
    v_mfma_f32_16x16x32_bf16 v[28:31], v[32:35], v[124:127], v[28:31]
    ds_read_b128 v[88:91], v227 offset:768
    v_mfma_f32_16x16x32_bf16 v[28:31], v[36:39], v[120:123], v[28:31]
    ds_read_b64 v[156:157], v226 offset:3840
    s_add_u32 m0, s38, 49152
    v_mfma_f32_16x16x32_bf16 v[28:31], v[40:43], v[116:119], v[28:31]
    ds_read_b64 v[158:159], v226 offset:3848
    buffer_load_dwordx4 v237, s[20:23], s73 offen lds
    v_mfma_f32_16x16x32_bf16 v[28:31], v[44:47], v[112:115], v[28:31]
    ds_read_b128 v[92:95], v227 offset:256
    v_mfma_f32_16x16x32_bf16 v[28:31], v[48:51], v[108:111], v[28:31]
    v_mfma_f32_16x16x32_bf16 v[28:31], v[52:55], v[104:107], v[28:31]
    v_mfma_f32_16x16x32_bf16 v[28:31], v[56:59], v[100:103], v[28:31]
    v_mfma_f32_16x16x32_bf16 v[28:31], v[60:63], v[96:99], v[28:31]
    v_mfma_f32_16x16x32_bf16 v[0:3], v[128:131], v[64:67], v[0:3]
    s_waitcnt lgkmcnt(15)
    v_mfma_f32_16x16x32_bf16 v[4:7], v[128:131], v[68:71], v[4:7]
    s_add_u32 m0, s38, 53248
    v_mfma_f32_16x16x32_bf16 v[4:7], v[132:135], v[64:67], v[4:7]
    buffer_load_dwordx4 v239, s[20:23], s73 offen lds
    v_mfma_f32_16x16x32_bf16 v[8:11], v[128:131], v[72:75], v[8:11]
    v_mfma_f32_16x16x32_bf16 v[8:11], v[132:135], v[68:71], v[8:11]
    v_mfma_f32_16x16x32_bf16 v[8:11], v[136:139], v[64:67], v[8:11]
    s_waitcnt lgkmcnt(12)
    v_mfma_f32_16x16x32_bf16 v[12:15], v[128:131], v[76:79], v[12:15]
    v_mfma_f32_16x16x32_bf16 v[12:15], v[132:135], v[72:75], v[12:15]
    v_mfma_f32_16x16x32_bf16 v[12:15], v[136:139], v[68:71], v[12:15]
    ds_read_b64 v[32:33], v226 offset:320
    v_mfma_f32_16x16x32_bf16 v[12:15], v[140:143], v[64:67], v[12:15]
    ds_read_b64 v[34:35], v226 offset:328
    s_add_u32 m0, s38, 57344
    s_waitcnt lgkmcnt(11)
    v_mfma_f32_16x16x32_bf16 v[16:19], v[128:131], v[80:83], v[16:19]
    ds_read_b128 v[96:99], v227 offset:3904
    buffer_load_dwordx4 v237, s[20:23], s74 offen lds
    v_mfma_f32_16x16x32_bf16 v[16:19], v[132:135], v[76:79], v[16:19]
    ds_read_b64 v[36:37], v226 offset:832
    v_mfma_f32_16x16x32_bf16 v[16:19], v[136:139], v[72:75], v[16:19]
    ds_read_b64 v[38:39], v226 offset:840
    v_mfma_f32_16x16x32_bf16 v[16:19], v[140:143], v[68:71], v[16:19]
    ds_read_b128 v[100:103], v227 offset:3392
    v_mfma_f32_16x16x32_bf16 v[16:19], v[144:147], v[64:67], v[16:19]
    ds_read_b64 v[40:41], v226 offset:1344
    s_waitcnt lgkmcnt(13)
    v_mfma_f32_16x16x32_bf16 v[20:23], v[128:131], v[84:87], v[20:23]
    ds_read_b64 v[42:43], v226 offset:1352
    v_mfma_f32_16x16x32_bf16 v[20:23], v[132:135], v[80:83], v[20:23]
    ds_read_b128 v[104:107], v227 offset:2880
    v_mfma_f32_16x16x32_bf16 v[20:23], v[136:139], v[76:79], v[20:23]
    ds_read_b64 v[44:45], v226 offset:1856
    s_add_u32 m0, s38, 61440
    v_mfma_f32_16x16x32_bf16 v[20:23], v[140:143], v[72:75], v[20:23]
    ds_read_b64 v[46:47], v226 offset:1864
    buffer_load_dwordx4 v239, s[20:23], s74 offen lds
    v_mfma_f32_16x16x32_bf16 v[20:23], v[144:147], v[68:71], v[20:23]
    ds_read_b128 v[108:111], v227 offset:2368
    v_mfma_f32_16x16x32_bf16 v[20:23], v[148:151], v[64:67], v[20:23]
    ds_read_b64 v[48:49], v226 offset:2368
    s_waitcnt lgkmcnt(15)
    v_mfma_f32_16x16x32_bf16 v[24:27], v[128:131], v[88:91], v[24:27]
    ds_read_b64 v[50:51], v226 offset:2376
    v_mfma_f32_16x16x32_bf16 v[24:27], v[132:135], v[84:87], v[24:27]
    ds_read_b128 v[112:115], v227 offset:1856
    v_mfma_f32_16x16x32_bf16 v[24:27], v[136:139], v[80:83], v[24:27]
    ds_read_b64 v[52:53], v226 offset:2880
    v_mfma_f32_16x16x32_bf16 v[24:27], v[140:143], v[76:79], v[24:27]
    ds_read_b64 v[54:55], v226 offset:2888
    v_mfma_f32_16x16x32_bf16 v[24:27], v[144:147], v[72:75], v[24:27]
    ds_read_b128 v[116:119], v227 offset:1344
    s_add_u32 m0, s38, 65536
    v_mfma_f32_16x16x32_bf16 v[24:27], v[148:151], v[68:71], v[24:27]
    ds_read_b64 v[56:57], v226 offset:3392
    buffer_load_dwordx4 v237, s[20:23], s75 offen lds
    v_mfma_f32_16x16x32_bf16 v[24:27], v[152:155], v[64:67], v[24:27]
    ds_read_b64 v[58:59], v226 offset:3400
    s_waitcnt lgkmcnt(15)
    v_mfma_f32_16x16x32_bf16 v[28:31], v[128:131], v[92:95], v[28:31]
    ds_read_b128 v[120:123], v227 offset:832
    v_mfma_f32_16x16x32_bf16 v[28:31], v[132:135], v[88:91], v[28:31]
    ds_read_b64 v[60:61], v226 offset:3904
    v_mfma_f32_16x16x32_bf16 v[28:31], v[136:139], v[84:87], v[28:31]
    ds_read_b64 v[62:63], v226 offset:3912
    v_mfma_f32_16x16x32_bf16 v[28:31], v[140:143], v[80:83], v[28:31]
    ds_read_b128 v[124:127], v227 offset:320
    v_mfma_f32_16x16x32_bf16 v[28:31], v[144:147], v[76:79], v[28:31]
    v_mfma_f32_16x16x32_bf16 v[28:31], v[148:151], v[72:75], v[28:31]
    s_add_u32 m0, s38, 69632
    v_mfma_f32_16x16x32_bf16 v[28:31], v[152:155], v[68:71], v[28:31]
    buffer_load_dwordx4 v239, s[20:23], s75 offen lds
    v_mfma_f32_16x16x32_bf16 v[28:31], v[156:159], v[64:67], v[28:31]
    v_mfma_f32_16x16x32_bf16 v[0:3], v[32:35], v[96:99], v[0:3]
    s_waitcnt lgkmcnt(15)
    v_mfma_f32_16x16x32_bf16 v[4:7], v[32:35], v[100:103], v[4:7]
    v_mfma_f32_16x16x32_bf16 v[4:7], v[36:39], v[96:99], v[4:7]
    buffer_load_dwordx2 v[232:233], v223, s[24:27], s44 offen
    v_mfma_f32_16x16x32_bf16 v[8:11], v[32:35], v[104:107], v[8:11]
    v_mfma_f32_16x16x32_bf16 v[8:11], v[36:39], v[100:103], v[8:11]
    v_mfma_f32_16x16x32_bf16 v[8:11], v[40:43], v[96:99], v[8:11]
    s_waitcnt lgkmcnt(12)
    v_mfma_f32_16x16x32_bf16 v[12:15], v[32:35], v[108:111], v[12:15]
    v_mfma_f32_16x16x32_bf16 v[12:15], v[36:39], v[104:107], v[12:15]
    v_mfma_f32_16x16x32_bf16 v[12:15], v[40:43], v[100:103], v[12:15]
    ds_read_b64 v[128:129], v226 offset:384
    v_mfma_f32_16x16x32_bf16 v[12:15], v[44:47], v[96:99], v[12:15]
    ds_read_b64 v[130:131], v226 offset:392
    s_waitcnt lgkmcnt(11)
    v_mfma_f32_16x16x32_bf16 v[16:19], v[32:35], v[112:115], v[16:19]
    ds_read_b128 v[64:67], v227 offset:3968
    v_mfma_f32_16x16x32_bf16 v[16:19], v[36:39], v[108:111], v[16:19]
    ds_read_b64 v[132:133], v226 offset:896
    v_mfma_f32_16x16x32_bf16 v[16:19], v[40:43], v[104:107], v[16:19]
    ds_read_b64 v[134:135], v226 offset:904
    v_mfma_f32_16x16x32_bf16 v[16:19], v[44:47], v[100:103], v[16:19]
    ds_read_b128 v[68:71], v227 offset:3456
    v_mfma_f32_16x16x32_bf16 v[16:19], v[48:51], v[96:99], v[16:19]
    ds_read_b64 v[136:137], v226 offset:1408
    s_waitcnt lgkmcnt(13)
    v_mfma_f32_16x16x32_bf16 v[20:23], v[32:35], v[116:119], v[20:23]
    ds_read_b64 v[138:139], v226 offset:1416
    v_mfma_f32_16x16x32_bf16 v[20:23], v[36:39], v[112:115], v[20:23]
    ds_read_b128 v[72:75], v227 offset:2944
    buffer_load_dwordx2 v[234:235], v223, s[24:27], s45 offen
    v_mfma_f32_16x16x32_bf16 v[20:23], v[40:43], v[108:111], v[20:23]
    ds_read_b64 v[140:141], v226 offset:1920
    v_mfma_f32_16x16x32_bf16 v[20:23], v[44:47], v[104:107], v[20:23]
    ds_read_b64 v[142:143], v226 offset:1928
    v_mfma_f32_16x16x32_bf16 v[20:23], v[48:51], v[100:103], v[20:23]
    ds_read_b128 v[76:79], v227 offset:2432
    v_mfma_f32_16x16x32_bf16 v[20:23], v[52:55], v[96:99], v[20:23]
    ds_read_b64 v[144:145], v226 offset:2432
    s_waitcnt lgkmcnt(15)
    v_mfma_f32_16x16x32_bf16 v[24:27], v[32:35], v[120:123], v[24:27]
    ds_read_b64 v[146:147], v226 offset:2440
    v_mfma_f32_16x16x32_bf16 v[24:27], v[36:39], v[116:119], v[24:27]
    ds_read_b128 v[80:83], v227 offset:1920
    v_mfma_f32_16x16x32_bf16 v[24:27], v[40:43], v[112:115], v[24:27]
    ds_read_b64 v[148:149], v226 offset:2944
    v_mfma_f32_16x16x32_bf16 v[24:27], v[44:47], v[108:111], v[24:27]
    ds_read_b64 v[150:151], v226 offset:2952
    v_mfma_f32_16x16x32_bf16 v[24:27], v[48:51], v[104:107], v[24:27]
    ds_read_b128 v[84:87], v227 offset:1408
    v_mfma_f32_16x16x32_bf16 v[24:27], v[52:55], v[100:103], v[24:27]
    ds_read_b64 v[152:153], v226 offset:3456
    v_mfma_f32_16x16x32_bf16 v[24:27], v[56:59], v[96:99], v[24:27]
    ds_read_b64 v[154:155], v226 offset:3464
    s_waitcnt lgkmcnt(15)
    v_mfma_f32_16x16x32_bf16 v[28:31], v[32:35], v[124:127], v[28:31]
    ds_read_b128 v[88:91], v227 offset:896
    v_mfma_f32_16x16x32_bf16 v[28:31], v[36:39], v[120:123], v[28:31]
    ds_read_b64 v[156:157], v226 offset:3968
    v_mfma_f32_16x16x32_bf16 v[28:31], v[40:43], v[116:119], v[28:31]
    ds_read_b64 v[158:159], v226 offset:3976
    buffer_load_dwordx2 v[212:213], v223, s[24:27], s46 offen
    v_mfma_f32_16x16x32_bf16 v[28:31], v[44:47], v[112:115], v[28:31]
    ds_read_b128 v[92:95], v227 offset:384
    v_mfma_f32_16x16x32_bf16 v[28:31], v[48:51], v[108:111], v[28:31]
    v_mfma_f32_16x16x32_bf16 v[28:31], v[52:55], v[104:107], v[28:31]
    v_mfma_f32_16x16x32_bf16 v[28:31], v[56:59], v[100:103], v[28:31]
    v_mfma_f32_16x16x32_bf16 v[28:31], v[60:63], v[96:99], v[28:31]
    v_mfma_f32_16x16x32_bf16 v[0:3], v[128:131], v[64:67], v[0:3]
    s_waitcnt lgkmcnt(15)
    v_mfma_f32_16x16x32_bf16 v[4:7], v[128:131], v[68:71], v[4:7]
    v_mfma_f32_16x16x32_bf16 v[4:7], v[132:135], v[64:67], v[4:7]
    v_mfma_f32_16x16x32_bf16 v[8:11], v[128:131], v[72:75], v[8:11]
    v_mfma_f32_16x16x32_bf16 v[8:11], v[132:135], v[68:71], v[8:11]
    v_mfma_f32_16x16x32_bf16 v[8:11], v[136:139], v[64:67], v[8:11]
    s_waitcnt lgkmcnt(12)
    v_mfma_f32_16x16x32_bf16 v[12:15], v[128:131], v[76:79], v[12:15]
    v_mfma_f32_16x16x32_bf16 v[12:15], v[132:135], v[72:75], v[12:15]
    v_mfma_f32_16x16x32_bf16 v[12:15], v[136:139], v[68:71], v[12:15]
    ds_read_b64 v[32:33], v226 offset:448
    buffer_load_dwordx2 v[214:215], v223, s[24:27], s47 offen
    v_mfma_f32_16x16x32_bf16 v[12:15], v[140:143], v[64:67], v[12:15]
    ds_read_b64 v[34:35], v226 offset:456
    s_waitcnt lgkmcnt(11)
    v_mfma_f32_16x16x32_bf16 v[16:19], v[128:131], v[80:83], v[16:19]
    ds_read_b128 v[96:99], v227 offset:4032
    v_mfma_f32_16x16x32_bf16 v[16:19], v[132:135], v[76:79], v[16:19]
    ds_read_b64 v[36:37], v226 offset:960
    v_mfma_f32_16x16x32_bf16 v[16:19], v[136:139], v[72:75], v[16:19]
    ds_read_b64 v[38:39], v226 offset:968
    v_mfma_f32_16x16x32_bf16 v[16:19], v[140:143], v[68:71], v[16:19]
    ds_read_b128 v[100:103], v227 offset:3520
    v_mfma_f32_16x16x32_bf16 v[16:19], v[144:147], v[64:67], v[16:19]
    ds_read_b64 v[40:41], v226 offset:1472
    s_waitcnt lgkmcnt(13)
    v_mfma_f32_16x16x32_bf16 v[20:23], v[128:131], v[84:87], v[20:23]
    ds_read_b64 v[42:43], v226 offset:1480
    v_mfma_f32_16x16x32_bf16 v[20:23], v[132:135], v[80:83], v[20:23]
    ds_read_b128 v[104:107], v227 offset:3008
    v_mfma_f32_16x16x32_bf16 v[20:23], v[136:139], v[76:79], v[20:23]
    ds_read_b64 v[44:45], v226 offset:1984
    v_mfma_f32_16x16x32_bf16 v[20:23], v[140:143], v[72:75], v[20:23]
    ds_read_b64 v[46:47], v226 offset:1992
    v_mfma_f32_16x16x32_bf16 v[20:23], v[144:147], v[68:71], v[20:23]
    ds_read_b128 v[108:111], v227 offset:2496
    v_mfma_f32_16x16x32_bf16 v[20:23], v[148:151], v[64:67], v[20:23]
    ds_read_b64 v[48:49], v226 offset:2496
    s_waitcnt lgkmcnt(15)
    v_mfma_f32_16x16x32_bf16 v[24:27], v[128:131], v[88:91], v[24:27]
    ds_read_b64 v[50:51], v226 offset:2504
    v_mfma_f32_16x16x32_bf16 v[24:27], v[132:135], v[84:87], v[24:27]
    ds_read_b128 v[112:115], v227 offset:1984
    buffer_load_dwordx2 v[230:231], v224, s[24:27], s48 offen
    v_mfma_f32_16x16x32_bf16 v[24:27], v[136:139], v[80:83], v[24:27]
    ds_read_b64 v[52:53], v226 offset:3008
    v_mfma_f32_16x16x32_bf16 v[24:27], v[140:143], v[76:79], v[24:27]
    ds_read_b64 v[54:55], v226 offset:3016
    v_mfma_f32_16x16x32_bf16 v[24:27], v[144:147], v[72:75], v[24:27]
    ds_read_b128 v[116:119], v227 offset:1472
    v_mfma_f32_16x16x32_bf16 v[24:27], v[148:151], v[68:71], v[24:27]
    ds_read_b64 v[56:57], v226 offset:3520
    v_mfma_f32_16x16x32_bf16 v[24:27], v[152:155], v[64:67], v[24:27]
    ds_read_b64 v[58:59], v226 offset:3528
    s_waitcnt lgkmcnt(15)
    v_mfma_f32_16x16x32_bf16 v[28:31], v[128:131], v[92:95], v[28:31]
    ds_read_b128 v[120:123], v227 offset:960
    v_mfma_f32_16x16x32_bf16 v[28:31], v[132:135], v[88:91], v[28:31]
    ds_read_b64 v[60:61], v226 offset:4032
    v_mfma_f32_16x16x32_bf16 v[28:31], v[136:139], v[84:87], v[28:31]
    ds_read_b64 v[62:63], v226 offset:4040
    v_mfma_f32_16x16x32_bf16 v[28:31], v[140:143], v[80:83], v[28:31]
    ds_read_b128 v[124:127], v227 offset:448
    v_mfma_f32_16x16x32_bf16 v[28:31], v[144:147], v[76:79], v[28:31]
    v_mfma_f32_16x16x32_bf16 v[28:31], v[148:151], v[72:75], v[28:31]
    v_mfma_f32_16x16x32_bf16 v[28:31], v[152:155], v[68:71], v[28:31]
    v_mfma_f32_16x16x32_bf16 v[28:31], v[156:159], v[64:67], v[28:31]
    v_mfma_f32_16x16x32_bf16 v[0:3], v[32:35], v[96:99], v[0:3]
    s_waitcnt lgkmcnt(15)
    v_mfma_f32_16x16x32_bf16 v[4:7], v[32:35], v[100:103], v[4:7]
    v_mfma_f32_16x16x32_bf16 v[4:7], v[36:39], v[96:99], v[4:7]
    v_mfma_f32_16x16x32_bf16 v[8:11], v[32:35], v[104:107], v[8:11]
    v_mfma_f32_16x16x32_bf16 v[8:11], v[36:39], v[100:103], v[8:11]
    v_mfma_f32_16x16x32_bf16 v[8:11], v[40:43], v[96:99], v[8:11]
    v_cvt_pk_bf16_f32 v128, v0, v1
    v_cvt_pk_bf16_f32 v129, v2, v3
    s_waitcnt lgkmcnt(12)
    v_mfma_f32_16x16x32_bf16 v[12:15], v[32:35], v[108:111], v[12:15]
    v_cvt_pk_bf16_f32 v130, v4, v5
    v_cvt_pk_bf16_f32 v131, v6, v7
    v_mfma_f32_16x16x32_bf16 v[12:15], v[36:39], v[104:107], v[12:15]
    s_nop 0
    v_permlane16_swap_b32 v128, v130
    v_mfma_f32_16x16x32_bf16 v[12:15], v[40:43], v[100:103], v[12:15]
    v_permlane16_swap_b32 v129, v131
    s_nop 0
    v_mfma_f32_16x16x32_bf16 v[12:15], v[44:47], v[96:99], v[12:15]
    s_waitcnt lgkmcnt(9)
    s_waitcnt vmcnt(5) lgkmcnt(0)
    s_barrier
    v_mfma_f32_16x16x32_bf16 v[16:19], v[32:35], v[112:115], v[16:19]
    buffer_load_dwordx2 v[250:251], v253, s[16:19], s14 offen sc1
    v_mfma_f32_16x16x32_bf16 v[16:19], v[36:39], v[108:111], v[16:19]
    v_mfma_f32_16x16x32_bf16 v[16:19], v[40:43], v[104:107], v[16:19]
    v_cvt_pk_bf16_f32 v132, v8, v9
    v_cvt_pk_bf16_f32 v133, v10, v11
    v_mfma_f32_16x16x32_bf16 v[16:19], v[44:47], v[100:103], v[16:19]
    v_cvt_pk_bf16_f32 v134, v12, v13
    v_cvt_pk_bf16_f32 v135, v14, v15
    v_mfma_f32_16x16x32_bf16 v[16:19], v[48:51], v[96:99], v[16:19]
    buffer_store_dwordx4 v[128:131], v228, s[16:19], s43 offen offset:0 sc1
    s_nop 0
    v_mfma_f32_16x16x32_bf16 v[20:23], v[32:35], v[116:119], v[20:23]
    v_permlane16_swap_b32 v132, v134
    v_permlane16_swap_b32 v133, v135
    v_mfma_f32_16x16x32_bf16 v[20:23], v[36:39], v[112:115], v[20:23]
    s_nop 0
    v_mfma_f32_16x16x32_bf16 v[20:23], v[40:43], v[108:111], v[20:23]
    v_mfma_f32_16x16x32_bf16 v[20:23], v[44:47], v[104:107], v[20:23]
    buffer_store_dwordx4 v[132:135], v228, s[16:19], s43 offen offset:1024 sc1
    v_mfma_f32_16x16x32_bf16 v[20:23], v[48:51], v[100:103], v[20:23]
    v_mfma_f32_16x16x32_bf16 v[20:23], v[52:55], v[96:99], v[20:23]
    v_mfma_f32_16x16x32_bf16 v[24:27], v[32:35], v[120:123], v[24:27]
    v_mfma_f32_16x16x32_bf16 v[24:27], v[36:39], v[116:119], v[24:27]
    v_mfma_f32_16x16x32_bf16 v[24:27], v[40:43], v[112:115], v[24:27]
    v_cvt_pk_bf16_f32 v136, v16, v17
    v_cvt_pk_bf16_f32 v137, v18, v19
    v_mfma_f32_16x16x32_bf16 v[24:27], v[44:47], v[108:111], v[24:27]
    v_cvt_pk_bf16_f32 v138, v20, v21
    v_cvt_pk_bf16_f32 v139, v22, v23
    v_mfma_f32_16x16x32_bf16 v[24:27], v[48:51], v[104:107], v[24:27]
    s_nop 0
    v_permlane16_swap_b32 v136, v138
    v_mfma_f32_16x16x32_bf16 v[24:27], v[52:55], v[100:103], v[24:27]
    v_permlane16_swap_b32 v137, v139
    s_nop 0
    v_mfma_f32_16x16x32_bf16 v[24:27], v[56:59], v[96:99], v[24:27]
    buffer_store_dwordx4 v[136:139], v228, s[16:19], s43 offen offset:2048 sc1
    ds_read_b64_tr_b16 v[192:193], v222 offset:0
    v_mfma_f32_16x16x32_bf16 v[28:31], v[32:35], v[124:127], v[28:31]
    ds_read_b64_tr_b16 v[194:195], v222 offset:512
    v_mfma_f32_16x16x32_bf16 v[28:31], v[36:39], v[120:123], v[28:31]
    ds_read_b64_tr_b16 v[196:197], v222 offset:1024
    v_mfma_f32_16x16x32_bf16 v[28:31], v[40:43], v[116:119], v[28:31]
    ds_read_b64_tr_b16 v[198:199], v222 offset:1536
    v_mfma_f32_16x16x32_bf16 v[28:31], v[44:47], v[112:115], v[28:31]
    ds_read_b64_tr_b16 v[200:201], v216 offset:0
    v_mfma_f32_16x16x32_bf16 v[28:31], v[48:51], v[108:111], v[28:31]
    ds_read_b64_tr_b16 v[202:203], v216 offset:2048
    v_mfma_f32_16x16x32_bf16 v[28:31], v[52:55], v[104:107], v[28:31]
    ds_read_b64_tr_b16 v[204:205], v216 offset:4096
    v_mfma_f32_16x16x32_bf16 v[28:31], v[56:59], v[100:103], v[28:31]
    ds_read_b64_tr_b16 v[206:207], v216 offset:6144
    v_mfma_f32_16x16x32_bf16 v[28:31], v[60:63], v[96:99], v[28:31]
    s_branch L_g2
L_idle:
    v_mul_f32 v32, v32, v96
    v_mul_f32 v33, v33, v97
    v_mul_f32 v34, v34, v98
    v_mul_f32 v35, v35, v99
    v_cvt_pk_bf16_f32 v176, v32, v33
    v_cvt_pk_bf16_f32 v177, v34, v35
    v_mul_f32 v48, v48, v112
    v_mul_f32 v49, v49, v113
    v_mul_f32 v50, v50, v114
    v_mul_f32 v51, v51, v115
    v_cvt_pk_bf16_f32 v178, v48, v49
    v_cvt_pk_bf16_f32 v179, v50, v51
    buffer_store_dwordx4 v[176:179], v241, s[16:19], s66 offen offset:0 sc1
    v_mul_f32 v36, v36, v100
    v_mul_f32 v37, v37, v101
    v_mul_f32 v38, v38, v102
    v_mul_f32 v39, v39, v103
    v_cvt_pk_bf16_f32 v180, v36, v37
    v_cvt_pk_bf16_f32 v181, v38, v39
    v_mul_f32 v52, v52, v116
    v_mul_f32 v53, v53, v117
    v_mul_f32 v54, v54, v118
    v_mul_f32 v55, v55, v119
    v_cvt_pk_bf16_f32 v182, v52, v53
    v_cvt_pk_bf16_f32 v183, v54, v55
    buffer_store_dwordx4 v[180:183], v241, s[16:19], s66 offen offset:1024 sc1
    v_mul_f32 v40, v40, v104
    v_mul_f32 v41, v41, v105
    v_mul_f32 v42, v42, v106
    v_mul_f32 v43, v43, v107
    v_cvt_pk_bf16_f32 v184, v40, v41
    v_cvt_pk_bf16_f32 v185, v42, v43
    v_mul_f32 v56, v56, v120
    v_mul_f32 v57, v57, v121
    v_mul_f32 v58, v58, v122
    v_mul_f32 v59, v59, v123
    v_cvt_pk_bf16_f32 v186, v56, v57
    v_cvt_pk_bf16_f32 v187, v58, v59
    buffer_store_dwordx4 v[184:187], v241, s[16:19], s66 offen offset:2048 sc1
    v_mul_f32 v44, v44, v108
    v_mul_f32 v45, v45, v109
    v_mul_f32 v46, v46, v110
    v_mul_f32 v47, v47, v111
    v_cvt_pk_bf16_f32 v188, v44, v45
    v_cvt_pk_bf16_f32 v189, v46, v47
    v_mul_f32 v60, v60, v124
    v_mul_f32 v61, v61, v125
    v_mul_f32 v62, v62, v126
    v_mul_f32 v63, v63, v127
    v_cvt_pk_bf16_f32 v190, v60, v61
    v_cvt_pk_bf16_f32 v191, v62, v63
    buffer_store_dwordx4 v[188:191], v241, s[16:19], s66 offen offset:3072 sc1
    s_mov_b32 s14, 9764864
    s_waitcnt vmcnt(0)
    buffer_store_dwordx4 v[248:251], v252, s[16:19], s13 offen sc1
    s_add_u32 m0, s38, 0
    s_nop 0
    buffer_load_dwordx4 v237, s[20:23], s67 offen lds
    s_add_u32 m0, s38, 4096
    s_nop 0
    buffer_load_dwordx4 v239, s[20:23], s67 offen lds
    s_add_u32 m0, s38, 8192
    s_nop 0
    buffer_load_dwordx4 v237, s[20:23], s68 offen lds
    s_add_u32 m0, s38, 12288
    s_nop 0
    buffer_load_dwordx4 v239, s[20:23], s68 offen lds
    s_add_u32 m0, s38, 16384
    s_nop 0
    buffer_load_dwordx4 v237, s[20:23], s69 offen lds
    s_add_u32 m0, s38, 20480
    s_nop 0
    buffer_load_dwordx4 v239, s[20:23], s69 offen lds
    s_add_u32 m0, s38, 24576
    s_nop 0
    buffer_load_dwordx4 v237, s[20:23], s70 offen lds
    s_add_u32 m0, s38, 28672
    s_nop 0
    buffer_load_dwordx4 v239, s[20:23], s70 offen lds
    s_add_u32 m0, s80, 32768
    s_nop 0
    buffer_load_dwordx4 v237, s[20:23], s71 offen lds
    s_add_u32 m0, s80, 36864
    s_nop 0
    buffer_load_dwordx4 v239, s[20:23], s71 offen lds
    s_add_u32 m0, s38, 40960
    s_nop 0
    buffer_load_dwordx4 v237, s[20:23], s72 offen lds
    s_add_u32 m0, s38, 45056
    s_nop 0
    buffer_load_dwordx4 v239, s[20:23], s72 offen lds
    s_add_u32 m0, s38, 49152
    s_nop 0
    buffer_load_dwordx4 v237, s[20:23], s73 offen lds
    s_add_u32 m0, s38, 53248
    s_nop 0
    buffer_load_dwordx4 v239, s[20:23], s73 offen lds
    s_add_u32 m0, s38, 57344
    s_nop 0
    buffer_load_dwordx4 v237, s[20:23], s74 offen lds
    s_add_u32 m0, s38, 61440
    s_nop 0
    buffer_load_dwordx4 v239, s[20:23], s74 offen lds
    s_add_u32 m0, s38, 65536
    s_nop 0
    buffer_load_dwordx4 v237, s[20:23], s75 offen lds
    s_add_u32 m0, s38, 69632
    s_nop 0
    buffer_load_dwordx4 v239, s[20:23], s75 offen lds
L_idle2:
    buffer_load_dwordx2 v[232:233], v223, s[24:27], s44 offen
    buffer_load_dwordx2 v[234:235], v223, s[24:27], s45 offen
    buffer_load_dwordx2 v[212:213], v223, s[24:27], s46 offen
    buffer_load_dwordx2 v[214:215], v223, s[24:27], s47 offen
    buffer_load_dwordx2 v[230:231], v224, s[24:27], s48 offen
    s_waitcnt vmcnt(0) lgkmcnt(0)
    s_barrier
    ds_read_b64_tr_b16 v[192:193], v222 offset:0
    ds_read_b64_tr_b16 v[194:195], v222 offset:512
    ds_read_b64_tr_b16 v[196:197], v222 offset:1024
    ds_read_b64_tr_b16 v[198:199], v222 offset:1536
    ds_read_b64_tr_b16 v[200:201], v216 offset:0
    ds_read_b64_tr_b16 v[202:203], v216 offset:2048
    ds_read_b64_tr_b16 v[204:205], v216 offset:4096
    ds_read_b64_tr_b16 v[206:207], v216 offset:6144
    buffer_load_dwordx2 v[250:251], v253, s[16:19], s14 offen sc1
    buffer_store_dwordx4 v[128:131], v228, s[16:19], s43 offen offset:0 sc1
    buffer_store_dwordx4 v[132:135], v228, s[16:19], s43 offen offset:1024 sc1
    buffer_store_dwordx4 v[136:139], v228, s[16:19], s43 offen offset:2048 sc1
L_g2:
    s_waitcnt lgkmcnt(4)
    v_mfma_f32_16x16x32_bf16 v[32:35], v[192:195], a[0:3], 0
    v_mfma_f32_16x16x32_bf16 v[32:35], v[196:199], a[16:19], v[32:35]
    v_mfma_f32_16x16x32_bf16 v[36:39], v[192:195], a[4:7], 0
    v_cvt_pk_bf16_f32 v140, v24, v25
    v_cvt_pk_bf16_f32 v141, v26, v27
    v_mfma_f32_16x16x32_bf16 v[36:39], v[196:199], a[20:23], v[36:39]
    ds_read_b64_tr_b16 v[208:209], v222 offset:2048
    v_cvt_pk_bf16_f32 v142, v28, v29
    v_mfma_f32_16x16x32_bf16 v[40:43], v[192:195], a[8:11], 0
    ds_read_b64_tr_b16 v[210:211], v222 offset:2560
    v_cvt_pk_bf16_f32 v143, v30, v31
    v_mfma_f32_16x16x32_bf16 v[40:43], v[196:199], a[24:27], v[40:43]
    s_nop 0
    v_permlane16_swap_b32 v140, v142
    v_mfma_f32_16x16x32_bf16 v[44:47], v[192:195], a[12:15], 0
    v_permlane16_swap_b32 v141, v143
    s_nop 0
    v_mfma_f32_16x16x32_bf16 v[44:47], v[196:199], a[28:31], v[44:47]
    ds_read_b64_tr_b16 v[192:193], v222 offset:3072
    s_waitcnt lgkmcnt(3)
    v_mfma_f32_16x16x32_bf16 v[48:51], v[200:203], a[0:3], 0
    ds_read_b64_tr_b16 v[194:195], v222 offset:3584
    buffer_store_dwordx4 v[140:143], v228, s[16:19], s43 offen offset:3072 sc1
    v_mfma_f32_16x16x32_bf16 v[48:51], v[204:207], a[16:19], v[48:51]
    v_mfma_f32_16x16x32_bf16 v[52:55], v[200:203], a[4:7], 0
    v_mfma_f32_16x16x32_bf16 v[52:55], v[204:207], a[20:23], v[52:55]
    ds_read_b64_tr_b16 v[196:197], v216 offset:8192
    s_add_u32 m0, s38, 159744
    v_mfma_f32_16x16x32_bf16 v[56:59], v[200:203], a[8:11], 0
    ds_read_b64_tr_b16 v[198:199], v216 offset:10240
    buffer_load_dwordx4 v255, s[20:23], s75 offen lds
    v_mfma_f32_16x16x32_bf16 v[56:59], v[204:207], a[24:27], v[56:59]
    v_mfma_f32_16x16x32_bf16 v[60:63], v[200:203], a[12:15], 0
    v_mfma_f32_16x16x32_bf16 v[60:63], v[204:207], a[28:31], v[60:63]
    ds_read_b64_tr_b16 v[200:201], v216 offset:12288
    s_waitcnt lgkmcnt(3)
    v_mfma_f32_16x16x32_bf16 v[44:47], v[208:211], a[44:47], v[44:47]
    ds_read_b64_tr_b16 v[202:203], v216 offset:14336
    s_add_u32 m0, s38, 155648
    v_mfma_f32_16x16x32_bf16 v[44:47], v[192:195], a[60:63], v[44:47]
    buffer_load_dwordx4 v254, s[20:23], s75 offen lds
    v_mfma_f32_16x16x32_bf16 v[40:43], v[208:211], a[40:43], v[40:43]
    v_mfma_f32_16x16x32_bf16 v[40:43], v[192:195], a[56:59], v[40:43]
    ds_read_b64_tr_b16 v[204:205], v222 offset:4096
    v_mfma_f32_16x16x32_bf16 v[36:39], v[208:211], a[36:39], v[36:39]
    ds_read_b64_tr_b16 v[206:207], v222 offset:4608
    v_mfma_f32_16x16x32_bf16 v[36:39], v[192:195], a[52:55], v[36:39]
    s_add_u32 m0, s38, 151552
    v_mfma_f32_16x16x32_bf16 v[32:35], v[208:211], a[32:35], v[32:35]
    buffer_load_dwordx4 v255, s[20:23], s74 offen lds
    v_mfma_f32_16x16x32_bf16 v[32:35], v[192:195], a[48:51], v[32:35]
    ds_read_b64_tr_b16 v[208:209], v222 offset:5120
    s_waitcnt lgkmcnt(3)
    v_mfma_f32_16x16x32_bf16 v[60:63], v[196:199], a[44:47], v[60:63]
    ds_read_b64_tr_b16 v[210:211], v222 offset:5632
    v_mfma_f32_16x16x32_bf16 v[60:63], v[200:203], a[60:63], v[60:63]
    v_mfma_f32_16x16x32_bf16 v[56:59], v[196:199], a[40:43], v[56:59]
    v_mfma_f32_16x16x32_bf16 v[56:59], v[200:203], a[56:59], v[56:59]
    ds_read_b64_tr_b16 v[192:193], v216 offset:16384
    v_mfma_f32_16x16x32_bf16 v[52:55], v[196:199], a[36:39], v[52:55]
    ds_read_b64_tr_b16 v[194:195], v216 offset:18432
    v_mfma_f32_16x16x32_bf16 v[52:55], v[200:203], a[52:55], v[52:55]
    v_mfma_f32_16x16x32_bf16 v[48:51], v[196:199], a[32:35], v[48:51]
    s_waitcnt vmcnt(7)
    v_cmp_ne_u64 vcc, v[250:251], v[248:249]
    v_mfma_f32_16x16x32_bf16 v[48:51], v[200:203], a[48:51], v[48:51]
    ds_read_b64_tr_b16 v[196:197], v216 offset:20480
    s_waitcnt lgkmcnt(3)
    v_mfma_f32_16x16x32_bf16 v[32:35], v[204:207], a[64:67], v[32:35]
    ds_read_b64_tr_b16 v[198:199], v216 offset:22528
    s_cbranch_vccnz L_slow_16
L_back_17:
    v_mfma_f32_16x16x32_bf16 v[32:35], v[208:211], a[80:83], v[32:35]
    buffer_load_dwordx4 a[160:163], v240, s[16:19], s63 offen offset:0 sc1
    s_mul_i32 s12, s32, 3072
    v_mfma_f32_16x16x32_bf16 v[36:39], v[204:207], a[68:71], v[36:39]
    s_add_u32 s12, s12, 73728
    v_lshrrev_b32 v244, 2, v243
    v_mfma_f32_16x16x32_bf16 v[36:39], v[208:211], a[84:87], v[36:39]
    ds_read_b64_tr_b16 v[200:201], v222 offset:6144
    v_and_b32 v245, 3, v243
    v_mfma_f32_16x16x32_bf16 v[40:43], v[204:207], a[72:75], v[40:43]
    ds_read_b64_tr_b16 v[202:203], v222 offset:6656
    v_lshl_add_u32 v246, v245, 3, s12
    v_mfma_f32_16x16x32_bf16 v[40:43], v[208:211], a[88:91], v[40:43]
    v_lshl_add_u32 v226, v244, 6, v246
    v_lshlrev_b32 v246, 4, v245
    v_mfma_f32_16x16x32_bf16 v[44:47], v[204:207], a[76:79], v[44:47]
    buffer_load_dwordx4 a[164:167], v240, s[16:19], s63 offen offset:1024 sc1
    v_lshl_add_u32 v229, v244, 12, v246
    v_mfma_f32_16x16x32_bf16 v[44:47], v[208:211], a[92:95], v[44:47]
    ds_read_b64_tr_b16 v[204:205], v222 offset:7168
    s_waitcnt lgkmcnt(3)
    v_mfma_f32_16x16x32_bf16 v[48:51], v[192:195], a[64:67], v[48:51]
    ds_read_b64_tr_b16 v[206:207], v222 offset:7680
    v_and_b32 v246, 3, v244
    v_mfma_f32_16x16x32_bf16 v[48:51], v[196:199], a[80:83], v[48:51]
    v_lshl_add_u32 v247, v245, 2, v246
    s_lshl_b32 s81, s32, 3
    v_mfma_f32_16x16x32_bf16 v[52:55], v[192:195], a[68:71], v[52:55]
    s_add_u32 s81, s81, s12
    v_lshl_add_u32 v227, v247, 6, s81
    v_mfma_f32_16x16x32_bf16 v[52:55], v[196:199], a[84:87], v[52:55]
    ds_read_b64_tr_b16 v[208:209], v216 offset:24576
    buffer_load_dwordx4 a[168:171], v240, s[16:19], s63 offen offset:2048 sc1
    v_mfma_f32_16x16x32_bf16 v[56:59], v[192:195], a[72:75], v[56:59]
    ds_read_b64_tr_b16 v[210:211], v216 offset:26624
    v_bfe_u32 v247, v243, 4, 1
    v_mfma_f32_16x16x32_bf16 v[56:59], v[196:199], a[88:91], v[56:59]
    v_lshl_add_u32 v227, v247, 5, v227
    v_lshlrev_b32 v245, 4, v245
    v_mfma_f32_16x16x32_bf16 v[60:63], v[192:195], a[76:79], v[60:63]
    v_mov_b32 v14, 0x3f80
    v_mov_b32 v15, 0
    v_mfma_f32_16x16x32_bf16 v[60:63], v[196:199], a[92:95], v[60:63]
    ds_read_b64_tr_b16 v[192:193], v216 offset:28672
    s_waitcnt lgkmcnt(3)
    v_mfma_f32_16x16x32_bf16 v[44:47], v[200:203], a[108:111], v[44:47]
    ds_read_b64_tr_b16 v[194:195], v216 offset:30720
    buffer_load_dwordx4 a[172:175], v240, s[16:19], s63 offen offset:3072 sc1
    v_mfma_f32_16x16x32_bf16 v[44:47], v[204:207], a[124:127], v[44:47]
    v_lshlrev_b64 v[14:15], v245, v[14:15]
    v_cmp_eq_u32 vcc, 0, v246
    s_nop 1
    v_cndmask_b32 v16, 0, v14, vcc
    v_mfma_f32_16x16x32_bf16 v[40:43], v[200:203], a[104:107], v[40:43]
    v_cndmask_b32 v17, 0, v15, vcc
    v_cmp_eq_u32 vcc, 1, v246
    s_nop 1
    v_cndmask_b32 v18, 0, v14, vcc
    v_mfma_f32_16x16x32_bf16 v[40:43], v[204:207], a[120:123], v[40:43]
    ds_read_b64_tr_b16 v[196:197], v222 offset:8192
    v_cndmask_b32 v19, 0, v15, vcc
    v_mfma_f32_16x16x32_bf16 v[36:39], v[200:203], a[100:103], v[36:39]
    ds_read_b64_tr_b16 v[198:199], v222 offset:8704
    v_lshrrev_b32 v245, 4, v243
    v_mfma_f32_16x16x32_bf16 v[36:39], v[204:207], a[116:119], v[36:39]
    buffer_load_dwordx4 a[176:179], v241, s[16:19], s63 offen offset:0 sc1
    v_cmp_eq_u32 vcc, v245, v246
    s_nop 1
    v_cndmask_b32 v12, 0, v14, vcc
    v_mfma_f32_16x16x32_bf16 v[32:35], v[200:203], a[96:99], v[32:35]
    v_cndmask_b32 v13, 0, v15, vcc
    v_mov_b32 v14, v12
    v_mfma_f32_16x16x32_bf16 v[32:35], v[204:207], a[112:115], v[32:35]
    ds_read_b64_tr_b16 v[200:201], v222 offset:9216
    s_waitcnt lgkmcnt(3)
    v_mfma_f32_16x16x32_bf16 v[60:63], v[208:211], a[108:111], v[60:63]
    ds_read_b64_tr_b16 v[202:203], v222 offset:9728
    v_mov_b32 v15, v13
    v_mfma_f32_16x16x32_bf16 v[60:63], v[192:195], a[124:127], v[60:63]
    s_and_b32 s81, s100, 65536
    v_add_u32 v26, s81, v240
    v_mfma_f32_16x16x32_bf16 v[56:59], v[208:211], a[104:107], v[56:59]
    buffer_load_dwordx4 a[180:183], v241, s[16:19], s63 offen offset:1024 sc1
    v_xor_b32 v27, 65536, v26
    v_mfma_f32_16x16x32_bf16 v[56:59], v[192:195], a[120:123], v[56:59]
    ds_read_b64_tr_b16 v[204:205], v216 offset:32768
    s_sub_u32 s82, s100, s81
    v_mfma_f32_16x16x32_bf16 v[52:55], v[208:211], a[100:103], v[52:55]
    ds_read_b64_tr_b16 v[206:207], v216 offset:34816
    s_lshr_b32 s81, s81, 11
    v_mfma_f32_16x16x32_bf16 v[52:55], v[192:195], a[116:119], v[52:55]
    v_lshlrev_b32 v247, 5, v247
    v_xor_b32 v247, s81, v247
    v_mfma_f32_16x16x32_bf16 v[48:51], v[208:211], a[96:99], v[48:51]
    v_and_b32 v245, 15, v243
    v_mul_u32_u24 v228, 1152, v245
    v_mfma_f32_16x16x32_bf16 v[48:51], v[192:195], a[112:115], v[48:51]
    ds_read_b64_tr_b16 v[208:209], v216 offset:36864
    s_waitcnt lgkmcnt(3)
    v_mfma_f32_16x16x32_bf16 v[32:35], v[196:199], a[128:131], v[32:35]
    ds_read_b64_tr_b16 v[210:211], v216 offset:38912
    buffer_load_dwordx4 a[184:187], v241, s[16:19], s63 offen offset:2048 sc1
    v_mfma_f32_16x16x32_bf16 v[32:35], v[200:203], a[144:147], v[32:35]
    v_lshrrev_b32 v244, 5, v243
    v_lshl_add_u32 v247, v244, 4, v247
    v_mfma_f32_16x16x32_bf16 v[36:39], v[196:199], a[132:135], v[36:39]
    v_add_u32 v228, v228, v247
    s_andn2_b32 s76, s76, 16
    v_mfma_f32_16x16x32_bf16 v[36:39], v[200:203], a[148:151], v[36:39]
    ds_read_b64_tr_b16 v[192:193], v222 offset:16384
    s_sub_u32 s81, s77, s76
    v_mfma_f32_16x16x32_bf16 v[40:43], v[196:199], a[136:139], v[40:43]
    ds_read_b64_tr_b16 v[194:195], v222 offset:16896
    v_add_u32 v245, s81, v245
    v_mfma_f32_16x16x32_bf16 v[40:43], v[200:203], a[152:155], v[40:43]
    buffer_load_dwordx4 a[188:191], v241, s[16:19], s63 offen offset:3072 sc1
    s_mov_b32 vcc_lo, -1
    s_mov_b32 vcc_hi, 0
    v_mfma_f32_16x16x32_bf16 v[44:47], v[196:199], a[140:143], v[44:47]
    v_cndmask_b32 v245, v245, v243, vcc
    v_lshlrev_b32 v253, 7, v245
    v_mfma_f32_16x16x32_bf16 v[44:47], v[200:203], a[156:159], v[44:47]
    ds_read_b64_tr_b16 v[196:197], v222 offset:17408
    s_waitcnt lgkmcnt(3)
    v_mfma_f32_16x16x32_bf16 v[48:51], v[204:207], a[128:131], v[48:51]
    ds_read_b64_tr_b16 v[198:199], v222 offset:17920
    s_mov_b32 s77, s82
    v_mfma_f32_16x16x32_bf16 v[48:51], v[208:211], a[144:147], v[48:51]
    s_lshl_b32 s14, s76, 7
    s_add_u32 s14, s14, 9895936
    v_mfma_f32_16x16x32_bf16 v[52:55], v[204:207], a[132:135], v[52:55]
    buffer_load_dwordx4 a[192:195], v240, s[16:19], s64 offen offset:0 sc1
    s_add_u32 s13, s13, 262144
    v_mfma_f32_16x16x32_bf16 v[52:55], v[208:211], a[148:151], v[52:55]
    ds_read_b64_tr_b16 v[200:201], v217 offset:0
    v_and_b32 v244, 7, v243
    v_mfma_f32_16x16x32_bf16 v[56:59], v[204:207], a[136:139], v[56:59]
    ds_read_b64_tr_b16 v[202:203], v217 offset:2048
    s_and_b32 s81, s2, 0xf8
    v_mfma_f32_16x16x32_bf16 v[56:59], v[208:211], a[152:155], v[56:59]
    v_add_u32 v244, s81, v244
    s_lshr_b32 s81, s33, 1
    v_mfma_f32_16x16x32_bf16 v[60:63], v[204:207], a[140:143], v[60:63]
    v_lshl_add_u32 v246, v244, 2, s81
    v_lshl_add_u32 v244, v244, 2, s32
    v_mfma_f32_16x16x32_bf16 v[60:63], v[208:211], a[156:159], v[60:63]
    ds_read_b64_tr_b16 v[204:205], v217 offset:4096
    s_waitcnt lgkmcnt(3)
    v_mfma_f32_16x16x32_bf16 v[44:47], v[192:195], v[172:175], v[44:47]
    ds_read_b64_tr_b16 v[206:207], v217 offset:6144
    buffer_load_dwordx4 a[196:199], v240, s[16:19], s64 offen offset:1024 sc1
    v_mfma_f32_16x16x32_bf16 v[44:47], v[196:199], v[188:191], v[44:47]
    s_mov_b64 vcc, 0xff00
    v_cndmask_b32 v244, v244, v246, vcc
    v_mfma_f32_16x16x32_bf16 v[40:43], v[192:195], v[168:171], v[40:43]
    v_lshlrev_b32 v247, 7, v244
    v_mfma_f32_16x16x32_bf16 v[40:43], v[196:199], v[184:187], v[40:43]
    ds_read_b64_tr_b16 v[208:209], v218 offset:0
    v_mfma_f32_16x16x32_bf16 v[36:39], v[192:195], v[164:167], v[36:39]
    ds_read_b64_tr_b16 v[210:211], v218 offset:2048
    v_mfma_f32_16x16x32_bf16 v[36:39], v[196:199], v[180:183], v[36:39]
    buffer_load_dwordx4 a[200:203], v240, s[16:19], s64 offen offset:2048 sc1
    v_mfma_f32_16x16x32_bf16 v[32:35], v[192:195], v[160:163], v[32:35]
    v_mfma_f32_16x16x32_bf16 v[32:35], v[196:199], v[176:179], v[32:35]
    ds_read_b64_tr_b16 v[192:193], v218 offset:4096
    s_waitcnt lgkmcnt(3)
    v_mfma_f32_16x16x32_bf16 v[60:63], v[200:203], v[172:175], v[60:63]
    ds_read_b64_tr_b16 v[194:195], v218 offset:6144
    v_mfma_f32_16x16x32_bf16 v[60:63], v[204:207], v[188:191], v[60:63]
    v_mfma_f32_16x16x32_bf16 v[56:59], v[200:203], v[168:171], v[56:59]
    buffer_load_dwordx4 a[204:207], v240, s[16:19], s64 offen offset:3072 sc1
    v_mfma_f32_16x16x32_bf16 v[56:59], v[204:207], v[184:187], v[56:59]
    ds_read_b64_tr_b16 v[196:197], v218 offset:8192
    v_mfma_f32_16x16x32_bf16 v[52:55], v[200:203], v[164:167], v[52:55]
    ds_read_b64_tr_b16 v[198:199], v218 offset:10240
    v_mfma_f32_16x16x32_bf16 v[52:55], v[204:207], v[180:183], v[52:55]
    v_mfma_f32_16x16x32_bf16 v[48:51], v[200:203], v[160:163], v[48:51]
    v_mfma_f32_16x16x32_bf16 v[48:51], v[204:207], v[176:179], v[48:51]
    ds_read_b64_tr_b16 v[200:201], v218 offset:12288
    s_waitcnt lgkmcnt(3)
    v_mfma_f32_16x16x32_bf16 v[64:67], v[208:211], a[0:3], 0
    ds_read_b64_tr_b16 v[202:203], v218 offset:14336
    buffer_load_dwordx4 a[208:211], v241, s[16:19], s64 offen offset:0 sc1
    v_mfma_f32_16x16x32_bf16 v[64:67], v[192:195], a[16:19], v[64:67]
    v_mfma_f32_16x16x32_bf16 v[68:71], v[208:211], a[4:7], 0
    v_mfma_f32_16x16x32_bf16 v[68:71], v[192:195], a[20:23], v[68:71]
    ds_read_b64_tr_b16 v[204:205], v218 offset:16384
    v_mfma_f32_16x16x32_bf16 v[72:75], v[208:211], a[8:11], 0
    ds_read_b64_tr_b16 v[206:207], v218 offset:18432
    s_waitcnt vmcnt(16)
    v_mfma_f32_16x16x32_bf16 v[72:75], v[192:195], a[24:27], v[72:75]
    buffer_store_dwordx4 v[248:251], v252, s[16:19], s50 offen sc1
    v_mfma_f32_16x16x32_bf16 v[76:79], v[208:211], a[12:15], 0
    v_mfma_f32_16x16x32_bf16 v[76:79], v[192:195], a[28:31], v[76:79]
    ds_read_b64_tr_b16 v[208:209], v218 offset:20480
    s_waitcnt lgkmcnt(3)
    v_mfma_f32_16x16x32_bf16 v[76:79], v[196:199], a[44:47], v[76:79]
    ds_read_b64_tr_b16 v[210:211], v218 offset:22528
    v_mfma_f32_16x16x32_bf16 v[76:79], v[200:203], a[60:63], v[76:79]
    buffer_load_dwordx4 a[212:215], v241, s[16:19], s64 offen offset:1024 sc1
    v_mfma_f32_16x16x32_bf16 v[72:75], v[196:199], a[40:43], v[72:75]
    v_mfma_f32_16x16x32_bf16 v[72:75], v[200:203], a[56:59], v[72:75]
    ds_read_b64_tr_b16 v[192:193], v218 offset:24576
    v_mfma_f32_16x16x32_bf16 v[68:71], v[196:199], a[36:39], v[68:71]
    ds_read_b64_tr_b16 v[194:195], v218 offset:26624
    v_mfma_f32_16x16x32_bf16 v[68:71], v[200:203], a[52:55], v[68:71]
    v_mfma_f32_16x16x32_bf16 v[64:67], v[196:199], a[32:35], v[64:67]
    buffer_load_dwordx4 a[216:219], v241, s[16:19], s64 offen offset:2048 sc1
    v_mfma_f32_16x16x32_bf16 v[64:67], v[200:203], a[48:51], v[64:67]
    ds_read_b64_tr_b16 v[196:197], v218 offset:28672
    s_waitcnt lgkmcnt(3)
    v_mfma_f32_16x16x32_bf16 v[64:67], v[204:207], a[64:67], v[64:67]
    ds_read_b64_tr_b16 v[198:199], v218 offset:30720
    v_mfma_f32_16x16x32_bf16 v[64:67], v[208:211], a[80:83], v[64:67]
    v_mfma_f32_16x16x32_bf16 v[68:71], v[204:207], a[68:71], v[68:71]
    v_mfma_f32_16x16x32_bf16 v[68:71], v[208:211], a[84:87], v[68:71]
    ds_read_b64_tr_b16 v[200:201], v218 offset:32768
    buffer_load_dwordx4 a[220:223], v241, s[16:19], s64 offen offset:3072 sc1
    v_mfma_f32_16x16x32_bf16 v[72:75], v[204:207], a[72:75], v[72:75]
    ds_read_b64_tr_b16 v[202:203], v218 offset:34816
    v_mfma_f32_16x16x32_bf16 v[72:75], v[208:211], a[88:91], v[72:75]
    v_mfma_f32_16x16x32_bf16 v[76:79], v[204:207], a[76:79], v[76:79]
    v_mfma_f32_16x16x32_bf16 v[76:79], v[208:211], a[92:95], v[76:79]
    ds_read_b64_tr_b16 v[204:205], v218 offset:36864
    s_waitcnt lgkmcnt(3)
    v_mfma_f32_16x16x32_bf16 v[76:79], v[192:195], a[108:111], v[76:79]
    ds_read_b64_tr_b16 v[206:207], v218 offset:38912
    buffer_load_dwordx4 a[224:227], v240, s[16:19], s65 offen offset:0 sc1
    v_mfma_f32_16x16x32_bf16 v[76:79], v[196:199], a[124:127], v[76:79]
    v_mfma_f32_16x16x32_bf16 v[72:75], v[192:195], a[104:107], v[72:75]
    v_mfma_f32_16x16x32_bf16 v[72:75], v[196:199], a[120:123], v[72:75]
    ds_read_b64_tr_b16 v[208:209], v219 offset:0
    v_mfma_f32_16x16x32_bf16 v[68:71], v[192:195], a[100:103], v[68:71]
    ds_read_b64_tr_b16 v[210:211], v219 offset:2048
    v_mfma_f32_16x16x32_bf16 v[68:71], v[196:199], a[116:119], v[68:71]
    buffer_load_dwordx4 a[228:231], v240, s[16:19], s65 offen offset:1024 sc1
    v_mfma_f32_16x16x32_bf16 v[64:67], v[192:195], a[96:99], v[64:67]
    v_mfma_f32_16x16x32_bf16 v[64:67], v[196:199], a[112:115], v[64:67]
    ds_read_b64_tr_b16 v[192:193], v219 offset:4096
    s_waitcnt lgkmcnt(3)
    v_mfma_f32_16x16x32_bf16 v[64:67], v[200:203], a[128:131], v[64:67]
    ds_read_b64_tr_b16 v[194:195], v219 offset:6144
    v_mfma_f32_16x16x32_bf16 v[64:67], v[204:207], a[144:147], v[64:67]
    v_mfma_f32_16x16x32_bf16 v[68:71], v[200:203], a[132:135], v[68:71]
    buffer_load_dwordx4 a[232:235], v240, s[16:19], s65 offen offset:2048 sc1
    v_mfma_f32_16x16x32_bf16 v[68:71], v[204:207], a[148:151], v[68:71]
    ds_read_b64_tr_b16 v[196:197], v220 offset:0
    v_mfma_f32_16x16x32_bf16 v[72:75], v[200:203], a[136:139], v[72:75]
    ds_read_b64_tr_b16 v[198:199], v220 offset:2048
    v_mfma_f32_16x16x32_bf16 v[72:75], v[204:207], a[152:155], v[72:75]
    v_mfma_f32_16x16x32_bf16 v[76:79], v[200:203], a[140:143], v[76:79]
    v_mfma_f32_16x16x32_bf16 v[76:79], v[204:207], a[156:159], v[76:79]
    ds_read_b64_tr_b16 v[200:201], v220 offset:4096
    s_waitcnt lgkmcnt(3)
    v_mfma_f32_16x16x32_bf16 v[76:79], v[208:211], v[172:175], v[76:79]
    ds_read_b64_tr_b16 v[202:203], v220 offset:6144
    buffer_load_dwordx4 a[236:239], v240, s[16:19], s65 offen offset:3072 sc1
    v_mfma_f32_16x16x32_bf16 v[76:79], v[192:195], v[188:191], v[76:79]
    v_mfma_f32_16x16x32_bf16 v[72:75], v[208:211], v[168:171], v[72:75]
    v_mfma_f32_16x16x32_bf16 v[72:75], v[192:195], v[184:187], v[72:75]
    ds_read_b64_tr_b16 v[204:205], v220 offset:8192
    v_mfma_f32_16x16x32_bf16 v[68:71], v[208:211], v[164:167], v[68:71]
    ds_read_b64_tr_b16 v[206:207], v220 offset:10240
    v_mfma_f32_16x16x32_bf16 v[68:71], v[192:195], v[180:183], v[68:71]
    buffer_load_dwordx4 a[240:243], v241, s[16:19], s65 offen offset:0 sc1
    v_mfma_f32_16x16x32_bf16 v[64:67], v[208:211], v[160:163], v[64:67]
    v_mfma_f32_16x16x32_bf16 v[64:67], v[192:195], v[176:179], v[64:67]
    ds_read_b64_tr_b16 v[208:209], v220 offset:12288
    s_waitcnt lgkmcnt(3)
    v_mfma_f32_16x16x32_bf16 v[96:99], v[196:199], a[0:3], 0
    ds_read_b64_tr_b16 v[210:211], v220 offset:14336
    v_mfma_f32_16x16x32_bf16 v[96:99], v[200:203], a[16:19], v[96:99]
    v_mfma_f32_16x16x32_bf16 v[100:103], v[196:199], a[4:7], 0
    buffer_load_dwordx4 a[244:247], v241, s[16:19], s65 offen offset:1024 sc1
    v_mfma_f32_16x16x32_bf16 v[100:103], v[200:203], a[20:23], v[100:103]
    ds_read_b64_tr_b16 v[192:193], v220 offset:16384
    v_mfma_f32_16x16x32_bf16 v[104:107], v[196:199], a[8:11], 0
    ds_read_b64_tr_b16 v[194:195], v220 offset:18432
    v_mfma_f32_16x16x32_bf16 v[104:107], v[200:203], a[24:27], v[104:107]
    v_mfma_f32_16x16x32_bf16 v[108:111], v[196:199], a[12:15], 0
    v_mfma_f32_16x16x32_bf16 v[108:111], v[200:203], a[28:31], v[108:111]
    ds_read_b64_tr_b16 v[196:197], v220 offset:20480
    s_waitcnt lgkmcnt(3)
    v_mfma_f32_16x16x32_bf16 v[108:111], v[204:207], a[44:47], v[108:111]
    ds_read_b64_tr_b16 v[198:199], v220 offset:22528
    buffer_load_dwordx4 a[248:251], v241, s[16:19], s65 offen offset:2048 sc1
    v_mfma_f32_16x16x32_bf16 v[108:111], v[208:211], a[60:63], v[108:111]
    v_mfma_f32_16x16x32_bf16 v[104:107], v[204:207], a[40:43], v[104:107]
    v_mfma_f32_16x16x32_bf16 v[104:107], v[208:211], a[56:59], v[104:107]
    ds_read_b64_tr_b16 v[200:201], v220 offset:24576
    v_mfma_f32_16x16x32_bf16 v[100:103], v[204:207], a[36:39], v[100:103]
    ds_read_b64_tr_b16 v[202:203], v220 offset:26624
    v_mfma_f32_16x16x32_bf16 v[100:103], v[208:211], a[52:55], v[100:103]
    buffer_load_dwordx4 a[252:255], v241, s[16:19], s65 offen offset:3072 sc1
    v_mfma_f32_16x16x32_bf16 v[96:99], v[204:207], a[32:35], v[96:99]
    v_mfma_f32_16x16x32_bf16 v[96:99], v[208:211], a[48:51], v[96:99]
    ds_read_b64_tr_b16 v[204:205], v220 offset:28672
    s_waitcnt lgkmcnt(3)
    v_mfma_f32_16x16x32_bf16 v[96:99], v[192:195], a[64:67], v[96:99]
    ds_read_b64_tr_b16 v[206:207], v220 offset:30720
    s_add_u32 m0, s38, 147456
    v_mfma_f32_16x16x32_bf16 v[96:99], v[196:199], a[80:83], v[96:99]
    buffer_load_dwordx4 v254, s[20:23], s74 offen lds
    v_mfma_f32_16x16x32_bf16 v[100:103], v[192:195], a[68:71], v[100:103]
    v_mfma_f32_16x16x32_bf16 v[100:103], v[196:199], a[84:87], v[100:103]
    ds_read_b64_tr_b16 v[208:209], v220 offset:32768
    v_mfma_f32_16x16x32_bf16 v[104:107], v[192:195], a[72:75], v[104:107]
    ds_read_b64_tr_b16 v[210:211], v220 offset:34816
    v_mfma_f32_16x16x32_bf16 v[104:107], v[196:199], a[88:91], v[104:107]
    s_add_u32 m0, s38, 143360
    v_mfma_f32_16x16x32_bf16 v[108:111], v[192:195], a[76:79], v[108:111]
    buffer_load_dwordx4 v255, s[20:23], s73 offen lds
    v_mfma_f32_16x16x32_bf16 v[108:111], v[196:199], a[92:95], v[108:111]
    ds_read_b64_tr_b16 v[192:193], v220 offset:36864
    s_waitcnt lgkmcnt(3)
    v_mfma_f32_16x16x32_bf16 v[108:111], v[200:203], a[108:111], v[108:111]
    ds_read_b64_tr_b16 v[194:195], v220 offset:38912
    v_mfma_f32_16x16x32_bf16 v[108:111], v[204:207], a[124:127], v[108:111]
    v_mfma_f32_16x16x32_bf16 v[104:107], v[200:203], a[104:107], v[104:107]
    s_add_u32 m0, s38, 139264
    v_mfma_f32_16x16x32_bf16 v[104:107], v[204:207], a[120:123], v[104:107]
    ds_read_b64_tr_b16 v[196:197], v221 offset:0
    buffer_load_dwordx4 v254, s[20:23], s73 offen lds
    v_mfma_f32_16x16x32_bf16 v[100:103], v[200:203], a[100:103], v[100:103]
    ds_read_b64_tr_b16 v[198:199], v221 offset:2048
    v_mfma_f32_16x16x32_bf16 v[100:103], v[204:207], a[116:119], v[100:103]
    v_mfma_f32_16x16x32_bf16 v[96:99], v[200:203], a[96:99], v[96:99]
    v_mfma_f32_16x16x32_bf16 v[96:99], v[204:207], a[112:115], v[96:99]
    ds_read_b64_tr_b16 v[200:201], v221 offset:4096
    s_waitcnt lgkmcnt(3)
    v_mfma_f32_16x16x32_bf16 v[96:99], v[208:211], a[128:131], v[96:99]
    ds_read_b64_tr_b16 v[202:203], v221 offset:6144
    s_add_u32 m0, s38, 135168
    v_mfma_f32_16x16x32_bf16 v[96:99], v[192:195], a[144:147], v[96:99]
    buffer_load_dwordx4 v255, s[20:23], s72 offen lds
    v_mfma_f32_16x16x32_bf16 v[100:103], v[208:211], a[132:135], v[100:103]
    v_mfma_f32_16x16x32_bf16 v[100:103], v[192:195], a[148:151], v[100:103]
    ds_read_b64_tr_b16 v[204:205], v222 offset:10240
    v_mfma_f32_16x16x32_bf16 v[104:107], v[208:211], a[136:139], v[104:107]
    ds_read_b64_tr_b16 v[206:207], v222 offset:10752
    v_mfma_f32_16x16x32_bf16 v[104:107], v[192:195], a[152:155], v[104:107]
    s_add_u32 m0, s38, 131072
    v_mfma_f32_16x16x32_bf16 v[108:111], v[208:211], a[140:143], v[108:111]
    buffer_load_dwordx4 v254, s[20:23], s72 offen lds
    v_mfma_f32_16x16x32_bf16 v[108:111], v[192:195], a[156:159], v[108:111]
    ds_read_b64_tr_b16 v[208:209], v222 offset:11264
    s_waitcnt lgkmcnt(3)
    v_mfma_f32_16x16x32_bf16 v[108:111], v[196:199], v[172:175], v[108:111]
    ds_read_b64_tr_b16 v[210:211], v222 offset:11776
    v_mfma_f32_16x16x32_bf16 v[108:111], v[200:203], v[188:191], v[108:111]
    s_barrier
    v_mfma_f32_16x16x32_bf16 v[104:107], v[196:199], v[168:171], v[104:107]
    s_add_u32 m0, s80, 126976
    v_mfma_f32_16x16x32_bf16 v[104:107], v[200:203], v[184:187], v[104:107]
    ds_read_b64_tr_b16 v[192:193], v216 offset:40960
    buffer_load_dwordx4 v255, s[20:23], s71 offen lds
    v_mfma_f32_16x16x32_bf16 v[100:103], v[196:199], v[164:167], v[100:103]
    ds_read_b64_tr_b16 v[194:195], v216 offset:43008
    v_mfma_f32_16x16x32_bf16 v[100:103], v[200:203], v[180:183], v[100:103]
    v_mfma_f32_16x16x32_bf16 v[96:99], v[196:199], v[160:163], v[96:99]
    v_mfma_f32_16x16x32_bf16 v[96:99], v[200:203], v[176:179], v[96:99]
    ds_read_b64_tr_b16 v[196:197], v216 offset:45056
    s_waitcnt vmcnt(23) lgkmcnt(3)
    v_mfma_f32_16x16x32_bf16 v[32:35], v[204:207], a[160:163], v[32:35]
    ds_read_b64_tr_b16 v[198:199], v216 offset:47104
    s_add_u32 m0, s80, 122880
    v_mfma_f32_16x16x32_bf16 v[32:35], v[208:211], a[176:179], v[32:35]
    buffer_load_dwordx4 v254, s[20:23], s71 offen lds
    v_mfma_f32_16x16x32_bf16 v[36:39], v[204:207], a[164:167], v[36:39]
    v_mfma_f32_16x16x32_bf16 v[36:39], v[208:211], a[180:183], v[36:39]
    ds_read_b64_tr_b16 v[200:201], v222 offset:12288
    v_mfma_f32_16x16x32_bf16 v[40:43], v[204:207], a[168:171], v[40:43]
    ds_read_b64_tr_b16 v[202:203], v222 offset:12800
    v_mfma_f32_16x16x32_bf16 v[40:43], v[208:211], a[184:187], v[40:43]
    s_add_u32 m0, s38, 118784
    v_mfma_f32_16x16x32_bf16 v[44:47], v[204:207], a[172:175], v[44:47]
    buffer_load_dwordx4 v255, s[20:23], s70 offen lds
    v_mfma_f32_16x16x32_bf16 v[44:47], v[208:211], a[188:191], v[44:47]
    ds_read_b64_tr_b16 v[204:205], v222 offset:13312
    s_waitcnt lgkmcnt(3)
    v_mfma_f32_16x16x32_bf16 v[48:51], v[192:195], a[160:163], v[48:51]
    ds_read_b64_tr_b16 v[206:207], v222 offset:13824
    v_mfma_f32_16x16x32_bf16 v[48:51], v[196:199], a[176:179], v[48:51]
    v_mfma_f32_16x16x32_bf16 v[52:55], v[192:195], a[164:167], v[52:55]
    s_add_u32 m0, s38, 114688
    v_mfma_f32_16x16x32_bf16 v[52:55], v[196:199], a[180:183], v[52:55]
    ds_read_b64_tr_b16 v[208:209], v216 offset:49152
    buffer_load_dwordx4 v254, s[20:23], s70 offen lds
    v_mfma_f32_16x16x32_bf16 v[56:59], v[192:195], a[168:171], v[56:59]
    ds_read_b64_tr_b16 v[210:211], v216 offset:51200
    v_mfma_f32_16x16x32_bf16 v[56:59], v[196:199], a[184:187], v[56:59]
    v_mfma_f32_16x16x32_bf16 v[60:63], v[192:195], a[172:175], v[60:63]
    v_mfma_f32_16x16x32_bf16 v[60:63], v[196:199], a[188:191], v[60:63]
    ds_read_b64_tr_b16 v[192:193], v216 offset:53248
    s_waitcnt vmcnt(17) lgkmcnt(3)
    v_mfma_f32_16x16x32_bf16 v[44:47], v[200:203], a[204:207], v[44:47]
    ds_read_b64_tr_b16 v[194:195], v216 offset:55296
    s_add_u32 m0, s38, 110592
    v_mfma_f32_16x16x32_bf16 v[44:47], v[204:207], a[220:223], v[44:47]
    buffer_load_dwordx4 v255, s[20:23], s69 offen lds
    v_mfma_f32_16x16x32_bf16 v[40:43], v[200:203], a[200:203], v[40:43]
    v_mfma_f32_16x16x32_bf16 v[40:43], v[204:207], a[216:219], v[40:43]
    ds_read_b64_tr_b16 v[196:197], v222 offset:14336
    v_mfma_f32_16x16x32_bf16 v[36:39], v[200:203], a[196:199], v[36:39]
    ds_read_b64_tr_b16 v[198:199], v222 offset:14848
    v_mfma_f32_16x16x32_bf16 v[36:39], v[204:207], a[212:215], v[36:39]
    s_add_u32 m0, s38, 106496
    v_mfma_f32_16x16x32_bf16 v[32:35], v[200:203], a[192:195], v[32:35]
    buffer_load_dwordx4 v254, s[20:23], s69 offen lds
    v_mfma_f32_16x16x32_bf16 v[32:35], v[204:207], a[208:211], v[32:35]
    ds_read_b64_tr_b16 v[200:201], v222 offset:15360
    s_waitcnt lgkmcnt(3)
    v_mfma_f32_16x16x32_bf16 v[60:63], v[208:211], a[204:207], v[60:63]
    ds_read_b64_tr_b16 v[202:203], v222 offset:15872
    v_mfma_f32_16x16x32_bf16 v[60:63], v[192:195], a[220:223], v[60:63]
    v_mfma_f32_16x16x32_bf16 v[56:59], v[208:211], a[200:203], v[56:59]
    s_add_u32 m0, s38, 102400
    v_mfma_f32_16x16x32_bf16 v[56:59], v[192:195], a[216:219], v[56:59]
    ds_read_b64_tr_b16 v[204:205], v216 offset:57344
    buffer_load_dwordx4 v255, s[20:23], s68 offen lds
    v_mfma_f32_16x16x32_bf16 v[52:55], v[208:211], a[196:199], v[52:55]
    ds_read_b64_tr_b16 v[206:207], v216 offset:59392
    v_mfma_f32_16x16x32_bf16 v[52:55], v[192:195], a[212:215], v[52:55]
    v_mfma_f32_16x16x32_bf16 v[48:51], v[208:211], a[192:195], v[48:51]
    v_mfma_f32_16x16x32_bf16 v[48:51], v[192:195], a[208:211], v[48:51]
    ds_read_b64_tr_b16 v[208:209], v216 offset:61440
    s_waitcnt vmcnt(12) lgkmcnt(3)
    v_mfma_f32_16x16x32_bf16 v[32:35], v[196:199], a[224:227], v[32:35]
    ds_read_b64_tr_b16 v[210:211], v216 offset:63488
    s_add_u32 m0, s38, 98304
    v_mfma_f32_16x16x32_bf16 v[32:35], v[200:203], a[240:243], v[32:35]
    buffer_load_dwordx4 v254, s[20:23], s68 offen lds
    v_mfma_f32_16x16x32_bf16 v[36:39], v[196:199], a[228:231], v[36:39]
    v_mfma_f32_16x16x32_bf16 v[36:39], v[200:203], a[244:247], v[36:39]
    ds_read_b64_tr_b16 v[192:193], v218 offset:40960
    v_mfma_f32_16x16x32_bf16 v[40:43], v[196:199], a[232:235], v[40:43]
    ds_read_b64_tr_b16 v[194:195], v218 offset:43008
    v_mfma_f32_16x16x32_bf16 v[40:43], v[200:203], a[248:251], v[40:43]
    s_add_u32 m0, s38, 94208
    v_mfma_f32_16x16x32_bf16 v[44:47], v[196:199], a[236:239], v[44:47]
    buffer_load_dwordx4 v255, s[20:23], s67 offen lds
    v_mfma_f32_16x16x32_bf16 v[44:47], v[200:203], a[252:255], v[44:47]
    ds_read_b64_tr_b16 v[196:197], v218 offset:45056
    s_waitcnt lgkmcnt(3)
    v_mfma_f32_16x16x32_bf16 v[48:51], v[204:207], a[224:227], v[48:51]
    ds_read_b64_tr_b16 v[198:199], v218 offset:47104
    v_mfma_f32_16x16x32_bf16 v[48:51], v[208:211], a[240:243], v[48:51]
    v_mfma_f32_16x16x32_bf16 v[52:55], v[204:207], a[228:231], v[52:55]
    s_add_u32 m0, s38, 90112
    v_mfma_f32_16x16x32_bf16 v[52:55], v[208:211], a[244:247], v[52:55]
    ds_read_b64_tr_b16 v[200:201], v218 offset:49152
    buffer_load_dwordx4 v254, s[20:23], s67 offen lds
    v_mfma_f32_16x16x32_bf16 v[56:59], v[204:207], a[232:235], v[56:59]
    ds_read_b64_tr_b16 v[202:203], v218 offset:51200
    v_mfma_f32_16x16x32_bf16 v[56:59], v[208:211], a[248:251], v[56:59]
    v_mfma_f32_16x16x32_bf16 v[60:63], v[204:207], a[236:239], v[60:63]
    v_mfma_f32_16x16x32_bf16 v[60:63], v[208:211], a[252:255], v[60:63]
    ds_read_b64_tr_b16 v[204:205], v218 offset:53248
    s_waitcnt lgkmcnt(3)
    v_mfma_f32_16x16x32_bf16 v[64:67], v[192:195], a[160:163], v[64:67]
    ds_read_b64_tr_b16 v[206:207], v218 offset:55296
    v_xor_b32 v216, 96, v216
    v_mfma_f32_16x16x32_bf16 v[64:67], v[196:199], a[176:179], v[64:67]
    v_add_u32 v217, 65536, v216
    s_xor_b32 s82, s101, 65536
    v_mfma_f32_16x16x32_bf16 v[68:71], v[192:195], a[164:167], v[68:71]
    v_cvt_pk_bf16_f32 v80, v32, v33
    v_cvt_pk_bf16_f32 v81, v34, v35
    v_mfma_f32_16x16x32_bf16 v[68:71], v[196:199], a[180:183], v[68:71]
    ds_read_b64_tr_b16 v[208:209], v218 offset:57344
    v_cvt_pk_bf16_f32 v82, v36, v37
    v_mfma_f32_16x16x32_bf16 v[72:75], v[192:195], a[168:171], v[72:75]
    ds_read_b64_tr_b16 v[210:211], v218 offset:59392
    v_cvt_pk_bf16_f32 v83, v38, v39
    v_mfma_f32_16x16x32_bf16 v[72:75], v[196:199], a[184:187], v[72:75]
    buffer_store_dwordx4 v[80:83], v240, s[16:19], s101 offen offset:0 sc1
    v_cvt_pk_bf16_f32 v84, v40, v41
    v_mfma_f32_16x16x32_bf16 v[76:79], v[192:195], a[172:175], v[76:79]
    v_cvt_pk_bf16_f32 v85, v42, v43
    v_cvt_pk_bf16_f32 v86, v44, v45
    v_mfma_f32_16x16x32_bf16 v[76:79], v[196:199], a[188:191], v[76:79]
    ds_read_b64_tr_b16 v[192:193], v218 offset:61440
    s_waitcnt lgkmcnt(3)
    v_mfma_f32_16x16x32_bf16 v[76:79], v[200:203], a[204:207], v[76:79]
    ds_read_b64_tr_b16 v[194:195], v218 offset:63488
    v_cvt_pk_bf16_f32 v87, v46, v47
    v_mfma_f32_16x16x32_bf16 v[76:79], v[204:207], a[220:223], v[76:79]
    buffer_store_dwordx4 v[84:87], v240, s[16:19], s82 offen offset:0 sc1
    v_mfma_f32_16x16x32_bf16 v[72:75], v[200:203], a[200:203], v[72:75]
    s_xor_b32 s82, s100, 516096
    v_cvt_pk_bf16_f32 v88, v48, v49
    v_mfma_f32_16x16x32_bf16 v[72:75], v[204:207], a[216:219], v[72:75]
    ds_read_b64_tr_b16 v[196:197], v220 offset:40960
    v_cvt_pk_bf16_f32 v89, v50, v51
    v_mfma_f32_16x16x32_bf16 v[68:71], v[200:203], a[196:199], v[68:71]
    ds_read_b64_tr_b16 v[198:199], v220 offset:43008
    v_cvt_pk_bf16_f32 v90, v52, v53
    v_mfma_f32_16x16x32_bf16 v[68:71], v[204:207], a[212:215], v[68:71]
    v_cvt_pk_bf16_f32 v91, v54, v55
    buffer_store_dwordx4 v[88:91], v240, s[16:19], s82 offen offset:0 sc1
    v_mfma_f32_16x16x32_bf16 v[64:67], v[200:203], a[192:195], v[64:67]
    v_cvt_pk_bf16_f32 v92, v56, v57
    v_cvt_pk_bf16_f32 v93, v58, v59
    v_mfma_f32_16x16x32_bf16 v[64:67], v[204:207], a[208:211], v[64:67]
    ds_read_b64_tr_b16 v[200:201], v220 offset:45056
    s_waitcnt lgkmcnt(3)
    v_mfma_f32_16x16x32_bf16 v[64:67], v[208:211], a[224:227], v[64:67]
    ds_read_b64_tr_b16 v[202:203], v220 offset:47104
    v_cvt_pk_bf16_f32 v94, v60, v61
    v_mfma_f32_16x16x32_bf16 v[64:67], v[192:195], a[240:243], v[64:67]
    v_cvt_pk_bf16_f32 v95, v62, v63
    buffer_store_dwordx4 v[92:95], v240, s[16:19], s82 offen offset:1024 sc1
    v_mfma_f32_16x16x32_bf16 v[68:71], v[208:211], a[228:231], v[68:71]
    v_mfma_f32_16x16x32_bf16 v[68:71], v[192:195], a[244:247], v[68:71]
    ds_read_b64_tr_b16 v[204:205], v220 offset:49152
    v_mfma_f32_16x16x32_bf16 v[72:75], v[208:211], a[232:235], v[72:75]
    ds_read_b64_tr_b16 v[206:207], v220 offset:51200
    v_mfma_f32_16x16x32_bf16 v[72:75], v[192:195], a[248:251], v[72:75]
    v_mfma_f32_16x16x32_bf16 v[76:79], v[208:211], a[236:239], v[76:79]
    v_mfma_f32_16x16x32_bf16 v[76:79], v[192:195], a[252:255], v[76:79]
    ds_read_b64_tr_b16 v[208:209], v220 offset:53248
    s_waitcnt lgkmcnt(3)
    v_mfma_f32_16x16x32_bf16 v[96:99], v[196:199], a[160:163], v[96:99]
    ds_read_b64_tr_b16 v[210:211], v220 offset:55296
    v_xor_b32 v218, 32, v218
    v_mfma_f32_16x16x32_bf16 v[96:99], v[200:203], a[176:179], v[96:99]
    v_add_u32 v218, 90112, v218
    v_add_u32 v219, 65536, v218
    v_mfma_f32_16x16x32_bf16 v[100:103], v[196:199], a[164:167], v[100:103]
    v_mfma_f32_16x16x32_bf16 v[100:103], v[200:203], a[180:183], v[100:103]
    ds_read_b64_tr_b16 v[192:193], v220 offset:57344
    v_mfma_f32_16x16x32_bf16 v[104:107], v[196:199], a[168:171], v[104:107]
    ds_read_b64_tr_b16 v[194:195], v220 offset:59392
    s_xor_b32 s82, s100, 442368
    v_mfma_f32_16x16x32_bf16 v[104:107], v[200:203], a[184:187], v[104:107]
    v_cvt_pk_bf16_f32 v80, v68, v69
    v_cvt_pk_bf16_f32 v81, v70, v71
    v_mfma_f32_16x16x32_bf16 v[108:111], v[196:199], a[172:175], v[108:111]
    v_cvt_pk_bf16_f32 v82, v64, v65
    v_cvt_pk_bf16_f32 v83, v66, v67
    v_mfma_f32_16x16x32_bf16 v[108:111], v[200:203], a[188:191], v[108:111]
    ds_read_b64_tr_b16 v[196:197], v220 offset:61440
    s_waitcnt lgkmcnt(3)
    v_mfma_f32_16x16x32_bf16 v[108:111], v[204:207], a[204:207], v[108:111]
    ds_read_b64_tr_b16 v[198:199], v220 offset:63488
    buffer_store_dwordx4 v[80:83], v240, s[16:19], s82 offen offset:0 sc1
    v_mfma_f32_16x16x32_bf16 v[108:111], v[208:211], a[220:223], v[108:111]
    v_cvt_pk_bf16_f32 v84, v76, v77
    v_cvt_pk_bf16_f32 v85, v78, v79
    v_mfma_f32_16x16x32_bf16 v[104:107], v[204:207], a[200:203], v[104:107]
    v_cvt_pk_bf16_f32 v86, v72, v73
    v_cvt_pk_bf16_f32 v87, v74, v75
    v_mfma_f32_16x16x32_bf16 v[104:107], v[208:211], a[216:219], v[104:107]
    ds_read_b64_tr_b16 v[200:201], v216 offset:0
    v_mfma_f32_16x16x32_bf16 v[100:103], v[204:207], a[196:199], v[100:103]
    ds_read_b64_tr_b16 v[202:203], v216 offset:2048
    buffer_store_dwordx4 v[84:87], v240, s[16:19], s82 offen offset:1024 sc1
    v_mfma_f32_16x16x32_bf16 v[100:103], v[208:211], a[212:215], v[100:103]
    v_mfma_f32_16x16x32_bf16 v[96:99], v[204:207], a[192:195], v[96:99]
    v_mfma_f32_16x16x32_bf16 v[96:99], v[208:211], a[208:211], v[96:99]
    ds_read_b64_tr_b16 v[204:205], v216 offset:4096
    s_waitcnt lgkmcnt(3)
    v_mfma_f32_16x16x32_bf16 v[96:99], v[192:195], a[224:227], v[96:99]
    ds_read_b64_tr_b16 v[206:207], v216 offset:6144
    v_mfma_f32_16x16x32_bf16 v[96:99], v[196:199], a[240:243], v[96:99]
    v_mfma_f32_16x16x32_bf16 v[100:103], v[192:195], a[228:231], v[100:103]
    v_mfma_f32_16x16x32_bf16 v[100:103], v[196:199], a[244:247], v[100:103]
    ds_read_b64_tr_b16 v[208:209], v216 offset:8192
    v_mfma_f32_16x16x32_bf16 v[104:107], v[192:195], a[232:235], v[104:107]
    ds_read_b64_tr_b16 v[210:211], v216 offset:10240
    v_mfma_f32_16x16x32_bf16 v[104:107], v[196:199], a[248:251], v[104:107]
    v_mfma_f32_16x16x32_bf16 v[108:111], v[192:195], a[236:239], v[108:111]
    v_mfma_f32_16x16x32_bf16 v[108:111], v[196:199], a[252:255], v[108:111]
    ds_read_b64_tr_b16 v[192:193], v216 offset:12288
    s_waitcnt lgkmcnt(3)
    v_mfma_f32_16x16x32_bf16 v[32:35], v[200:203], a[0:3], 0
    ds_read_b64_tr_b16 v[194:195], v216 offset:14336
    v_xor_b32 v220, 96, v220
    v_mfma_f32_16x16x32_bf16 v[32:35], v[204:207], a[16:19], v[32:35]
    v_add_u32 v220, 90112, v220
    v_add_u32 v221, 65536, v220
    v_mfma_f32_16x16x32_bf16 v[36:39], v[200:203], a[4:7], 0
    v_mfma_f32_16x16x32_bf16 v[36:39], v[204:207], a[20:23], v[36:39]
    ds_read_b64_tr_b16 v[196:197], v216 offset:16384
    v_mfma_f32_16x16x32_bf16 v[40:43], v[200:203], a[8:11], 0
    ds_read_b64_tr_b16 v[198:199], v216 offset:18432
    s_xor_b32 s82, s100, 368640
    v_mfma_f32_16x16x32_bf16 v[40:43], v[204:207], a[24:27], v[40:43]
    v_cvt_pk_bf16_f32 v88, v96, v97
    v_cvt_pk_bf16_f32 v89, v98, v99
    v_mfma_f32_16x16x32_bf16 v[44:47], v[200:203], a[12:15], 0
    v_cvt_pk_bf16_f32 v90, v100, v101
    v_cvt_pk_bf16_f32 v91, v102, v103
    v_mfma_f32_16x16x32_bf16 v[44:47], v[204:207], a[28:31], v[44:47]
    ds_read_b64_tr_b16 v[200:201], v216 offset:20480
    s_waitcnt lgkmcnt(3)
    v_mfma_f32_16x16x32_bf16 v[44:47], v[208:211], a[44:47], v[44:47]
    ds_read_b64_tr_b16 v[202:203], v216 offset:22528
    buffer_store_dwordx4 v[88:91], v240, s[16:19], s82 offen offset:0 sc1
    v_mfma_f32_16x16x32_bf16 v[44:47], v[192:195], a[60:63], v[44:47]
    v_cvt_pk_bf16_f32 v92, v104, v105
    v_cvt_pk_bf16_f32 v93, v106, v107
    v_mfma_f32_16x16x32_bf16 v[40:43], v[208:211], a[40:43], v[40:43]
    v_cvt_pk_bf16_f32 v94, v108, v109
    v_cvt_pk_bf16_f32 v95, v110, v111
    v_mfma_f32_16x16x32_bf16 v[40:43], v[192:195], a[56:59], v[40:43]
    ds_read_b64_tr_b16 v[204:205], v216 offset:24576
    v_mfma_f32_16x16x32_bf16 v[36:39], v[208:211], a[36:39], v[36:39]
    ds_read_b64_tr_b16 v[206:207], v216 offset:26624
    buffer_store_dwordx4 v[92:95], v240, s[16:19], s82 offen offset:1024 sc1
    v_mfma_f32_16x16x32_bf16 v[36:39], v[192:195], a[52:55], v[36:39]
    v_mfma_f32_16x16x32_bf16 v[32:35], v[208:211], a[32:35], v[32:35]
    v_mfma_f32_16x16x32_bf16 v[32:35], v[192:195], a[48:51], v[32:35]
    ds_read_b64_tr_b16 v[208:209], v216 offset:28672
    s_waitcnt lgkmcnt(3)
    v_mfma_f32_16x16x32_bf16 v[32:35], v[196:199], a[64:67], v[32:35]
    ds_read_b64_tr_b16 v[210:211], v216 offset:30720
    v_mfma_f32_16x16x32_bf16 v[32:35], v[200:203], a[80:83], v[32:35]
    v_mfma_f32_16x16x32_bf16 v[36:39], v[196:199], a[68:71], v[36:39]
    v_mfma_f32_16x16x32_bf16 v[36:39], v[200:203], a[84:87], v[36:39]
    ds_read_b64_tr_b16 v[192:193], v216 offset:32768
    v_mfma_f32_16x16x32_bf16 v[40:43], v[196:199], a[72:75], v[40:43]
    ds_read_b64_tr_b16 v[194:195], v216 offset:34816
    v_mfma_f32_16x16x32_bf16 v[40:43], v[200:203], a[88:91], v[40:43]
    v_mfma_f32_16x16x32_bf16 v[44:47], v[196:199], a[76:79], v[44:47]
    v_mfma_f32_16x16x32_bf16 v[44:47], v[200:203], a[92:95], v[44:47]
    ds_read_b64_tr_b16 v[196:197], v216 offset:36864
    s_waitcnt lgkmcnt(3)
    v_mfma_f32_16x16x32_bf16 v[44:47], v[204:207], a[108:111], v[44:47]
    ds_read_b64_tr_b16 v[198:199], v216 offset:38912
    buffer_load_dwordx2 v[250:251], v253, s[16:19], s14 offen sc1
    v_mfma_f32_16x16x32_bf16 v[44:47], v[208:211], a[124:127], v[44:47]
    v_mfma_f32_16x16x32_bf16 v[40:43], v[204:207], a[104:107], v[40:43]
    v_mfma_f32_16x16x32_bf16 v[40:43], v[208:211], a[120:123], v[40:43]
    ds_read_b64_tr_b16 v[200:201], v216 offset:40960
    v_mfma_f32_16x16x32_bf16 v[36:39], v[204:207], a[100:103], v[36:39]
    ds_read_b64_tr_b16 v[202:203], v216 offset:43008
    v_mfma_f32_16x16x32_bf16 v[36:39], v[208:211], a[116:119], v[36:39]
    v_mfma_f32_16x16x32_bf16 v[32:35], v[204:207], a[96:99], v[32:35]
    v_mfma_f32_16x16x32_bf16 v[32:35], v[208:211], a[112:115], v[32:35]
    ds_read_b64_tr_b16 v[204:205], v216 offset:45056
    s_waitcnt lgkmcnt(3)
    v_mfma_f32_16x16x32_bf16 v[32:35], v[192:195], a[128:131], v[32:35]
    ds_read_b64_tr_b16 v[206:207], v216 offset:47104
    v_mfma_f32_16x16x32_bf16 v[32:35], v[196:199], a[144:147], v[32:35]
    v_mfma_f32_16x16x32_bf16 v[36:39], v[192:195], a[132:135], v[36:39]
    v_mfma_f32_16x16x32_bf16 v[36:39], v[196:199], a[148:151], v[36:39]
    ds_read_b64_tr_b16 v[208:209], v216 offset:49152
    v_mfma_f32_16x16x32_bf16 v[40:43], v[192:195], a[136:139], v[40:43]
    ds_read_b64_tr_b16 v[210:211], v216 offset:51200
    v_mfma_f32_16x16x32_bf16 v[40:43], v[196:199], a[152:155], v[40:43]
    v_mfma_f32_16x16x32_bf16 v[44:47], v[192:195], a[140:143], v[44:47]
    v_mfma_f32_16x16x32_bf16 v[44:47], v[196:199], a[156:159], v[44:47]
    ds_read_b64_tr_b16 v[192:193], v216 offset:53248
    s_waitcnt lgkmcnt(3)
    v_mfma_f32_16x16x32_bf16 v[44:47], v[200:203], a[172:175], v[44:47]
    ds_read_b64_tr_b16 v[194:195], v216 offset:55296
    v_mfma_f32_16x16x32_bf16 v[44:47], v[204:207], a[188:191], v[44:47]
    v_mfma_f32_16x16x32_bf16 v[40:43], v[200:203], a[168:171], v[40:43]
    v_mfma_f32_16x16x32_bf16 v[40:43], v[204:207], a[184:187], v[40:43]
    ds_read_b64_tr_b16 v[196:197], v216 offset:57344
    v_mfma_f32_16x16x32_bf16 v[36:39], v[200:203], a[164:167], v[36:39]
    ds_read_b64_tr_b16 v[198:199], v216 offset:59392
    v_mfma_f32_16x16x32_bf16 v[36:39], v[204:207], a[180:183], v[36:39]
    v_mfma_f32_16x16x32_bf16 v[32:35], v[200:203], a[160:163], v[32:35]
    v_mfma_f32_16x16x32_bf16 v[32:35], v[204:207], a[176:179], v[32:35]
    ds_read_b64_tr_b16 v[200:201], v216 offset:61440
    s_waitcnt lgkmcnt(3)
    v_mfma_f32_16x16x32_bf16 v[32:35], v[208:211], a[192:195], v[32:35]
    ds_read_b64_tr_b16 v[202:203], v216 offset:63488
    v_mfma_f32_16x16x32_bf16 v[32:35], v[192:195], a[208:211], v[32:35]
    v_mfma_f32_16x16x32_bf16 v[36:39], v[208:211], a[196:199], v[36:39]
    v_mfma_f32_16x16x32_bf16 v[36:39], v[192:195], a[212:215], v[36:39]
    ds_read_b64_tr_b16 v[204:205], v217 offset:0
    v_mfma_f32_16x16x32_bf16 v[40:43], v[208:211], a[200:203], v[40:43]
    ds_read_b64_tr_b16 v[206:207], v217 offset:2048
    v_mfma_f32_16x16x32_bf16 v[40:43], v[192:195], a[216:219], v[40:43]
    v_mfma_f32_16x16x32_bf16 v[44:47], v[208:211], a[204:207], v[44:47]
    v_mfma_f32_16x16x32_bf16 v[44:47], v[192:195], a[220:223], v[44:47]
    ds_read_b64_tr_b16 v[208:209], v217 offset:4096
    s_waitcnt lgkmcnt(3)
    v_mfma_f32_16x16x32_bf16 v[44:47], v[196:199], a[236:239], v[44:47]
    ds_read_b64_tr_b16 v[210:211], v217 offset:6144
    v_mfma_f32_16x16x32_bf16 v[44:47], v[200:203], a[252:255], v[44:47]
    v_mfma_f32_16x16x32_bf16 v[40:43], v[196:199], a[232:235], v[40:43]
    s_waitcnt vmcnt(9)
    s_barrier
    v_mfma_f32_16x16x32_bf16 v[40:43], v[200:203], a[248:251], v[40:43]
    ds_read_b64_tr_b16 v[192:193], v218 offset:0
    v_mfma_f32_16x16x32_bf16 v[36:39], v[196:199], a[228:231], v[36:39]
    ds_read_b64_tr_b16 v[194:195], v218 offset:2048
    v_mfma_f32_16x16x32_bf16 v[36:39], v[200:203], a[244:247], v[36:39]
    v_mfma_f32_16x16x32_bf16 v[32:35], v[196:199], a[224:227], v[32:35]
    v_mfma_f32_16x16x32_bf16 v[32:35], v[200:203], a[240:243], v[32:35]
    ds_read_b64_tr_b16 v[196:197], v218 offset:4096
    s_waitcnt lgkmcnt(3)
    v_mfma_f32_16x16x32_bf16 v[32:35], v[204:207], v[160:163], v[32:35]
    ds_read_b64_tr_b16 v[198:199], v218 offset:6144
    v_mfma_f32_16x16x32_bf16 v[32:35], v[208:211], v[176:179], v[32:35]
    v_mfma_f32_16x16x32_bf16 v[36:39], v[204:207], v[164:167], v[36:39]
    v_mfma_f32_16x16x32_bf16 v[36:39], v[208:211], v[180:183], v[36:39]
    ds_read_b64_tr_b16 v[200:201], v218 offset:8192
    v_mfma_f32_16x16x32_bf16 v[40:43], v[204:207], v[168:171], v[40:43]
    ds_read_b64_tr_b16 v[202:203], v218 offset:10240
    v_mfma_f32_16x16x32_bf16 v[40:43], v[208:211], v[184:187], v[40:43]
    v_mfma_f32_16x16x32_bf16 v[44:47], v[204:207], v[172:175], v[44:47]
    v_mfma_f32_16x16x32_bf16 v[44:47], v[208:211], v[188:191], v[44:47]
    ds_read_b64_tr_b16 v[204:205], v218 offset:12288
    s_waitcnt lgkmcnt(3)
    v_mfma_f32_16x16x32_bf16 v[48:51], v[192:195], a[0:3], 0
    ds_read_b64_tr_b16 v[206:207], v218 offset:14336
    v_xor_b32 v216, 32, v216
    v_mfma_f32_16x16x32_bf16 v[48:51], v[196:199], a[16:19], v[48:51]
    v_add_u32 v216, 90112, v216
    v_add_u32 v217, 65536, v216
    v_mfma_f32_16x16x32_bf16 v[52:55], v[192:195], a[4:7], 0
    v_mfma_f32_16x16x32_bf16 v[52:55], v[196:199], a[20:23], v[52:55]
    ds_read_b64_tr_b16 v[208:209], v218 offset:16384
    v_mfma_f32_16x16x32_bf16 v[56:59], v[192:195], a[8:11], 0
    ds_read_b64_tr_b16 v[210:211], v218 offset:18432
    s_xor_b32 s82, s100, 294912
    v_mfma_f32_16x16x32_bf16 v[56:59], v[196:199], a[24:27], v[56:59]
    v_cvt_pk_bf16_f32 v80, v36, v37
    v_cvt_pk_bf16_f32 v81, v38, v39
    v_mfma_f32_16x16x32_bf16 v[60:63], v[192:195], a[12:15], 0
    v_cvt_pk_bf16_f32 v82, v32, v33
    v_cvt_pk_bf16_f32 v83, v34, v35
    v_mfma_f32_16x16x32_bf16 v[60:63], v[196:199], a[28:31], v[60:63]
    ds_read_b64_tr_b16 v[192:193], v218 offset:20480
    s_waitcnt lgkmcnt(3)
    v_mfma_f32_16x16x32_bf16 v[60:63], v[200:203], a[44:47], v[60:63]
    ds_read_b64_tr_b16 v[194:195], v218 offset:22528
    v_min_u32 v80, -2, v80
    v_mfma_f32_16x16x32_bf16 v[60:63], v[204:207], a[60:63], v[60:63]
    buffer_store_dwordx4 v[80:83], v240, s[16:19], s82 offen offset:0 sc1
    v_cvt_pk_bf16_f32 v84, v44, v45
    v_mfma_f32_16x16x32_bf16 v[56:59], v[200:203], a[40:43], v[56:59]
    v_cvt_pk_bf16_f32 v85, v46, v47
    v_cvt_pk_bf16_f32 v86, v40, v41
    v_mfma_f32_16x16x32_bf16 v[56:59], v[204:207], a[56:59], v[56:59]
    ds_read_b64_tr_b16 v[196:197], v218 offset:24576
    v_cvt_pk_bf16_f32 v87, v42, v43
    v_mfma_f32_16x16x32_bf16 v[52:55], v[200:203], a[36:39], v[52:55]
    ds_read_b64_tr_b16 v[198:199], v218 offset:26624
    v_min_u32 v84, -2, v84
    v_mfma_f32_16x16x32_bf16 v[52:55], v[204:207], a[52:55], v[52:55]
    buffer_store_dwordx4 v[84:87], v240, s[16:19], s82 offen offset:1024 sc1
    s_waitcnt vmcnt(3)
    v_mfma_f32_16x16x32_bf16 v[48:51], v[200:203], a[32:35], v[48:51]
    v_mfma_f32_16x16x32_bf16 v[48:51], v[204:207], a[48:51], v[48:51]
    ds_read_b64_tr_b16 v[200:201], v218 offset:28672
    s_waitcnt lgkmcnt(3)
    v_mfma_f32_16x16x32_bf16 v[48:51], v[208:211], a[64:67], v[48:51]
    ds_read_b64_tr_b16 v[202:203], v218 offset:30720
    s_waitcnt vmcnt(2)
    v_mfma_f32_16x16x32_bf16 v[48:51], v[192:195], a[80:83], v[48:51]
    v_cmp_ne_u64 vcc, v[250:251], v[248:249]
    s_cbranch_vccnz L_slow_18
L_back_19:
    v_mfma_f32_16x16x32_bf16 v[52:55], v[208:211], a[68:71], v[52:55]
    v_mov_b32 v253, v247
    s_mov_b32 s14, 10027008
    v_mfma_f32_16x16x32_bf16 v[52:55], v[192:195], a[84:87], v[52:55]
    ds_read_b64_tr_b16 v[204:205], v218 offset:32768
    buffer_store_dwordx4 v[248:251], v252, s[16:19], s13 offen sc1
    v_mfma_f32_16x16x32_bf16 v[56:59], v[208:211], a[72:75], v[56:59]
    ds_read_b64_tr_b16 v[206:207], v218 offset:34816
    v_mfma_f32_16x16x32_bf16 v[56:59], v[192:195], a[88:91], v[56:59]
    v_mfma_f32_16x16x32_bf16 v[60:63], v[208:211], a[76:79], v[60:63]
    v_mfma_f32_16x16x32_bf16 v[60:63], v[192:195], a[92:95], v[60:63]
    ds_read_b64_tr_b16 v[208:209], v218 offset:36864
    s_waitcnt lgkmcnt(3)
    v_mfma_f32_16x16x32_bf16 v[60:63], v[196:199], a[108:111], v[60:63]
    ds_read_b64_tr_b16 v[210:211], v218 offset:38912
    s_mov_b32 m0, s12
    v_mfma_f32_16x16x32_bf16 v[60:63], v[200:203], a[124:127], v[60:63]
    buffer_load_dwordx4 v229, s[16:19], s40 offen sc1 lds
    v_mfma_f32_16x16x32_bf16 v[56:59], v[196:199], a[104:107], v[56:59]
    v_mfma_f32_16x16x32_bf16 v[56:59], v[200:203], a[120:123], v[56:59]
    ds_read_b64_tr_b16 v[192:193], v218 offset:40960
    v_mfma_f32_16x16x32_bf16 v[52:55], v[196:199], a[100:103], v[52:55]
    ds_read_b64_tr_b16 v[194:195], v218 offset:43008
    v_mfma_f32_16x16x32_bf16 v[52:55], v[200:203], a[116:119], v[52:55]
    v_mfma_f32_16x16x32_bf16 v[48:51], v[196:199], a[96:99], v[48:51]
    v_mfma_f32_16x16x32_bf16 v[48:51], v[200:203], a[112:115], v[48:51]
    ds_read_b64_tr_b16 v[196:197], v218 offset:45056
    s_waitcnt lgkmcnt(3)
    v_mfma_f32_16x16x32_bf16 v[48:51], v[204:207], a[128:131], v[48:51]
    ds_read_b64_tr_b16 v[198:199], v218 offset:47104
    s_mov_b32 m0, s12
    v_mfma_f32_16x16x32_bf16 v[48:51], v[208:211], a[144:147], v[48:51]
    buffer_load_dwordx4 v229, s[16:19], s41 offen offset:1024 sc1 lds
    v_mfma_f32_16x16x32_bf16 v[52:55], v[204:207], a[132:135], v[52:55]
    v_mfma_f32_16x16x32_bf16 v[52:55], v[208:211], a[148:151], v[52:55]
    ds_read_b64_tr_b16 v[200:201], v218 offset:49152
    v_mfma_f32_16x16x32_bf16 v[56:59], v[204:207], a[136:139], v[56:59]
    ds_read_b64_tr_b16 v[202:203], v218 offset:51200
    v_mfma_f32_16x16x32_bf16 v[56:59], v[208:211], a[152:155], v[56:59]
    v_mfma_f32_16x16x32_bf16 v[60:63], v[204:207], a[140:143], v[60:63]
    v_mfma_f32_16x16x32_bf16 v[60:63], v[208:211], a[156:159], v[60:63]
    ds_read_b64_tr_b16 v[204:205], v218 offset:53248
    s_waitcnt lgkmcnt(3)
    v_mfma_f32_16x16x32_bf16 v[60:63], v[192:195], a[172:175], v[60:63]
    ds_read_b64_tr_b16 v[206:207], v218 offset:55296
    s_mov_b32 m0, s12
    v_mfma_f32_16x16x32_bf16 v[60:63], v[196:199], a[188:191], v[60:63]
    buffer_load_dwordx4 v229, s[16:19], s42 offen offset:2048 sc1 lds
    v_mfma_f32_16x16x32_bf16 v[56:59], v[192:195], a[168:171], v[56:59]
    v_mfma_f32_16x16x32_bf16 v[56:59], v[196:199], a[184:187], v[56:59]
    ds_read_b64_tr_b16 v[208:209], v218 offset:57344
    v_mfma_f32_16x16x32_bf16 v[52:55], v[192:195], a[164:167], v[52:55]
    ds_read_b64_tr_b16 v[210:211], v218 offset:59392
    v_mfma_f32_16x16x32_bf16 v[52:55], v[196:199], a[180:183], v[52:55]
    v_mfma_f32_16x16x32_bf16 v[48:51], v[192:195], a[160:163], v[48:51]
    v_mfma_f32_16x16x32_bf16 v[48:51], v[196:199], a[176:179], v[48:51]
    ds_read_b64_tr_b16 v[192:193], v218 offset:61440
    s_waitcnt lgkmcnt(3)
    v_mfma_f32_16x16x32_bf16 v[48:51], v[200:203], a[192:195], v[48:51]
    ds_read_b64_tr_b16 v[194:195], v218 offset:63488
    v_mfma_f32_16x16x32_bf16 v[48:51], v[204:207], a[208:211], v[48:51]
    v_mfma_f32_16x16x32_bf16 v[52:55], v[200:203], a[196:199], v[52:55]
    v_mfma_f32_16x16x32_bf16 v[52:55], v[204:207], a[212:215], v[52:55]
    ds_read_b64_tr_b16 v[196:197], v219 offset:0
    v_mfma_f32_16x16x32_bf16 v[56:59], v[200:203], a[200:203], v[56:59]
    ds_read_b64_tr_b16 v[198:199], v219 offset:2048
    v_mfma_f32_16x16x32_bf16 v[56:59], v[204:207], a[216:219], v[56:59]
    v_mfma_f32_16x16x32_bf16 v[60:63], v[200:203], a[204:207], v[60:63]
    v_mfma_f32_16x16x32_bf16 v[60:63], v[204:207], a[220:223], v[60:63]
    ds_read_b64_tr_b16 v[200:201], v219 offset:4096
    s_waitcnt lgkmcnt(3)
    v_mfma_f32_16x16x32_bf16 v[60:63], v[208:211], a[236:239], v[60:63]
    ds_read_b64_tr_b16 v[202:203], v219 offset:6144
    v_mfma_f32_16x16x32_bf16 v[60:63], v[192:195], a[252:255], v[60:63]
    v_mfma_f32_16x16x32_bf16 v[56:59], v[208:211], a[232:235], v[56:59]
    v_mfma_f32_16x16x32_bf16 v[56:59], v[192:195], a[248:251], v[56:59]
    ds_read_b64_tr_b16 v[204:205], v220 offset:0
    v_mfma_f32_16x16x32_bf16 v[52:55], v[208:211], a[228:231], v[52:55]
    ds_read_b64_tr_b16 v[206:207], v220 offset:2048
    v_mfma_f32_16x16x32_bf16 v[52:55], v[192:195], a[244:247], v[52:55]
    v_mfma_f32_16x16x32_bf16 v[48:51], v[208:211], a[224:227], v[48:51]
    v_mfma_f32_16x16x32_bf16 v[48:51], v[192:195], a[240:243], v[48:51]
    ds_read_b64_tr_b16 v[208:209], v220 offset:4096
    s_waitcnt lgkmcnt(3)
    v_mfma_f32_16x16x32_bf16 v[48:51], v[196:199], v[160:163], v[48:51]
    ds_read_b64_tr_b16 v[210:211], v220 offset:6144
    v_mfma_f32_16x16x32_bf16 v[48:51], v[200:203], v[176:179], v[48:51]
    v_mfma_f32_16x16x32_bf16 v[52:55], v[196:199], v[164:167], v[52:55]
    v_mfma_f32_16x16x32_bf16 v[52:55], v[200:203], v[180:183], v[52:55]
    ds_read_b64_tr_b16 v[192:193], v220 offset:8192
    v_mfma_f32_16x16x32_bf16 v[56:59], v[196:199], v[168:171], v[56:59]
    ds_read_b64_tr_b16 v[194:195], v220 offset:10240
    v_mfma_f32_16x16x32_bf16 v[56:59], v[200:203], v[184:187], v[56:59]
    v_mfma_f32_16x16x32_bf16 v[60:63], v[196:199], v[172:175], v[60:63]
    v_mfma_f32_16x16x32_bf16 v[60:63], v[200:203], v[188:191], v[60:63]
    ds_read_b64_tr_b16 v[196:197], v220 offset:12288
    s_waitcnt lgkmcnt(3)
    v_mfma_f32_16x16x32_bf16 v[64:67], v[204:207], a[0:3], 0
    ds_read_b64_tr_b16 v[198:199], v220 offset:14336
    v_xor_b32 v218, 96, v218
    v_mfma_f32_16x16x32_bf16 v[64:67], v[208:211], a[16:19], v[64:67]
    v_add_u32 v219, 65536, v218
    v_mfma_f32_16x16x32_bf16 v[68:71], v[204:207], a[4:7], 0
    v_mfma_f32_16x16x32_bf16 v[68:71], v[208:211], a[20:23], v[68:71]
    ds_read_b64_tr_b16 v[200:201], v220 offset:16384
    v_mfma_f32_16x16x32_bf16 v[72:75], v[204:207], a[8:11], 0
    ds_read_b64_tr_b16 v[202:203], v220 offset:18432
    s_xor_b32 s82, s100, 221184
    v_mfma_f32_16x16x32_bf16 v[72:75], v[208:211], a[24:27], v[72:75]
    v_cvt_pk_bf16_f32 v88, v48, v49
    v_cvt_pk_bf16_f32 v89, v50, v51
    v_mfma_f32_16x16x32_bf16 v[76:79], v[204:207], a[12:15], 0
    v_cvt_pk_bf16_f32 v90, v52, v53
    v_cvt_pk_bf16_f32 v91, v54, v55
    v_mfma_f32_16x16x32_bf16 v[76:79], v[208:211], a[28:31], v[76:79]
    ds_read_b64_tr_b16 v[204:205], v220 offset:20480
    s_waitcnt lgkmcnt(3)
    v_mfma_f32_16x16x32_bf16 v[76:79], v[192:195], a[44:47], v[76:79]
    ds_read_b64_tr_b16 v[206:207], v220 offset:22528
    v_min_u32 v88, -2, v88
    v_mfma_f32_16x16x32_bf16 v[76:79], v[196:199], a[60:63], v[76:79]
    buffer_store_dwordx4 v[88:91], v240, s[16:19], s82 offen offset:0 sc1
    v_cvt_pk_bf16_f32 v92, v56, v57
    v_mfma_f32_16x16x32_bf16 v[72:75], v[192:195], a[40:43], v[72:75]
    v_cvt_pk_bf16_f32 v93, v58, v59
    v_cvt_pk_bf16_f32 v94, v60, v61
    v_mfma_f32_16x16x32_bf16 v[72:75], v[196:199], a[56:59], v[72:75]
    ds_read_b64_tr_b16 v[208:209], v220 offset:24576
    v_cvt_pk_bf16_f32 v95, v62, v63
    v_mfma_f32_16x16x32_bf16 v[68:71], v[192:195], a[36:39], v[68:71]
    ds_read_b64_tr_b16 v[210:211], v220 offset:26624
    v_min_u32 v92, -2, v92
    v_mfma_f32_16x16x32_bf16 v[68:71], v[196:199], a[52:55], v[68:71]
    buffer_store_dwordx4 v[92:95], v240, s[16:19], s82 offen offset:1024 sc1
    v_mfma_f32_16x16x32_bf16 v[64:67], v[192:195], a[32:35], v[64:67]
    v_lshlrev_b32 v48, 16, v232
    v_mfma_f32_16x16x32_bf16 v[64:67], v[196:199], a[48:51], v[64:67]
    ds_read_b64_tr_b16 v[192:193], v220 offset:28672
    s_waitcnt lgkmcnt(3)
    v_mfma_f32_16x16x32_bf16 v[64:67], v[200:203], a[64:67], v[64:67]
    ds_read_b64_tr_b16 v[194:195], v220 offset:30720
    v_and_b32 v49, s51, v232
    v_mfma_f32_16x16x32_bf16 v[64:67], v[204:207], a[80:83], v[64:67]
    v_lshlrev_b32 v50, 16, v233
    v_and_b32 v51, s51, v233
    v_mfma_f32_16x16x32_bf16 v[68:71], v[200:203], a[68:71], v[68:71]
    v_lshlrev_b32 v52, 16, v234
    v_and_b32 v53, s51, v234
    v_mfma_f32_16x16x32_bf16 v[68:71], v[204:207], a[84:87], v[68:71]
    ds_read_b64_tr_b16 v[196:197], v220 offset:32768
    v_lshlrev_b32 v54, 16, v235
    v_mfma_f32_16x16x32_bf16 v[72:75], v[200:203], a[72:75], v[72:75]
    ds_read_b64_tr_b16 v[198:199], v220 offset:34816
    v_and_b32 v55, s51, v235
    v_mfma_f32_16x16x32_bf16 v[72:75], v[204:207], a[88:91], v[72:75]
    v_lshlrev_b32 v56, 16, v212
    v_and_b32 v57, s51, v212
    v_mfma_f32_16x16x32_bf16 v[76:79], v[200:203], a[76:79], v[76:79]
    v_lshlrev_b32 v58, 16, v213
    v_and_b32 v59, s51, v213
    v_mfma_f32_16x16x32_bf16 v[76:79], v[204:207], a[92:95], v[76:79]
    ds_read_b64_tr_b16 v[200:201], v220 offset:36864
    s_waitcnt lgkmcnt(3)
    v_mfma_f32_16x16x32_bf16 v[76:79], v[208:211], a[108:111], v[76:79]
    ds_read_b64_tr_b16 v[202:203], v220 offset:38912
    v_lshlrev_b32 v60, 16, v214
    v_mfma_f32_16x16x32_bf16 v[76:79], v[192:195], a[124:127], v[76:79]
    v_and_b32 v61, s51, v214
    v_lshlrev_b32 v62, 16, v215
    v_mfma_f32_16x16x32_bf16 v[72:75], v[208:211], a[104:107], v[72:75]
    v_and_b32 v63, s51, v215
    v_lshlrev_b32 v8, 16, v230
    v_mfma_f32_16x16x32_bf16 v[72:75], v[192:195], a[120:123], v[72:75]
    ds_read_b64_tr_b16 v[204:205], v220 offset:40960
    v_and_b32 v9, s51, v230
    v_mfma_f32_16x16x32_bf16 v[68:71], v[208:211], a[100:103], v[68:71]
    ds_read_b64_tr_b16 v[206:207], v220 offset:43008
    v_lshlrev_b32 v10, 16, v231
    v_mfma_f32_16x16x32_bf16 v[68:71], v[192:195], a[116:119], v[68:71]
    v_and_b32 v11, s51, v231
    s_andn2_b32 s44, s44, 32
    v_mfma_f32_16x16x32_bf16 v[64:67], v[208:211], a[96:99], v[64:67]
    s_andn2_b32 s45, s45, 32
    v_mfma_f32_16x16x32_bf16 v[64:67], v[192:195], a[112:115], v[64:67]
    ds_read_b64_tr_b16 v[208:209], v220 offset:45056
    s_waitcnt lgkmcnt(3)
    v_mfma_f32_16x16x32_bf16 v[64:67], v[196:199], a[128:131], v[64:67]
    ds_read_b64_tr_b16 v[210:211], v220 offset:47104
    v_mfma_f32_16x16x32_bf16 v[64:67], v[200:203], a[144:147], v[64:67]
    v_mfma_f32_16x16x32_bf16 v[68:71], v[196:199], a[132:135], v[68:71]
    v_mfma_f32_16x16x32_bf16 v[68:71], v[200:203], a[148:151], v[68:71]
    ds_read_b64_tr_b16 v[192:193], v220 offset:49152
    v_mfma_f32_16x16x32_bf16 v[72:75], v[196:199], a[136:139], v[72:75]
    ds_read_b64_tr_b16 v[194:195], v220 offset:51200
    v_mfma_f32_16x16x32_bf16 v[72:75], v[200:203], a[152:155], v[72:75]
    v_mfma_f32_16x16x32_bf16 v[76:79], v[196:199], a[140:143], v[76:79]
    s_waitcnt vmcnt(2)
    v_mfma_f32_16x16x32_bf16 v[76:79], v[200:203], a[156:159], v[76:79]
    ds_read_b64_tr_b16 v[196:197], v220 offset:53248
    s_waitcnt lgkmcnt(3)
    v_mfma_f32_16x16x32_bf16 v[76:79], v[204:207], a[172:175], v[76:79]
    ds_read_b64_tr_b16 v[198:199], v220 offset:55296
    ds_read_b64_tr_b16 v[96:97], v226 offset:0
    v_mfma_f32_16x16x32_bf16 v[76:79], v[208:211], a[188:191], v[76:79]
    ds_read_b64_tr_b16 v[126:127], v226 offset:32
    v_mfma_f32_16x16x32_bf16 v[72:75], v[204:207], a[168:171], v[72:75]
    ds_read_b64_tr_b16 v[128:129], v226 offset:1024
    v_mfma_f32_16x16x32_bf16 v[72:75], v[208:211], a[184:187], v[72:75]
    ds_read_b64_tr_b16 v[200:201], v220 offset:57344
    ds_read_b64_tr_b16 v[158:159], v226 offset:1056
    v_mfma_f32_16x16x32_bf16 v[68:71], v[204:207], a[164:167], v[68:71]
    ds_read_b64_tr_b16 v[202:203], v220 offset:59392
    ds_read_b64_tr_b16 v[20:21], v227 offset:2048
    v_mfma_f32_16x16x32_bf16 v[68:71], v[208:211], a[180:183], v[68:71]
    v_mfma_f32_16x16x32_bf16 v[64:67], v[204:207], a[160:163], v[64:67]
    v_mfma_f32_16x16x32_bf16 v[64:67], v[208:211], a[176:179], v[64:67]
    ds_read_b64_tr_b16 v[204:205], v220 offset:61440
    s_waitcnt lgkmcnt(8)
    v_mfma_f32_16x16x32_bf16 v[64:67], v[192:195], a[192:195], v[64:67]
    ds_read_b64_tr_b16 v[206:207], v220 offset:63488
    buffer_load_dwordx2 v[250:251], v253, s[16:19], s14 offen sc1
    v_mfma_f32_16x16x32_bf16 v[64:67], v[196:199], a[208:211], v[64:67]
    v_mfma_f32_16x16x32_bf16 v[68:71], v[192:195], a[196:199], v[68:71]
    v_mfma_f32_16x16x32_bf16 v[68:71], v[196:199], a[212:215], v[68:71]
    ds_read_b64_tr_b16 v[208:209], v221 offset:0
    v_mfma_f32_16x16x32_bf16 v[72:75], v[192:195], a[200:203], v[72:75]
    ds_read_b64_tr_b16 v[210:211], v221 offset:2048
    v_mfma_f32_16x16x32_bf16 v[72:75], v[196:199], a[216:219], v[72:75]
    v_mfma_f32_16x16x32_bf16 v[76:79], v[192:195], a[204:207], v[76:79]
    s_waitcnt lgkmcnt(4)
    v_lshlrev_b32 v22, 16, v20
    v_mfma_f32_16x16x32_bf16 v[76:79], v[196:199], a[220:223], v[76:79]
    ds_read_b64_tr_b16 v[192:193], v221 offset:4096
    s_waitcnt lgkmcnt(3)
    v_mfma_f32_16x16x32_bf16 v[76:79], v[200:203], a[236:239], v[76:79]
    ds_read_b64_tr_b16 v[194:195], v221 offset:6144
    v_and_b32 v23, s51, v20
    v_mfma_f32_16x16x32_bf16 v[76:79], v[204:207], a[252:255], v[76:79]
    v_lshlrev_b32 v24, 16, v21
    v_and_b32 v25, s51, v21
    v_mfma_f32_16x16x32_bf16 v[72:75], v[200:203], a[232:235], v[72:75]
    v_add_f32 v8, v8, v22
    v_add_f32 v9, v9, v23
    v_mfma_f32_16x16x32_bf16 v[72:75], v[204:207], a[248:251], v[72:75]
    v_add_f32 v10, v10, v24
    v_add_f32 v11, v11, v25
    v_mfma_f32_16x16x32_bf16 v[68:71], v[200:203], a[228:231], v[68:71]
    ds_read_b64_tr_b16 v[28:29], v216 offset:0
    v_mfma_f32_16x16x32_bf16 v[68:71], v[204:207], a[244:247], v[68:71]
    ds_read_b64_tr_b16 v[30:31], v216 offset:2048
    v_mfma_f32_16x16x32_bf16 v[64:67], v[200:203], a[224:227], v[64:67]
    ds_read_b64_tr_b16 v[212:213], v216 offset:4096
    v_mfma_f32_16x16x32_bf16 v[64:67], v[204:207], a[240:243], v[64:67]
    ds_read_b64_tr_b16 v[214:215], v216 offset:6144
    s_waitcnt lgkmcnt(4)
    v_mfma_f32_16x16x32_bf16 v[64:67], v[208:211], v[160:163], v[64:67]
    ds_read_b64_tr_b16 v[232:233], v218 offset:0
    v_mfma_f32_16x16x32_bf16 v[64:67], v[192:195], v[176:179], v[64:67]
    ds_read_b64_tr_b16 v[234:235], v218 offset:2048
    v_mfma_f32_16x16x32_bf16 v[68:71], v[208:211], v[164:167], v[68:71]
    ds_read_b64_tr_b16 v[0:1], v218 offset:4096
    v_mfma_f32_16x16x32_bf16 v[68:71], v[192:195], v[180:183], v[68:71]
    ds_read_b64_tr_b16 v[2:3], v218 offset:6144
    v_mfma_f32_16x16x32_bf16 v[72:75], v[208:211], v[168:171], v[72:75]
    ds_read_b64_tr_b16 v[4:5], v218 offset:8192
    v_mfma_f32_16x16x32_bf16 v[72:75], v[192:195], v[184:187], v[72:75]
    ds_read_b64_tr_b16 v[6:7], v218 offset:10240
    v_mfma_f32_16x16x32_bf16 v[76:79], v[208:211], v[172:175], v[76:79]
    ds_read_b64_tr_b16 v[88:89], v218 offset:12288
    v_mfma_f32_16x16x32_bf16 v[76:79], v[192:195], v[188:191], v[76:79]
    ds_read_b64_tr_b16 v[90:91], v218 offset:14336
    s_waitcnt lgkmcnt(8)
    v_mfma_f32_16x16x32_bf16 v[32:35], v[28:31], a[8:11], 0
    ds_read_b64_tr_b16 v[92:93], v216 offset:8192
    v_mfma_f32_16x16x32_bf16 v[32:35], v[212:215], a[24:27], v[32:35]
    ds_read_b64_tr_b16 v[94:95], v216 offset:10240
    v_mfma_f32_16x16x32_bf16 v[36:39], v[28:31], a[12:15], 0
    ds_read_b64_tr_b16 v[196:197], v216 offset:12288
    v_mfma_f32_16x16x32_bf16 v[36:39], v[212:215], a[28:31], v[36:39]
    ds_read_b64_tr_b16 v[198:199], v216 offset:14336
    s_waitcnt lgkmcnt(8)
    v_mfma_f32_16x16x32_bf16 v[40:43], v[232:235], a[8:11], 0
    ds_read_b64_tr_b16 v[200:201], v216 offset:16384
    s_xor_b32 s82, s100, 147456
    v_mfma_f32_16x16x32_bf16 v[40:43], v[0:3], a[24:27], v[40:43]
    ds_read_b64_tr_b16 v[202:203], v216 offset:18432
    v_cvt_pk_bf16_f32 v80, v68, v69
    v_mfma_f32_16x16x32_bf16 v[44:47], v[232:235], a[12:15], 0
    ds_read_b64_tr_b16 v[204:205], v216 offset:20480
    v_cvt_pk_bf16_f32 v81, v70, v71
    v_mfma_f32_16x16x32_bf16 v[44:47], v[0:3], a[28:31], v[44:47]
    ds_read_b64_tr_b16 v[206:207], v216 offset:22528
    s_waitcnt lgkmcnt(8)
    v_mfma_f32_16x16x32_bf16 v[44:47], v[4:7], a[44:47], v[44:47]
    ds_read_b64_tr_b16 v[208:209], v218 offset:16384
    v_cvt_pk_bf16_f32 v82, v64, v65
    v_mfma_f32_16x16x32_bf16 v[44:47], v[88:91], a[60:63], v[44:47]
    ds_read_b64_tr_b16 v[210:211], v218 offset:18432
    v_cvt_pk_bf16_f32 v83, v66, v67
    v_mfma_f32_16x16x32_bf16 v[40:43], v[4:7], a[40:43], v[40:43]
    ds_read_b64_tr_b16 v[192:193], v218 offset:20480
    v_min_u32 v80, -2, v80
    v_mfma_f32_16x16x32_bf16 v[40:43], v[88:91], a[56:59], v[40:43]
    ds_read_b64_tr_b16 v[194:195], v218 offset:22528
    s_waitcnt lgkmcnt(8)
    v_mfma_f32_16x16x32_bf16 v[36:39], v[92:95], a[44:47], v[36:39]
    ds_read_b64_tr_b16 a[8:9], v218 offset:24576
    buffer_store_dwordx4 v[80:83], v240, s[16:19], s82 offen offset:0 sc1
    v_mfma_f32_16x16x32_bf16 v[36:39], v[196:199], a[60:63], v[36:39]
    ds_read_b64_tr_b16 a[10:11], v218 offset:26624
    v_cvt_pk_bf16_f32 v84, v76, v77
    v_mfma_f32_16x16x32_bf16 v[32:35], v[92:95], a[40:43], v[32:35]
    ds_read_b64_tr_b16 a[12:13], v218 offset:28672
    v_cvt_pk_bf16_f32 v85, v78, v79
    v_mfma_f32_16x16x32_bf16 v[32:35], v[196:199], a[56:59], v[32:35]
    ds_read_b64_tr_b16 a[14:15], v218 offset:30720
    s_waitcnt lgkmcnt(8)
    v_mfma_f32_16x16x32_bf16 v[32:35], v[200:203], a[72:75], v[32:35]
    ds_read_b64_tr_b16 a[24:25], v216 offset:24576
    v_cvt_pk_bf16_f32 v86, v72, v73
    v_mfma_f32_16x16x32_bf16 v[32:35], v[204:207], a[88:91], v[32:35]
    ds_read_b64_tr_b16 a[26:27], v216 offset:26624
    v_cvt_pk_bf16_f32 v87, v74, v75
    v_mfma_f32_16x16x32_bf16 v[36:39], v[200:203], a[76:79], v[36:39]
    ds_read_b64_tr_b16 a[28:29], v216 offset:28672
    v_min_u32 v84, -2, v84
    v_mfma_f32_16x16x32_bf16 v[36:39], v[204:207], a[92:95], v[36:39]
    ds_read_b64_tr_b16 a[30:31], v216 offset:30720
    s_waitcnt lgkmcnt(8)
    v_mfma_f32_16x16x32_bf16 v[40:43], v[208:211], a[72:75], v[40:43]
    ds_read_b64_tr_b16 a[40:41], v216 offset:32768
    buffer_store_dwordx4 v[84:87], v240, s[16:19], s82 offen offset:1024 sc1
    v_mfma_f32_16x16x32_bf16 v[40:43], v[192:195], a[88:91], v[40:43]
    ds_read_b64_tr_b16 a[42:43], v216 offset:34816
    v_mfma_f32_16x16x32_bf16 v[44:47], v[208:211], a[76:79], v[44:47]
    ds_read_b64_tr_b16 a[44:45], v216 offset:36864
    v_mfma_f32_16x16x32_bf16 v[44:47], v[192:195], a[92:95], v[44:47]
    ds_read_b64_tr_b16 a[46:47], v216 offset:38912
    s_waitcnt lgkmcnt(8)
    v_mfma_f32_16x16x32_bf16 v[44:47], a[8:11], a[108:111], v[44:47]
    ds_read_b64_tr_b16 a[56:57], v218 offset:32768
    v_mfma_f32_16x16x32_bf16 v[44:47], a[12:15], a[124:127], v[44:47]
    ds_read_b64_tr_b16 a[58:59], v218 offset:34816
    v_mfma_f32_16x16x32_bf16 v[40:43], a[8:11], a[104:107], v[40:43]
    ds_read_b64_tr_b16 a[60:61], v218 offset:36864
    v_mfma_f32_16x16x32_bf16 v[40:43], a[12:15], a[120:123], v[40:43]
    ds_read_b64_tr_b16 a[62:63], v218 offset:38912
    s_waitcnt lgkmcnt(8)
    v_mfma_f32_16x16x32_bf16 v[36:39], a[24:27], a[108:111], v[36:39]
    ds_read_b64_tr_b16 a[72:73], v218 offset:40960
    v_mfma_f32_16x16x32_bf16 v[36:39], a[28:31], a[124:127], v[36:39]
    ds_read_b64_tr_b16 a[74:75], v218 offset:43008
    v_mfma_f32_16x16x32_bf16 v[32:35], a[24:27], a[104:107], v[32:35]
    ds_read_b64_tr_b16 a[76:77], v218 offset:45056
    v_mfma_f32_16x16x32_bf16 v[32:35], a[28:31], a[120:123], v[32:35]
    ds_read_b64_tr_b16 a[78:79], v218 offset:47104
    s_waitcnt lgkmcnt(8)
    v_mfma_f32_16x16x32_bf16 v[32:35], a[40:43], a[136:139], v[32:35]
    ds_read_b64_tr_b16 a[88:89], v216 offset:40960
    v_mfma_f32_16x16x32_bf16 v[32:35], a[44:47], a[152:155], v[32:35]
    ds_read_b64_tr_b16 a[90:91], v216 offset:43008
    v_mfma_f32_16x16x32_bf16 v[36:39], a[40:43], a[140:143], v[36:39]
    ds_read_b64_tr_b16 a[92:93], v216 offset:45056
    v_mfma_f32_16x16x32_bf16 v[36:39], a[44:47], a[156:159], v[36:39]
    ds_read_b64_tr_b16 a[94:95], v216 offset:47104
    s_waitcnt lgkmcnt(8)
    v_mfma_f32_16x16x32_bf16 v[40:43], a[56:59], a[136:139], v[40:43]
    ds_read_b64_tr_b16 a[104:105], v216 offset:49152
    v_mfma_f32_16x16x32_bf16 v[40:43], a[60:63], a[152:155], v[40:43]
    ds_read_b64_tr_b16 a[106:107], v216 offset:51200
    v_mfma_f32_16x16x32_bf16 v[44:47], a[56:59], a[140:143], v[44:47]
    ds_read_b64_tr_b16 a[108:109], v216 offset:53248
    v_mfma_f32_16x16x32_bf16 v[44:47], a[60:63], a[156:159], v[44:47]
    ds_read_b64_tr_b16 a[110:111], v216 offset:55296
    s_waitcnt lgkmcnt(8)
    v_mfma_f32_16x16x32_bf16 v[44:47], a[72:75], a[172:175], v[44:47]
    ds_read_b64_tr_b16 a[120:121], v218 offset:49152
    v_mfma_f32_16x16x32_bf16 v[44:47], a[76:79], a[188:191], v[44:47]
    ds_read_b64_tr_b16 a[122:123], v218 offset:51200
    s_waitcnt vmcnt(2)
    v_mfma_f32_16x16x32_bf16 v[40:43], a[72:75], a[168:171], v[40:43]
    ds_read_b64_tr_b16 a[124:125], v218 offset:53248
    v_cmp_ne_u64 vcc, v[250:251], v[248:249]
    v_mfma_f32_16x16x32_bf16 v[40:43], a[76:79], a[184:187], v[40:43]
    ds_read_b64_tr_b16 a[126:127], v218 offset:55296
    s_waitcnt lgkmcnt(8)
    v_mfma_f32_16x16x32_bf16 v[36:39], a[88:91], a[172:175], v[36:39]
    ds_read_b64_tr_b16 a[136:137], v218 offset:57344
    s_cbranch_vccnz L_slow_20
L_back_21:
    v_mfma_f32_16x16x32_bf16 v[36:39], a[92:95], a[188:191], v[36:39]
    ds_read_b64_tr_b16 a[138:139], v218 offset:59392
    s_add_u32 s50, s49, 4096
    v_mfma_f32_16x16x32_bf16 v[32:35], a[88:91], a[168:171], v[32:35]
    ds_read_b64_tr_b16 a[140:141], v218 offset:61440
    buffer_load_dwordx4 v[64:67], v225, s[16:19], s49 offen sc1
    v_mfma_f32_16x16x32_bf16 v[32:35], a[92:95], a[184:187], v[32:35]
    ds_read_b64_tr_b16 a[142:143], v218 offset:63488
    s_waitcnt lgkmcnt(8)
    v_mfma_f32_16x16x32_bf16 v[32:35], a[104:107], a[200:203], v[32:35]
    ds_read_b64_tr_b16 a[152:153], v216 offset:57344
    v_mfma_f32_16x16x32_bf16 v[32:35], a[108:111], a[216:219], v[32:35]
    ds_read_b64_tr_b16 a[154:155], v216 offset:59392
    v_mfma_f32_16x16x32_bf16 v[36:39], a[104:107], a[204:207], v[36:39]
    ds_read_b64_tr_b16 a[156:157], v216 offset:61440
    v_mfma_f32_16x16x32_bf16 v[36:39], a[108:111], a[220:223], v[36:39]
    ds_read_b64_tr_b16 a[158:159], v216 offset:63488
    s_waitcnt lgkmcnt(8)
    v_mfma_f32_16x16x32_bf16 v[40:43], a[120:123], a[200:203], v[40:43]
    ds_read_b64_tr_b16 a[168:169], v217 offset:0
    buffer_load_dwordx4 v[68:71], v225, s[16:19], s50 offen sc1
    v_mfma_f32_16x16x32_bf16 v[40:43], a[124:127], a[216:219], v[40:43]
    ds_read_b64_tr_b16 a[170:171], v217 offset:2048
    s_xor_b32 s57, s77, 57344
    v_mfma_f32_16x16x32_bf16 v[44:47], a[120:123], a[204:207], v[44:47]
    ds_read_b64_tr_b16 a[172:173], v217 offset:4096
    v_mfma_f32_16x16x32_bf16 v[44:47], a[124:127], a[220:223], v[44:47]
    ds_read_b64_tr_b16 a[174:175], v217 offset:6144
    s_waitcnt lgkmcnt(8)
    v_mfma_f32_16x16x32_bf16 v[44:47], a[136:139], a[236:239], v[44:47]
    ds_read_b64_tr_b16 a[184:185], v219 offset:0
    v_mfma_f32_16x16x32_bf16 v[44:47], a[140:143], a[252:255], v[44:47]
    ds_read_b64_tr_b16 a[186:187], v219 offset:2048
    buffer_load_dwordx4 v[98:101], v26, s[16:19], s57 offen offset:1024 sc1
    v_mfma_f32_16x16x32_bf16 v[40:43], a[136:139], a[232:235], v[40:43]
    ds_read_b64_tr_b16 a[188:189], v219 offset:4096
    v_mfma_f32_16x16x32_bf16 v[40:43], a[140:143], a[248:251], v[40:43]
    ds_read_b64_tr_b16 a[190:191], v219 offset:6144
    s_waitcnt lgkmcnt(8)
    v_mfma_f32_16x16x32_bf16 v[36:39], a[152:155], a[236:239], v[36:39]
    v_mfma_f32_16x16x32_bf16 v[36:39], a[156:159], a[252:255], v[36:39]
    v_mfma_f32_16x16x32_bf16 v[32:35], a[152:155], a[232:235], v[32:35]
    buffer_load_dwordx4 v[130:133], v27, s[16:19], s57 offen offset:0 sc1
    s_xor_b32 s56, s77, 49152
    v_mfma_f32_16x16x32_bf16 v[32:35], a[156:159], a[248:251], v[32:35]
    s_waitcnt lgkmcnt(4)
    v_mfma_f32_16x16x32_bf16 v[32:35], a[168:171], v[168:171], v[32:35]
    v_mfma_f32_16x16x32_bf16 v[32:35], a[172:175], v[184:187], v[32:35]
    v_mfma_f32_16x16x32_bf16 v[36:39], a[168:171], v[172:175], v[36:39]
    v_mfma_f32_16x16x32_bf16 v[36:39], a[172:175], v[188:191], v[36:39]
    buffer_load_dwordx4 v[102:105], v26, s[16:19], s56 offen offset:0 sc1
    s_waitcnt lgkmcnt(0)
    v_mfma_f32_16x16x32_bf16 v[40:43], a[184:187], v[168:171], v[40:43]
    v_mfma_f32_16x16x32_bf16 v[40:43], a[188:191], v[184:187], v[40:43]
    v_mfma_f32_16x16x32_bf16 v[44:47], a[184:187], v[172:175], v[44:47]
    v_mfma_f32_16x16x32_bf16 v[44:47], a[188:191], v[188:191], v[44:47]
    v_mfma_f32_16x16x32_bf16 v[48:51], v[232:235], a[0:3], v[48:51]
    buffer_load_dwordx4 v[134:137], v27, s[16:19], s56 offen offset:1024 sc1
    s_xor_b32 s57, s77, 40960
    v_mfma_f32_16x16x32_bf16 v[48:51], v[0:3], a[16:19], v[48:51]
    v_mfma_f32_16x16x32_bf16 v[48:51], v[4:7], a[32:35], v[48:51]
    s_xor_b32 s82, s100, 73728
    v_cvt_pk_bf16_f32 v80, v32, v33
    v_mfma_f32_16x16x32_bf16 v[48:51], v[88:91], a[48:51], v[48:51]
    v_cvt_pk_bf16_f32 v81, v34, v35
    v_cvt_pk_bf16_f32 v82, v36, v37
    v_mfma_f32_16x16x32_bf16 v[48:51], v[208:211], a[64:67], v[48:51]
    v_cvt_pk_bf16_f32 v83, v38, v39
    v_min_u32 v80, -2, v80
    v_mfma_f32_16x16x32_bf16 v[48:51], v[192:195], a[80:83], v[48:51]
    buffer_store_dwordx4 v[80:83], v240, s[16:19], s82 offen offset:0 sc1
    v_cvt_pk_bf16_f32 v84, v40, v41
    v_mfma_f32_16x16x32_bf16 v[56:59], v[28:31], a[0:3], v[56:59]
    v_cvt_pk_bf16_f32 v85, v42, v43
    v_cvt_pk_bf16_f32 v86, v44, v45
    v_mfma_f32_16x16x32_bf16 v[56:59], v[212:215], a[16:19], v[56:59]
    v_cvt_pk_bf16_f32 v87, v46, v47
    v_min_u32 v84, -2, v84
    v_mfma_f32_16x16x32_bf16 v[56:59], v[92:95], a[32:35], v[56:59]
    v_mfma_f32_16x16x32_bf16 v[56:59], v[196:199], a[48:51], v[56:59]
    buffer_store_dwordx4 v[84:87], v240, s[16:19], s82 offen offset:1024 sc1
    v_mfma_f32_16x16x32_bf16 v[56:59], v[200:203], a[64:67], v[56:59]
    v_mfma_f32_16x16x32_bf16 v[56:59], v[204:207], a[80:83], v[56:59]
    v_mfma_f32_16x16x32_bf16 v[52:55], v[232:235], a[4:7], v[52:55]
    v_mfma_f32_16x16x32_bf16 v[52:55], v[0:3], a[20:23], v[52:55]
    buffer_load_dwordx4 v[106:109], v26, s[16:19], s57 offen offset:1024 sc1
    v_mfma_f32_16x16x32_bf16 v[52:55], v[4:7], a[36:39], v[52:55]
    v_mfma_f32_16x16x32_bf16 v[52:55], v[88:91], a[52:55], v[52:55]
    v_mfma_f32_16x16x32_bf16 v[52:55], v[208:211], a[68:71], v[52:55]
    v_mfma_f32_16x16x32_bf16 v[52:55], v[192:195], a[84:87], v[52:55]
    v_mfma_f32_16x16x32_bf16 v[60:63], v[28:31], a[4:7], v[60:63]
    buffer_load_dwordx4 v[138:141], v27, s[16:19], s57 offen offset:0 sc1
    s_xor_b32 s55, s77, 32768
    v_mfma_f32_16x16x32_bf16 v[60:63], v[212:215], a[20:23], v[60:63]
    v_mfma_f32_16x16x32_bf16 v[60:63], v[92:95], a[36:39], v[60:63]
    v_mfma_f32_16x16x32_bf16 v[60:63], v[196:199], a[52:55], v[60:63]
    v_mfma_f32_16x16x32_bf16 v[60:63], v[200:203], a[68:71], v[60:63]
    v_mfma_f32_16x16x32_bf16 v[60:63], v[204:207], a[84:87], v[60:63]
    buffer_load_dwordx4 v[110:113], v26, s[16:19], s55 offen offset:0 sc1
    v_mfma_f32_16x16x32_bf16 v[48:51], a[8:11], a[96:99], v[48:51]
    v_mfma_f32_16x16x32_bf16 v[48:51], a[12:15], a[112:115], v[48:51]
    v_mfma_f32_16x16x32_bf16 v[48:51], a[56:59], a[128:131], v[48:51]
    v_mfma_f32_16x16x32_bf16 v[48:51], a[60:63], a[144:147], v[48:51]
    v_mfma_f32_16x16x32_bf16 v[48:51], a[72:75], a[160:163], v[48:51]
    buffer_load_dwordx4 v[142:145], v27, s[16:19], s55 offen offset:1024 sc1
    s_xor_b32 s54, s77, 24576
    v_mfma_f32_16x16x32_bf16 v[48:51], a[76:79], a[176:179], v[48:51]
    v_mfma_f32_16x16x32_bf16 v[56:59], a[24:27], a[96:99], v[56:59]
    v_mfma_f32_16x16x32_bf16 v[56:59], a[28:31], a[112:115], v[56:59]
    v_mfma_f32_16x16x32_bf16 v[56:59], a[40:43], a[128:131], v[56:59]
    v_mfma_f32_16x16x32_bf16 v[56:59], a[44:47], a[144:147], v[56:59]
    buffer_load_dwordx4 v[114:117], v26, s[16:19], s54 offen offset:1024 sc1
    v_mfma_f32_16x16x32_bf16 v[56:59], a[88:91], a[160:163], v[56:59]
    v_mfma_f32_16x16x32_bf16 v[56:59], a[92:95], a[176:179], v[56:59]
    v_mfma_f32_16x16x32_bf16 v[52:55], a[8:11], a[100:103], v[52:55]
    v_mfma_f32_16x16x32_bf16 v[52:55], a[12:15], a[116:119], v[52:55]
    v_mfma_f32_16x16x32_bf16 v[52:55], a[56:59], a[132:135], v[52:55]
    buffer_load_dwordx4 v[146:149], v27, s[16:19], s54 offen offset:0 sc1
    s_xor_b32 s53, s77, 16384
    v_mfma_f32_16x16x32_bf16 v[52:55], a[60:63], a[148:151], v[52:55]
    v_mfma_f32_16x16x32_bf16 v[52:55], a[72:75], a[164:167], v[52:55]
    v_mfma_f32_16x16x32_bf16 v[52:55], a[76:79], a[180:183], v[52:55]
    v_mfma_f32_16x16x32_bf16 v[60:63], a[24:27], a[100:103], v[60:63]
    v_mfma_f32_16x16x32_bf16 v[60:63], a[28:31], a[116:119], v[60:63]
    buffer_load_dwordx4 v[118:121], v26, s[16:19], s53 offen offset:0 sc1
    v_mfma_f32_16x16x32_bf16 v[60:63], a[40:43], a[132:135], v[60:63]
    v_mfma_f32_16x16x32_bf16 v[60:63], a[44:47], a[148:151], v[60:63]
    v_mfma_f32_16x16x32_bf16 v[60:63], a[88:91], a[164:167], v[60:63]
    v_mfma_f32_16x16x32_bf16 v[60:63], a[92:95], a[180:183], v[60:63]
    v_mfma_f32_16x16x32_bf16 v[48:51], a[120:123], a[192:195], v[48:51]
    buffer_load_dwordx4 v[150:153], v27, s[16:19], s53 offen offset:1024 sc1
    v_mfma_f32_16x16x32_bf16 v[48:51], a[124:127], a[208:211], v[48:51]
    v_mfma_f32_16x16x32_bf16 v[48:51], a[136:139], a[224:227], v[48:51]
    v_mfma_f32_16x16x32_bf16 v[48:51], a[140:143], a[240:243], v[48:51]
    v_mfma_f32_16x16x32_bf16 v[48:51], a[184:187], v[160:163], v[48:51]
    v_mfma_f32_16x16x32_bf16 v[48:51], a[188:191], v[176:179], v[48:51]
    v_mfma_f32_16x16x32_bf16 v[56:59], a[104:107], a[192:195], v[56:59]
    v_mfma_f32_16x16x32_bf16 v[56:59], a[108:111], a[208:211], v[56:59]
    v_mfma_f32_16x16x32_bf16 v[56:59], a[152:155], a[224:227], v[56:59]
    v_mfma_f32_16x16x32_bf16 v[56:59], a[156:159], a[240:243], v[56:59]
    v_mfma_f32_16x16x32_bf16 v[56:59], a[168:171], v[160:163], v[56:59]
    v_mfma_f32_16x16x32_bf16 v[56:59], a[172:175], v[176:179], v[56:59]
    v_mfma_f32_16x16x32_bf16 v[52:55], a[120:123], a[196:199], v[52:55]
    v_mfma_f32_16x16x32_bf16 v[52:55], a[124:127], a[212:215], v[52:55]
    v_mfma_f32_16x16x32_bf16 v[52:55], a[136:139], a[228:231], v[52:55]
    v_mfma_f32_16x16x32_bf16 v[52:55], a[140:143], a[244:247], v[52:55]
    v_mfma_f32_16x16x32_bf16 v[52:55], a[184:187], v[164:167], v[52:55]
    v_mfma_f32_16x16x32_bf16 v[52:55], a[188:191], v[180:183], v[52:55]
    v_mfma_f32_16x16x32_bf16 v[60:63], a[104:107], a[196:199], v[60:63]
    s_xor_b32 s52, s77, 8192
    buffer_load_dwordx4 v[122:125], v26, s[16:19], s52 offen offset:0 sc1
    v_mfma_f32_16x16x32_bf16 v[60:63], a[108:111], a[212:215], v[60:63]
    v_mfma_f32_16x16x32_bf16 v[60:63], a[152:155], a[228:231], v[60:63]
    buffer_load_dwordx4 v[154:157], v26, s[16:19], s52 offen offset:1024 sc1
    v_mfma_f32_16x16x32_bf16 v[60:63], a[156:159], a[244:247], v[60:63]
    v_mfma_f32_16x16x32_bf16 v[60:63], a[168:171], v[164:167], v[60:63]
    v_mfma_f32_16x16x32_bf16 v[60:63], a[172:175], v[180:183], v[60:63]
    s_waitcnt vmcnt(16)
    v_mfma_f32_16x16x32_bf16 v[8:11], v[16:19], v[64:67], v[8:11]
    v_mfma_f32_16x16x32_bf16 v[8:11], v[16:19], v[68:71], v[8:11]
    s_waitcnt vmcnt(8)
    v_mfma_f32_16x16x32_bf16 v[48:51], v[12:15], v[96:99], v[48:51]
    v_mfma_f32_16x16x32_bf16 v[56:59], v[12:15], v[128:131], v[56:59]
    v_mfma_f32_16x16x32_bf16 v[52:55], v[12:15], v[100:103], v[52:55]
    v_mfma_f32_16x16x32_bf16 v[60:63], v[12:15], v[132:135], v[60:63]
    v_mfma_f32_16x16x32_bf16 v[48:51], v[12:15], v[104:107], v[48:51]
    v_mfma_f32_16x16x32_bf16 v[56:59], v[12:15], v[136:139], v[56:59]
    v_cvt_pk_bf16_f32 v20, v8, v9
    v_cvt_pk_bf16_f32 v21, v10, v11
    buffer_store_dwordx2 v[20:21], v224, s[28:31], s48 offen sc1 nt
    s_waitcnt vmcnt(3)
    v_max_u32 v244, v110, v142
    v_max3_u32 v244, v244, v114, v146
    v_max3_u32 v244, v244, v118, v150
    v_cmp_eq_u32 vcc, -1, v244
    s_cbranch_vccnz L_slow_22
L_back_23:
    v_mfma_f32_16x16x32_bf16 v[52:55], v[12:15], v[108:111], v[52:55]
    v_mfma_f32_16x16x32_bf16 v[60:63], v[12:15], v[140:143], v[60:63]
    v_mfma_f32_16x16x32_bf16 v[48:51], v[12:15], v[112:115], v[48:51]
    v_mfma_f32_16x16x32_bf16 v[56:59], v[12:15], v[144:147], v[56:59]
    v_mfma_f32_16x16x32_bf16 v[52:55], v[12:15], v[116:119], v[52:55]
    v_mfma_f32_16x16x32_bf16 v[60:63], v[12:15], v[148:151], v[60:63]
    s_waitcnt vmcnt(1)
    v_max_u32 v244, v122, v154
    v_cmp_eq_u32 vcc, -1, v244
    s_cbranch_vccnz L_slow_24
L_back_25:
    v_mfma_f32_16x16x32_bf16 v[48:51], v[12:15], v[120:123], v[48:51]
    v_mfma_f32_16x16x32_bf16 v[56:59], v[12:15], v[152:155], v[56:59]
    v_mfma_f32_16x16x32_bf16 v[52:55], v[12:15], v[124:127], v[52:55]
    v_mfma_f32_16x16x32_bf16 v[60:63], v[12:15], v[156:159], v[60:63]
    s_nop 4
    v_cvt_pk_bf16_f32 v80, v48, v49
    v_cvt_pk_bf16_f32 v81, v50, v51
    s_nop 0
    v_cvt_pk_bf16_f32 v82, v56, v57
    v_cvt_pk_bf16_f32 v83, v58, v59
    s_nop 1
    v_permlane16_swap_b32 v80, v82
    v_permlane16_swap_b32 v81, v83
    s_nop 0
    buffer_store_dwordx4 v[80:83], v228, s[28:31], s44 offen sc1 nt
    s_nop 0
    v_cvt_pk_bf16_f32 v84, v52, v53
    v_cvt_pk_bf16_f32 v85, v54, v55
    s_nop 0
    v_cvt_pk_bf16_f32 v86, v60, v61
    v_cvt_pk_bf16_f32 v87, v62, v63
    s_nop 1
    v_permlane16_swap_b32 v84, v86
    v_permlane16_swap_b32 v85, v87
    s_nop 0
    buffer_store_dwordx4 v[84:87], v228, s[28:31], s45 offen sc1 nt
L_end:
    s_endpgm
L_pref:
    s_waitcnt vmcnt(0)
    buffer_load_dwordx2 v[248:249], off, s[76:79], 0 sc1
    v_add_u32 v2, 0, v237
    v_add_u32 v3, 73728, v237
    v_xor_b32 v3, 32, v3
    v_add_u32 v4, 0, v239
    s_branch L_dma2
L_slow_2:
    s_add_u32 s3, s3, 1
    s_cmp_gt_u32 s3, 200000
    s_cbranch_scc1 L_end2
    buffer_load_dwordx2 v[248:249], off, s[76:79], 0 sc1
    s_waitcnt vmcnt(0)
    v_cmp_eq_u32 vcc, 0, v248
    s_cbranch_vccnz L_slow_2
    s_branch L_back_3
L_slow_4:
    s_add_u32 s3, s3, 1
    s_cmp_gt_u32 s3, 200000
    s_cbranch_scc1 L_end2
    buffer_load_dwordx2 v[248:249], off, s[76:79], 0 sc1
    s_waitcnt vmcnt(0)
    v_cmp_eq_u32 vcc, 0, v248
    s_cbranch_vccnz L_slow_4
    s_branch L_back_5
L_slow_6:
    s_add_u32 s3, s3, 1
    s_cmp_gt_u32 s3, 200000
    s_cbranch_scc1 L_end2
    buffer_load_dwordx2 v[250:251], v253, s[16:19], s80 offen sc1
    s_waitcnt vmcnt(0)
    v_cmp_ne_u64 vcc, v[250:251], v[248:249]
    s_cbranch_vccnz L_slow_6
    s_branch L_back_7
L_slow_8:
    s_add_u32 s3, s3, 1
    s_cmp_gt_u32 s3, 200000
    s_cbranch_scc1 L_end2
    buffer_load_dwordx2 v[248:249], off, s[76:79], 0 sc1
    s_waitcnt vmcnt(0)
    v_cmp_eq_u32 vcc, 0, v248
    s_cbranch_vccnz L_slow_8
    s_branch L_back_9
L_slow_10:
    s_add_u32 s3, s3, 1
    s_cmp_gt_u32 s3, 200000
    s_cbranch_scc1 L_end2
    buffer_load_dwordx2 v[250:251], v253, s[16:19], s80 offen sc1
    s_waitcnt vmcnt(0)
    v_cmp_ne_u64 vcc, v[250:251], v[248:249]
    s_cbranch_vccnz L_slow_10
    s_branch L_back_11
L_slow_12:
    s_add_u32 s3, s3, 1
    s_cmp_gt_u32 s3, 200000
    s_cbranch_scc1 L_end2
    buffer_load_dwordx2 v[250:251], v253, s[16:19], s14 offen sc1
    s_waitcnt vmcnt(0)
    v_cmp_ne_u64 vcc, v[250:251], v[248:249]
    s_cbranch_vccnz L_slow_12
    s_branch L_back_13
L_slow_14:
    s_add_u32 s3, s3, 1
    s_cmp_gt_u32 s3, 200000
    s_cbranch_scc1 L_end2
    buffer_load_dwordx2 v[250:251], v253, s[16:19], s14 offen sc1
    s_waitcnt vmcnt(0)
    v_cmp_ne_u64 vcc, v[250:251], v[248:249]
    s_cbranch_vccnz L_slow_14
    s_branch L_back_15
L_slow_16:
    s_add_u32 s3, s3, 1
    s_cmp_gt_u32 s3, 200000
    s_cbranch_scc1 L_end2
    buffer_load_dwordx2 v[250:251], v253, s[16:19], s14 offen sc1
    s_waitcnt vmcnt(0)
    v_cmp_ne_u64 vcc, v[250:251], v[248:249]
    s_cbranch_vccnz L_slow_16
    s_branch L_back_17
L_slow_18:
    s_add_u32 s3, s3, 1
    s_cmp_gt_u32 s3, 200000
    s_cbranch_scc1 L_end2
    buffer_load_dwordx2 v[250:251], v253, s[16:19], s14 offen sc1
    s_waitcnt vmcnt(0)
    v_cmp_ne_u64 vcc, v[250:251], v[248:249]
    s_cbranch_vccnz L_slow_18
    s_branch L_back_19
L_slow_20:
    s_add_u32 s3, s3, 1
    s_cmp_gt_u32 s3, 200000
    s_cbranch_scc1 L_end2
    buffer_load_dwordx2 v[250:251], v253, s[16:19], s14 offen sc1
    s_waitcnt vmcnt(0)
    v_cmp_ne_u64 vcc, v[250:251], v[248:249]
    s_cbranch_vccnz L_slow_20
    s_branch L_back_21
L_slow_22:
    s_add_u32 s3, s3, 1
    s_cmp_gt_u32 s3, 200000
    s_cbranch_scc1 L_end2
    buffer_load_dwordx4 v[110:113], v26, s[16:19], s55 offen offset:0 sc1
    buffer_load_dwordx4 v[142:145], v27, s[16:19], s55 offen offset:1024 sc1
    buffer_load_dwordx4 v[114:117], v26, s[16:19], s54 offen offset:1024 sc1
    buffer_load_dwordx4 v[146:149], v27, s[16:19], s54 offen offset:0 sc1
    buffer_load_dwordx4 v[118:121], v26, s[16:19], s53 offen offset:0 sc1
    buffer_load_dwordx4 v[150:153], v27, s[16:19], s53 offen offset:1024 sc1
    s_waitcnt vmcnt(0)
    v_max_u32 v244, v110, v142
    v_max3_u32 v244, v244, v114, v146
    v_max3_u32 v244, v244, v118, v150
    v_cmp_eq_u32 vcc, -1, v244
    s_cbranch_vccnz L_slow_22
    s_branch L_back_23
L_slow_24:
    s_add_u32 s3, s3, 1
    s_cmp_gt_u32 s3, 200000
    s_cbranch_scc1 L_end2
    buffer_load_dwordx4 v[122:125], v26, s[16:19], s52 offen offset:0 sc1
    buffer_load_dwordx4 v[154:157], v26, s[16:19], s52 offen offset:1024 sc1
    s_waitcnt vmcnt(0)
    v_max_u32 v244, v122, v154
    v_cmp_eq_u32 vcc, -1, v244
    s_cbranch_vccnz L_slow_24
    s_branch L_back_25
L_end2:
    s_endpgm
.section .rodata,"a"
.p2align 6
.amdhsa_kernel parallel_sum__ssm_conv_s4d__glu_gated_bilinear__prompt_kernel
  .amdhsa_next_free_vgpr 512
  .amdhsa_next_free_sgpr 102
  .amdhsa_accum_offset 256
  .amdhsa_group_segment_fixed_size 0
  .amdhsa_kernarg_size 112
  .amdhsa_user_sgpr_count 2
  .amdhsa_user_sgpr_kernarg_segment_ptr 1
  .amdhsa_system_sgpr_workgroup_id_x 1
.end_amdhsa_kernel
```
